```python
import torch

def _softmax(x, axis=-1):
    return torch.softmax(x, dim=axis)
def _gelu(x):
    return torch.nn.functional.gelu(x, approximate="tanh")
def _silu(x):
    return torch.nn.functional.silu(x)
def _sigmoid(x):
    return torch.sigmoid(x)
def _layernorm(x, axis=-1, eps=1e-5):
    m = x.mean(dim=axis, keepdim=True)
    v = x.var(dim=axis, keepdim=True, unbiased=False)
    return (x - m) / torch.sqrt(v + eps)
def _scatter_add(tgt, idx, src, axis=0):
    return tgt.clone().index_add_(axis, idx, src)
def _segment_sum(src, seg, n):
    out = torch.zeros((n,) + src.shape[1:], dtype=src.dtype)
    return out.index_add_(0, seg, src)
def _pad(x, pw):
    flat = tuple(v for pair in reversed(pw) for v in pair)
    return torch.nn.functional.pad(x, flat)

kernel_name = 'gated_mix__sliding_block__moe_arch_mod__prompt'

def setup_inputs():

    _w = (lambda a: (lambda t: t.to(torch.bfloat16) if t.is_floating_point() else t)(torch.as_tensor(a)))
    def _A_setup():
        B, S, D = 1, 2048, 640
        return {
            "x": _w((lambda *s: torch.randn(*s, dtype=torch.bfloat16) * 0.05)(B, S, D)),
            "wqkv": _w((lambda *s: torch.randn(*s, dtype=torch.bfloat16) * 1.6)(D, 3 * D)),
            "wo": _w((lambda *s: torch.randn(*s, dtype=torch.bfloat16) * 0.05)(D, D)),
        }
    _A_in = _A_setup()

    def _B_setup():
        B, S, D, F, C = 1, 2048, 640, 1536, 2
        return {
            "x": _w((lambda *s: torch.randn(*s, dtype=torch.bfloat16) * 0.05)(B, S, D)),
            "w_r": _w((lambda *s: torch.randn(*s, dtype=torch.bfloat16) * 3.2)(D)),
            "w_gate": _w((lambda *s: torch.randn(*s, dtype=torch.bfloat16) * 0.4)(D, F)),
            "w_up": _w((lambda *s: torch.randn(*s, dtype=torch.bfloat16) * 0.4)(D, F)),
            "w_down": _w((lambda *s: torch.randn(*s, dtype=torch.bfloat16) * 0.4)(F, D)),
        }
    _B_in = _B_setup()

    return {
        "A_x": _A_in["x"],
        "A_wqkv": _A_in["wqkv"],
        "A_wo": _A_in["wo"],
        "B_x": _B_in["x"],
        "B_w_r": _B_in["w_r"],
        "B_w_gate": _B_in["w_gate"],
        "B_w_up": _B_in["w_up"],
        "B_w_down": _B_in["w_down"],
        "gate_w": _w((lambda *s: torch.randn(*s, dtype=torch.bfloat16) * 0.05)(640) * 16.0),
    }

def reference(A_x, A_wqkv, A_wo, B_x, B_w_r, B_w_gate, B_w_up, B_w_down, gate_w):
    def _A_ref(x, wqkv, wo):
        B, S, D = x.shape
        H = 32; Dh = D // H; W = 256
        qkv = (lambda x, *d: x.permute(*d))((x @ wqkv).reshape(B, S, 3, H, Dh), 2, 0, 3, 1, 4)
        q, k, v = qkv[0], qkv[1], qkv[2]
        scores = torch.einsum("bhqd,bhkd->bhqk", q, k) * (Dh ** -0.5)
        idx = torch.arange(S)
        mask = (idx[:, None] - idx[None, :] >= 0) & (idx[:, None] - idx[None, :] < W)
        scores = torch.where(mask[None, None], scores, -1e9)
        p = _softmax(scores, axis=-1)
        o = torch.einsum("bhqk,bhkd->bhqd", p, v)
        return (lambda x, *d: x.permute(*d))(o, 0, 2, 1, 3).reshape(B, S, D) @ wo

    def _B_ref(x, w_r, w_gate, w_up, w_down):
        B, S, D = x.shape
        C = 2
        r = x @ w_r
        idx = torch.argsort(-r, axis=-1)[:, :C]
        idx_e = (lambda x, n, axis: torch.repeat_interleave(x, n, dim=axis))(idx.reshape(B, C, 1), D, axis=2)
        x_sel = (lambda x, i, axis: torch.take_along_dim(x, i, dim=axis))(x, idx_e, axis=1)
        g = _silu(x_sel @ w_gate)
        u = x_sel @ w_up
        y = (g * u) @ w_down
        r_sel = _sigmoid((lambda x, i, axis: torch.take_along_dim(x, i, dim=axis))(r, idx, axis=1))
        y = y * r_sel.reshape(B, C, 1)
        b_off = (torch.arange(B) * S).reshape(B, 1)
        flat_idx = (idx + b_off).reshape(B * C)
        zero = (x * 0.0).reshape(B * S, D)
        upd = _scatter_add(zero, flat_idx, y.reshape(B * C, D), axis=0)
        return x + upd.reshape(B, S, D)

    x = A_x
    g = _sigmoid((x * gate_w).sum(-1, keepdims=True))
    a = _A_ref(x, A_wqkv, A_wo)
    b = _B_ref(x, B_w_r, B_w_gate, B_w_up, B_w_down)
    return g * a + (1 - g) * b
```

```asm
; @launch grid=(256,1,1) block=(512,1,1) lds=163840
.amdgcn_target "amdgcn-amd-amdhsa--gfx950"
.text
.globl gated_mix__sliding_block__moe_arch_mod__prompt_kernel
.p2align 12
.p2align 8
.type gated_mix__sliding_block__moe_arch_mod__prompt_kernel,@function
gated_mix__sliding_block__moe_arch_mod__prompt_kernel:
    s_cmp_ge_u32 s2, 256
    s_cbranch_scc1 L_end
    s_load_dwordx2 s[4:5], s[0:1], 0
    s_load_dwordx2 s[8:9], s[0:1], 8
    s_load_dwordx2 s[12:13], s[0:1], 88
    s_load_dwordx2 s[16:17], s[0:1], 16
    s_getpc_b64 s[96:97]
    v_lshrrev_b32 v1, 6, v0
    v_and_b32 v0, 63, v0
    s_and_b32 s41, s2, 7
    s_lshr_b32 s42, s2, 3
    v_readfirstlane_b32 s40, v1
    s_lshl_b32 s58, s42, 3
    v_add_u32 v1, s58, v1
    v_and_b32 v2, 1, v0
    v_lshlrev_b32 v1, 7, v1
    v_lshl_add_u32 v1, v2, 15, v1
    v_min_u32 v1, L_code_end-gated_mix__sliding_block__moe_arch_mod__prompt_kernel-64, v1
    global_load_dword v200, v1, s[96:97]
    s_lshr_b32 s43, s41, 2
    s_and_b32 s44, s41, 3
    s_and_b32 s45, s42, 3
    s_lshr_b32 s46, s42, 2
    s_sub_u32 s58, s46, s43
    s_cmp_eq_u32 s58, 7
    s_cselect_b32 s58, 2, 0
    s_xor_b32 s45, s45, s58
    s_lshl_b32 s47, s44, 2
    s_add_u32 s47, s47, s45
    s_add_u32 s58, s45, s46
    s_and_b32 s58, s58, 1
    s_mov_b32 s48, 1985229328
    s_mov_b32 s49, 152
    s_cmp_eq_u32 s58, 1
    s_cselect_b32 s48, 1732584193, s48
    s_cselect_b32 s49, 137, s49
    s_lshl_b32 s59, s41, 2
    s_lshr_b32 s50, 0x20757520, s59
    s_and_b32 s50, s50, 15
    s_mov_b32 s6, 2621440
    s_mov_b32 s7, 0x20000
    s_mov_b32 s10, 2457600
    s_mov_b32 s11, 0x20000
    s_mov_b32 s14, 12648448
    s_mov_b32 s15, 0x20000
    s_cmp_ge_u32 s40, 4
    s_cbranch_scc1 L_loader
    s_cmp_lg_u32 s40, 0
    s_cbranch_scc1 L_norp
    s_mov_b32 s18, 819200
    s_mov_b32 s19, 0x20000
    v_mul_u32_u24 v40, 26, v0
    v_lshrrev_b32 v40, 8, v40
    v_mul_u32_u24 v40, 1120, v40
    v_lshl_add_u32 v40, v0, 4, v40
    s_lshl_b32 s58, s41, 2
    s_add_u32 s58, s58, s45
    s_mul_i32 s58, s58, 25600
    s_mul_i32 s59, s46, 160
    s_add_u32 s58, s58, s59
    s_mov_b32 exec_hi, 0xff
    s_waitcnt lgkmcnt(0)
    buffer_load_dwordx4 v[32:35], v40, s[16:19], s58 offen
    s_add_u32 s58, s58, 5120
    buffer_load_dwordx4 v[36:39], v40, s[16:19], s58 offen
    s_add_u32 s58, s58, 5120
    buffer_load_dwordx4 v[60:63], v40, s[16:19], s58 offen
    s_add_u32 s58, s58, 5120
    buffer_load_dwordx4 v[204:207], v40, s[16:19], s58 offen
    s_add_u32 s58, s58, 5120
    buffer_load_dwordx4 v[252:255], v40, s[16:19], s58 offen
    s_mov_b64 exec, -1
L_norp:
    v_mov_b32 v52, 0
    v_mov_b32 v53, 0
    v_mov_b32 v54, 0
    v_mov_b32 v55, 0
    s_lshl_b32 s58, s42, 2
    s_add_u32 s96, s58, s40
    s_cmp_lg_u32 s96, 113
    s_cbranch_scc1 L_noclear
    v_lshrrev_b32 v8, 1, v0
    v_lshlrev_b32 v8, 7, v8
    v_lshl_add_u32 v8, v2, 4, v8
    s_mul_i32 s58, s41, 28672
    s_add_u32 s58, s58, 11010048
    s_waitcnt lgkmcnt(0)
    buffer_store_dwordx4 v[52:55], v8, s[12:15], s58 offen sc1
    s_add_u32 s58, s58, 4096
    buffer_store_dwordx4 v[52:55], v8, s[12:15], s58 offen sc1
    s_add_u32 s58, s58, 4096
    buffer_store_dwordx4 v[52:55], v8, s[12:15], s58 offen sc1
    s_add_u32 s58, s58, 4096
    buffer_store_dwordx4 v[52:55], v8, s[12:15], s58 offen sc1
    s_add_u32 s58, s58, 4096
    buffer_store_dwordx4 v[52:55], v8, s[12:15], s58 offen sc1
    s_add_u32 s58, s58, 4096
    buffer_store_dwordx4 v[52:55], v8, s[12:15], s58 offen sc1
    s_add_u32 s58, s58, 4096
    buffer_store_dwordx4 v[52:55], v8, s[12:15], s58 offen sc1
L_noclear:
    s_branch L_compute
L_loader:
    s_sub_u32 s3, s40, 4
    v_lshrrev_b32 v3, 3, v0
    v_and_b32 v4, 7, v0
    v_lshrrev_b32 v5, 4, v0
    v_xor_b32 v6, v4, v5
    v_lshlrev_b32 v6, 4, v6
    s_lshl_b32 s58, s47, 7
    s_lshl_b32 s59, s3, 5
    s_add_u32 s58, s58, s59
    v_add_u32 v7, s58, v3
    v_mul_u32_u24 v7, 1280, v7
    v_add_u32 v10, v7, v6
    v_xor_b32 v6, 64, v6
    v_add_u32 v12, v7, v6
    v_add_u32 v11, 10240, v12
    v_add_u32 v12, 20480, v12
    v_add_u32 v13, 30720, v10
    v_and_b32 v5, 1, v5
    v_lshlrev_b32 v5, 2, v5
    v_xor_b32 v6, v4, v5
    v_lshlrev_b32 v6, 4, v6
    s_lshr_b32 s58, s3, 1
    s_lshl_b32 s59, s46, 1
    s_add_u32 s59, s59, s58
    s_mul_i32 s62, s59, 52
    s_lshr_b32 s62, s62, 8
    s_add_u32 s62, s62, s43
    s_mul_i32 s63, s62, 320
    s_lshl_b32 s60, s59, 6
    s_add_u32 s60, s60, s63
    s_lshl_b32 s60, s60, 1
    s_and_b32 s58, s3, 1
    s_mul_i32 s58, s58, 122880
    s_add_u32 s60, s60, s58
    s_cmp_lt_u32 s59, 10
    s_cselect_b32 s61, 16, 32
    v_mul_u32_u24 v7, 3840, v3
    v_add3_u32 v14, v7, v6, s60
    v_xor_b32 v6, s61, v6
    v_add3_u32 v15, v7, v6, s60
    v_add_u32 v15, 30720, v15
    v_add_u32 v16, 61440, v14
    v_add_u32 v17, 61440, v15
    s_lshl_b32 s93, s3, 12
    s_mov_b32 s90, 0
    s_cmp_eq_u32 s59, 15
    s_cbranch_scc1 L_ld_aux
    s_waitcnt lgkmcnt(0)
L_ld_xw:
    s_and_b32 s58, s48, 15
    s_lshr_b64 s[48:49], s[48:49], 4
    s_add_u32 s58, s58, s50
    s_sub_u32 s63, s58, 10
    s_min_u32 s58, s58, s63
    s_lshl_b32 s59, s58, 7
    s_mul_i32 s60, s58, 245760
    s_add_u32 s62, s90, 3
    s_and_b32 s62, s62, 3
    s_lshl_b32 s62, s62, 14
    s_add_u32 s62, s62, s93
    s_add_u32 m0, s62, 0
    s_nop 0
    buffer_load_dwordx4 v10, s[4:7], s59 offen lds
    s_add_u32 m0, s62, 1024
    s_nop 0
    buffer_load_dwordx4 v11, s[4:7], s59 offen lds
    s_add_u32 m0, s62, 2048
    s_nop 0
    buffer_load_dwordx4 v12, s[4:7], s59 offen lds
    s_add_u32 m0, s62, 3072
    s_nop 0
    buffer_load_dwordx4 v13, s[4:7], s59 offen lds
    s_add_u32 s61, s90, 2
    s_and_b32 s61, s61, 3
    s_lshl_b32 s61, s61, 14
    s_add_u32 s61, s61, s93
    s_add_u32 m0, s61, 69632
    s_nop 0
    buffer_load_dwordx4 v14, s[8:11], s60 offen lds
    s_add_u32 m0, s61, 70656
    s_nop 0
    buffer_load_dwordx4 v15, s[8:11], s60 offen lds
    s_add_u32 m0, s61, 71680
    s_nop 0
    buffer_load_dwordx4 v16, s[8:11], s60 offen lds
    s_add_u32 m0, s61, 72704
    s_nop 0
    buffer_load_dwordx4 v17, s[8:11], s60 offen lds
    s_add_u32 s90, s90, 1
    s_cmp_lt_u32 s90, 2
    s_cbranch_scc1 L_ld_xw
    s_load_dwordx2 s[16:17], s[0:1], 16
    s_load_dwordx2 s[20:21], s[0:1], 72
    s_load_dwordx2 s[24:25], s[0:1], 40
    s_load_dwordx2 s[28:29], s[0:1], 48
    s_load_dwordx2 s[32:33], s[0:1], 56
    s_load_dwordx2 s[36:37], s[0:1], 80
    s_mov_b32 s18, 819200
    s_mov_b32 s19, 0x20000
    s_mov_b32 s22, 2621440
    s_mov_b32 s23, 0x20000
    s_mov_b32 s38, 256
    s_mov_b32 s39, 0x20000
    s_and_b32 s58, s42, 1
    s_lshl_b32 s51, s44, 1
    s_add_u32 s51, s51, s58
    s_lshr_b32 s58, s42, 1
    s_lshl_b32 s52, s43, 4
    s_add_u32 s52, s52, s58
    s_and_b32 s53, s52, 1
    s_mul_i32 s58, s42, 26
    s_lshr_b32 s58, s58, 8
    s_mul_i32 s59, s58, 10
    s_sub_u32 s57, s42, s59
    s_mul_i32 s56, s41, 3
    s_add_u32 s56, s56, s58
    s_sub_u32 s91, 11, s40
    s_cmp_lt_u32 s40, 4
    s_cselect_b32 s91, s40, s91
    v_lshlrev_b32 v6, 4, v4
    s_lshl_b32 s58, s3, 4
    v_add_u32 v7, s58, v3
    v_mul_u32_u24 v8, 3072, v7
    v_add_u32 v8, v8, v6
    v_mul_u32_u24 v9, 1280, v7
    v_add_u32 v9, v9, v6
    s_mul_i32 s58, s57, 196608
    s_lshl_b32 s59, s56, 7
    s_add_u32 s58, s58, s59
    v_add_u32 v8, s58, v8
    s_mul_i32 s58, s56, 81920
    s_lshl_b32 s59, s57, 7
    s_add_u32 s58, s58, s59
    v_add_u32 v9, s58, v9
    v_add_u32 v18, 24576, v8
    v_add_u32 v19, 10240, v9
    s_lshl_b32 s101, s3, 11
    s_add_u32 s101, s101, 135168
    s_add_u32 s58, s45, s46
    s_and_b32 s58, s58, 3
    s_mul_i32 s58, s58, 2
    s_add_u32 s100, s58, 3
    s_lshr_b32 s58, s3, 1
    s_lshl_b32 s59, s46, 1
    s_add_u32 s59, s59, s58
    s_mul_i32 s62, s59, 52
    s_lshr_b32 s62, s62, 8
    s_add_u32 s62, s62, s43
    s_mul_i32 s63, s62, 320
    s_lshl_b32 s60, s59, 6
    s_add_u32 s60, s60, s63
    s_lshl_b32 s60, s60, 8
    s_mul_i32 s61, s47, 491520
    s_add_u32 s60, s60, s61
    s_and_b32 s58, s3, 1
    s_lshl_b32 s58, s58, 13
    s_add_u32 s98, s60, s58
    v_lshlrev_b32 v22, 7, v0
    s_cmp_ge_u32 s59, 5
    s_cselect_b32 s61, s45, 0
    s_cmp_ge_u32 s59, 10
    s_cselect_b32 s61, 2, s61
    s_cmp_lt_u32 s61, 2
    s_cselect_b32 s99, 1, 0
    s_waitcnt lgkmcnt(0)
L_ld_xw_w:
    s_waitcnt vmcnt(8)
    s_barrier
    s_cmp_eq_u32 s90, 10
    s_cbranch_scc1 L_ld_tail
    s_cmp_lg_u32 s90, s100
    s_cbranch_scc1 L_ld_xw_n
    s_cmp_ge_u32 s42, 30
    s_cbranch_scc1 L_ld_xw_n
    s_add_u32 m0, s101, 0
    s_nop 0
    global_load_lds_dwordx4 v8, s[24:25]
    s_add_u32 m0, s101, 1024
    s_nop 0
    global_load_lds_dwordx4 v18, s[24:25]
    s_add_u32 m0, s101, 8192
    s_nop 0
    global_load_lds_dwordx4 v8, s[28:29]
    s_add_u32 m0, s101, 9216
    s_nop 0
    global_load_lds_dwordx4 v18, s[28:29]
    s_add_u32 m0, s101, 16384
    s_nop 0
    global_load_lds_dwordx4 v9, s[32:33]
    s_add_u32 m0, s101, 17408
    s_nop 0
    global_load_lds_dwordx4 v19, s[32:33]
L_ld_xw_n:
    s_and_b32 s58, s48, 15
    s_lshr_b64 s[48:49], s[48:49], 4
    s_add_u32 s58, s58, s50
    s_sub_u32 s63, s58, 10
    s_min_u32 s58, s58, s63
    s_lshl_b32 s59, s58, 7
    s_mul_i32 s60, s58, 245760
    s_add_u32 s62, s90, 3
    s_and_b32 s62, s62, 3
    s_lshl_b32 s62, s62, 14
    s_add_u32 s62, s62, s93
    s_add_u32 m0, s62, 0
    s_nop 0
    buffer_load_dwordx4 v10, s[4:7], s59 offen lds
    s_add_u32 m0, s62, 1024
    s_nop 0
    buffer_load_dwordx4 v11, s[4:7], s59 offen lds
    s_add_u32 m0, s62, 2048
    s_nop 0
    buffer_load_dwordx4 v12, s[4:7], s59 offen lds
    s_add_u32 m0, s62, 3072
    s_nop 0
    buffer_load_dwordx4 v13, s[4:7], s59 offen lds
    s_add_u32 s61, s90, 2
    s_and_b32 s61, s61, 3
    s_lshl_b32 s61, s61, 14
    s_add_u32 s61, s61, s93
    s_add_u32 m0, s61, 69632
    s_nop 0
    buffer_load_dwordx4 v14, s[8:11], s60 offen lds
    s_add_u32 m0, s61, 70656
    s_nop 0
    buffer_load_dwordx4 v15, s[8:11], s60 offen lds
    s_add_u32 m0, s61, 71680
    s_nop 0
    buffer_load_dwordx4 v16, s[8:11], s60 offen lds
    s_add_u32 m0, s61, 72704
    s_nop 0
    buffer_load_dwordx4 v17, s[8:11], s60 offen lds
    s_add_u32 s90, s90, 1
    s_branch L_ld_xw_w
L_ld_aux:
    s_load_dwordx2 s[98:99], s[0:1], 32
    s_load_dwordx2 s[100:101], s[0:1], 64
    s_mov_b32 s58, 161024
    s_cmp_eq_u32 s3, 2
    s_cselect_b32 s58, 159744, s58
    v_lshlrev_b32 v14, 4, v0
    s_mov_b32 m0, s58
    s_waitcnt lgkmcnt(0)
    s_cselect_b64 s[98:99], s[98:99], s[100:101]
    global_load_lds_dwordx4 v14, s[98:99]
    s_mov_b64 exec, 0xffff
    global_load_lds_dwordx4 v14, s[98:99] offset:1024
    s_mov_b64 exec, -1
L_ld_x:
    s_and_b32 s58, s48, 15
    s_lshr_b64 s[48:49], s[48:49], 4
    s_add_u32 s58, s58, s50
    s_sub_u32 s63, s58, 10
    s_min_u32 s58, s58, s63
    s_lshl_b32 s59, s58, 7
    s_mul_i32 s60, s58, 245760
    s_add_u32 s62, s90, 3
    s_and_b32 s62, s62, 3
    s_lshl_b32 s62, s62, 14
    s_add_u32 s62, s62, s93
    s_add_u32 m0, s62, 0
    s_nop 0
    buffer_load_dwordx4 v10, s[4:7], s59 offen lds
    s_add_u32 m0, s62, 1024
    s_nop 0
    buffer_load_dwordx4 v11, s[4:7], s59 offen lds
    s_add_u32 m0, s62, 2048
    s_nop 0
    buffer_load_dwordx4 v12, s[4:7], s59 offen lds
    s_add_u32 m0, s62, 3072
    s_nop 0
    buffer_load_dwordx4 v13, s[4:7], s59 offen lds
    s_add_u32 s90, s90, 1
    s_cmp_lt_u32 s90, 2
    s_cbranch_scc1 L_ld_x
    s_load_dwordx2 s[16:17], s[0:1], 16
    s_load_dwordx2 s[20:21], s[0:1], 72
    s_load_dwordx2 s[24:25], s[0:1], 40
    s_load_dwordx2 s[28:29], s[0:1], 48
    s_load_dwordx2 s[32:33], s[0:1], 56
    s_load_dwordx2 s[36:37], s[0:1], 80
    s_mov_b32 s18, 819200
    s_mov_b32 s19, 0x20000
    s_mov_b32 s22, 2621440
    s_mov_b32 s23, 0x20000
    s_mov_b32 s38, 256
    s_mov_b32 s39, 0x20000
    s_and_b32 s58, s42, 1
    s_lshl_b32 s51, s44, 1
    s_add_u32 s51, s51, s58
    s_lshr_b32 s58, s42, 1
    s_lshl_b32 s52, s43, 4
    s_add_u32 s52, s52, s58
    s_and_b32 s53, s52, 1
    s_mul_i32 s58, s42, 26
    s_lshr_b32 s58, s58, 8
    s_mul_i32 s59, s58, 10
    s_sub_u32 s57, s42, s59
    s_mul_i32 s56, s41, 3
    s_add_u32 s56, s56, s58
    s_sub_u32 s91, 11, s40
    s_cmp_lt_u32 s40, 4
    s_cselect_b32 s91, s40, s91
    v_lshlrev_b32 v6, 4, v4
    s_lshl_b32 s58, s3, 4
    v_add_u32 v7, s58, v3
    v_mul_u32_u24 v8, 3072, v7
    v_add_u32 v8, v8, v6
    v_mul_u32_u24 v9, 1280, v7
    v_add_u32 v9, v9, v6
    s_mul_i32 s58, s57, 196608
    s_lshl_b32 s59, s56, 7
    s_add_u32 s58, s58, s59
    v_add_u32 v8, s58, v8
    s_mul_i32 s58, s56, 81920
    s_lshl_b32 s59, s57, 7
    s_add_u32 s58, s58, s59
    v_add_u32 v9, s58, v9
    v_add_u32 v18, 24576, v8
    v_add_u32 v19, 10240, v9
    s_lshl_b32 s101, s3, 11
    s_add_u32 s101, s101, 135168
    s_add_u32 s58, s45, s46
    s_and_b32 s58, s58, 3
    s_mul_i32 s58, s58, 2
    s_add_u32 s100, s58, 3
    s_lshr_b32 s58, s3, 1
    s_lshl_b32 s59, s46, 1
    s_add_u32 s59, s59, s58
    s_mul_i32 s62, s59, 52
    s_lshr_b32 s62, s62, 8
    s_add_u32 s62, s62, s43
    s_mul_i32 s63, s62, 320
    s_lshl_b32 s60, s59, 6
    s_add_u32 s60, s60, s63
    s_lshl_b32 s60, s60, 8
    s_mul_i32 s61, s47, 491520
    s_add_u32 s60, s60, s61
    s_and_b32 s58, s3, 1
    s_lshl_b32 s58, s58, 13
    s_add_u32 s98, s60, s58
    v_lshlrev_b32 v22, 7, v0
    s_cmp_ge_u32 s59, 5
    s_cselect_b32 s61, s45, 0
    s_cmp_ge_u32 s59, 10
    s_cselect_b32 s61, 2, s61
    s_cmp_lt_u32 s61, 2
    s_cselect_b32 s99, 1, 0
    s_waitcnt lgkmcnt(0)
L_ld_x_w:
    s_waitcnt vmcnt(4)
    s_barrier
    s_cmp_eq_u32 s90, 10
    s_cbranch_scc1 L_ld_tail
    s_cmp_lg_u32 s90, s100
    s_cbranch_scc1 L_ld_x_n
    s_cmp_ge_u32 s42, 30
    s_cbranch_scc1 L_ld_x_n
    s_add_u32 m0, s101, 0
    s_nop 0
    global_load_lds_dwordx4 v8, s[24:25]
    s_add_u32 m0, s101, 1024
    s_nop 0
    global_load_lds_dwordx4 v18, s[24:25]
    s_add_u32 m0, s101, 8192
    s_nop 0
    global_load_lds_dwordx4 v8, s[28:29]
    s_add_u32 m0, s101, 9216
    s_nop 0
    global_load_lds_dwordx4 v18, s[28:29]
    s_add_u32 m0, s101, 16384
    s_nop 0
    global_load_lds_dwordx4 v9, s[32:33]
    s_add_u32 m0, s101, 17408
    s_nop 0
    global_load_lds_dwordx4 v19, s[32:33]
L_ld_x_n:
    s_and_b32 s58, s48, 15
    s_lshr_b64 s[48:49], s[48:49], 4
    s_add_u32 s58, s58, s50
    s_sub_u32 s63, s58, 10
    s_min_u32 s58, s58, s63
    s_lshl_b32 s59, s58, 7
    s_mul_i32 s60, s58, 245760
    s_add_u32 s62, s90, 3
    s_and_b32 s62, s62, 3
    s_lshl_b32 s62, s62, 14
    s_add_u32 s62, s62, s93
    s_add_u32 m0, s62, 0
    s_nop 0
    buffer_load_dwordx4 v10, s[4:7], s59 offen lds
    s_add_u32 m0, s62, 1024
    s_nop 0
    buffer_load_dwordx4 v11, s[4:7], s59 offen lds
    s_add_u32 m0, s62, 2048
    s_nop 0
    buffer_load_dwordx4 v12, s[4:7], s59 offen lds
    s_add_u32 m0, s62, 3072
    s_nop 0
    buffer_load_dwordx4 v13, s[4:7], s59 offen lds
    s_add_u32 s90, s90, 1
    s_branch L_ld_x_w
L_ld_tail:
    s_cmp_lg_u32 s3, 1
    s_cbranch_scc1 L_ld_nw
    s_lshl_b32 s58, s46, 12
    s_add_u32 s58, s58, 11206656
    s_mov_b32 exec_hi, 0
    buffer_load_dword v126, v22, s[12:15], s58 offen sc1
    s_mov_b64 exec, -1
    s_add_u32 s99, s99, 2
L_ld_nw:
    s_bitcmp0_b32 s99, 0
    s_cbranch_scc1 L_pt_none
    buffer_load_dword v201, v22, s[12:15], s98 offen sc1
L_pt_none:
    s_waitcnt vmcnt(2)
    s_cmp_eq_u32 s99, 3
    s_cbranch_scc1 L_ld_b9
    s_waitcnt vmcnt(1)
    s_cmp_lg_u32 s99, 0
    s_cbranch_scc1 L_ld_b9
    s_waitcnt vmcnt(0)
L_ld_b9:
    s_barrier
    s_branch L_att
L_compute:
    s_and_b32 s3, s40, 1
    s_lshr_b32 s93, s40, 1
    v_and_b32 v10, 15, v0
    v_lshrrev_b32 v11, 4, v0
    v_bfe_u32 v12, v0, 1, 3
    v_xor_b32 v12, v12, v11
    v_lshlrev_b32 v12, 4, v12
    v_bfe_u32 v13, v0, 2, 2
    v_lshl_add_u32 v13, v11, 3, v13
    v_lshlrev_b32 v13, 7, v13
    v_bfe_u32 v14, v0, 3, 1
    v_lshl_add_u32 v13, v14, 6, v13
    v_and_b32 v14, 1, v0
    v_lshl_add_u32 v13, v14, 3, v13
    s_and_b32 s58, s42, 1
    s_lshl_b32 s51, s44, 1
    s_add_u32 s51, s51, s58
    s_lshr_b32 s58, s42, 1
    s_lshl_b32 s52, s43, 4
    s_add_u32 s52, s52, s58
    s_and_b32 s53, s52, 1
    s_mul_i32 s58, s42, 26
    s_lshr_b32 s58, s58, 8
    s_mul_i32 s59, s58, 10
    s_sub_u32 s57, s42, s59
    s_mul_i32 s56, s41, 3
    s_add_u32 s56, s56, s58
    s_sub_u32 s91, 11, s40
    s_cmp_lt_u32 s40, 4
    s_cselect_b32 s91, s40, s91
    s_waitcnt lgkmcnt(0)
    v_lshlrev_b32 v50, 15, v0
    v_and_b32 v49, 7, v0
    v_lshlrev_b32 v49, 2, v49
    s_lshl_b32 s100, s41, 7
    s_add_u32 s100, s100, 11190272
    s_getreg_b32 s101, hwreg(HW_REG_XCC_ID, 0, 4)
    s_add_u32 s101, s101, 1
    v_mov_b32 v51, s101
    s_cmp_lg_u32 s40, 1
    s_cbranch_scc1 L_noclr
    v_mov_b32 v8, 162816
    ds_write_b128 v8, v[52:55]
    s_waitcnt lgkmcnt(0)
L_noclr:
    s_load_dwordx2 s[16:17], s[0:1], 16
    s_load_dwordx2 s[20:21], s[0:1], 72
    s_load_dwordx2 s[24:25], s[0:1], 40
    s_load_dwordx2 s[28:29], s[0:1], 48
    s_load_dwordx2 s[32:33], s[0:1], 56
    s_load_dwordx2 s[36:37], s[0:1], 80
    s_mov_b32 s18, 819200
    s_mov_b32 s19, 0x20000
    s_mov_b32 s22, 2621440
    s_mov_b32 s23, 0x20000
    s_mov_b32 s38, 256
    s_mov_b32 s39, 0x20000
    s_and_b32 s58, s52, 15
    s_mul_i32 s58, s58, 20
    v_bfe_u32 v40, v0, 1, 1
    v_mad_u32_u24 v40, v40, 19, s58
    v_lshrrev_b32 v40, 6, v40
    v_bfe_u32 v43, v0, 2, 2
    v_min_u32 v43, 2, v43
    v_mad_u32_u24 v40, v43, 5, v40
    v_lshrrev_b32 v40, 1, v40
    v_and_b32 v43, 1, v0
    v_lshl_add_u32 v40, v40, 2, v43
    v_lshlrev_b32 v245, 10, v40
    s_and_b32 s58, s51, 1
    s_lshl_b32 s58, s58, 4
    s_add_u32 s58, s58, s41
    s_lshl_b32 s58, s58, 7
    s_add_u32 s35, s58, 11010048
    v_and_b32 v41, 31, v0
    v_lshrrev_b32 v42, 5, v0
    s_mul_i32 s60, s51, 983040
    s_mul_i32 s8, s52, 5
    s_add_u32 s8, s8, s53
    s_lshl_b32 s8, s8, 10
    s_add_u32 s8, s8, s60
    s_lshr_b32 s58, s52, 1
    s_mul_i32 s9, s58, 10240
    s_add_u32 s9, s9, s60
    s_add_u32 s9, s9, 4096
    s_xor_b32 s10, s58, s53
    s_and_b32 s10, s10, 1
    s_lshl_b32 s10, s10, 3
    s_mul_i32 s11, s52, 5120
    s_add_u32 s11, s11, s60
    s_add_u32 s11, s11, 327680
    s_lshl_b32 s58, s91, 9
    s_add_u32 s58, s58, 118784
    v_lshlrev_b32 v40, 4, v41
    s_lshl_b32 s59, s91, 10
    s_add_u32 s59, s59, 118784
    v_lshl_add_u32 v240, v0, 4, s59
    s_add_u32 s58, s58, s10
    s_add_u32 s58, s58, 16384
    v_add_u32 v241, s58, v40
    s_mul_i32 s58, s91, 1280
    s_add_u32 s58, s58, 143360
    v_mul_u32_u24 v43, 320, v42
    v_add3_u32 v242, v40, v43, s58
    s_lshr_b32 s58, s91, 2
    s_mul_i32 s58, s58, 489472
    s_lshl_b32 s59, s91, 9
    s_add_u32 s58, s58, s59
    v_lshl_add_u32 v244, v42, 11, v40
    v_add_u32 v244, s58, v244
    v_lshlrev_b32 v243, 4, v0
    v_lshlrev_b32 v40, 2, v42
    v_sub_u32 v40, v41, v40
    v_mov_b32 v43, 0xff800000
    v_mov_b32 v44, 0
    v_cmp_gt_i32 vcc, 0, v40
    v_cmp_gt_i32 s[58:59], 1, v40
    s_nop 0
    v_cndmask_b32 v208, v44, v43, vcc
    v_cndmask_b32 v224, v43, v44, vcc
    v_cndmask_b32 v209, v44, v43, s[58:59]
    v_cndmask_b32 v225, v43, v44, s[58:59]
    v_cmp_gt_i32 vcc, 2, v40
    v_cmp_gt_i32 s[58:59], 3, v40
    s_nop 0
    v_cndmask_b32 v210, v44, v43, vcc
    v_cndmask_b32 v226, v43, v44, vcc
    v_cndmask_b32 v211, v44, v43, s[58:59]
    v_cndmask_b32 v227, v43, v44, s[58:59]
    v_cmp_gt_i32 vcc, 8, v40
    v_cmp_gt_i32 s[58:59], 9, v40
    s_nop 0
    v_cndmask_b32 v212, v44, v43, vcc
    v_cndmask_b32 v228, v43, v44, vcc
    v_cndmask_b32 v213, v44, v43, s[58:59]
    v_cndmask_b32 v229, v43, v44, s[58:59]
    v_cmp_gt_i32 vcc, 10, v40
    v_cmp_gt_i32 s[58:59], 11, v40
    s_nop 0
    v_cndmask_b32 v214, v44, v43, vcc
    v_cndmask_b32 v230, v43, v44, vcc
    v_cndmask_b32 v215, v44, v43, s[58:59]
    v_cndmask_b32 v231, v43, v44, s[58:59]
    v_cmp_gt_i32 vcc, 16, v40
    v_cmp_gt_i32 s[58:59], 17, v40
    s_nop 0
    v_cndmask_b32 v216, v44, v43, vcc
    v_cndmask_b32 v232, v43, v44, vcc
    v_cndmask_b32 v217, v44, v43, s[58:59]
    v_cndmask_b32 v233, v43, v44, s[58:59]
    v_cmp_gt_i32 vcc, 18, v40
    v_cmp_gt_i32 s[58:59], 19, v40
    s_nop 0
    v_cndmask_b32 v218, v44, v43, vcc
    v_cndmask_b32 v234, v43, v44, vcc
    v_cndmask_b32 v219, v44, v43, s[58:59]
    v_cndmask_b32 v235, v43, v44, s[58:59]
    v_cmp_gt_i32 vcc, 24, v40
    v_cmp_gt_i32 s[58:59], 25, v40
    s_nop 0
    v_cndmask_b32 v220, v44, v43, vcc
    v_cndmask_b32 v236, v43, v44, vcc
    v_cndmask_b32 v221, v44, v43, s[58:59]
    v_cndmask_b32 v237, v43, v44, s[58:59]
    v_cmp_gt_i32 vcc, 26, v40
    v_cmp_gt_i32 s[58:59], 27, v40
    s_nop 0
    v_cndmask_b32 v222, v44, v43, vcc
    v_cndmask_b32 v238, v43, v44, vcc
    v_cndmask_b32 v223, v44, v43, s[58:59]
    v_cndmask_b32 v239, v43, v44, s[58:59]
    v_mov_b32 v22, 0
    v_mov_b32 v23, 0
    v_cmp_gt_u32 vcc, 32, v0
    v_cmp_gt_u32 s[58:59], 20, v41
    v_mov_b32 v43, 1040
    v_and_b32 v44, 27, v41
    v_xor_b32 v44, 24, v44
    v_min_u32 v44, 1, v44
    v_lshlrev_b32 v44, 5, v44
    v_add_u32 v44, 1024, v44
    v_cndmask_b32 v241, v43, v241, vcc
    v_cndmask_b32 v242, v44, v242, s[58:59]
    s_sub_u32 s34, 8, s91
    s_cmp_eq_u32 s51, 0
    s_cselect_b32 s31, s34, 0
    s_cselect_b32 s34, 15, s34
    s_add_u32 s58, s41, 15
    s_lshl_b32 s58, s58, 7
    s_add_u32 s58, s58, 11108352
    s_lshl_b32 s59, s41, 7
    s_add_u32 s59, s59, 11010048
    s_bitcmp1_b32 s51, 0
    s_cselect_b32 s58, s59, s58
    s_cmp_eq_u32 s34, 8
    s_cselect_b32 s30, s58, 0
    s_lshl_b32 s58, s41, 11
    s_add_u32 s58, s58, 11173888
    s_cmp_eq_u32 s40, 4
    s_cselect_b32 s30, s58, s30
    s_lshl_b32 s58, s46, 12
    s_add_u32 s58, s58, 11206656
    s_cmp_eq_u32 s40, 5
    s_cselect_b32 s30, s58, s30
    s_cmp_lt_u32 s42, 30
    s_cselect_b32 s53, s40, 0
    s_lshl_b32 s58, s44, 1
    s_add_u32 s58, s58, s43
    s_lshl_b32 s58, s58, 2
    s_add_u32 s58, s58, s45
    s_lshl_b32 s58, s58, 2
    s_and_b32 s59, s40, 3
    s_add_u32 s58, s58, s59
    s_lshl_b32 s58, s58, 4
    v_and_b32 v40, 15, v0
    v_add_u32 v246, s58, v40
    v_lshlrev_b32 v248, 2, v246
    v_add_u32 v248, 10485760, v248
    s_add_u32 s86, s8, 163840
    s_lshr_b32 s58, s91, 2
    s_mul_i32 s58, s58, 486400
    s_mul_i32 s59, s91, 1280
    s_add_u32 s58, s58, s59
    s_add_u32 s87, s58, s11
    s_lshl_b32 s58, s91, 10
    s_add_u32 m0, s58, 126976
    s_cmp_lg_u32 s53, 2
    s_cbranch_scc1 L_nosent
    v_mul_u32_u24 v41, 61184, v11
    v_add_u32 v41, v41, v243
    v_mov_b32 v52, -1
    v_mov_b32 v53, -1
    v_mov_b32 v54, -1
    v_mov_b32 v55, -1
    s_mul_i32 s58, s56, 2560
    s_lshl_b32 s59, s57, 8
    s_add_u32 s58, s58, s59
    s_add_u32 s58, s58, 10878976
    s_mov_b32 exec_hi, 0
    buffer_store_dwordx4 v[52:55], v41, s[12:15], s58 offen sc1
    s_mov_b64 exec, -1
L_nosent:
    s_lshl_b32 s58, s41, 2
    s_add_u32 s58, s58, s45
    s_mul_i32 s58, s58, 3200
    s_mul_i32 s59, s46, 102400
    s_add_u32 s58, s58, s59
    s_add_u32 s88, s58, 11796480
    s_lshl_b32 s59, s46, 1
    s_cmp_eq_u32 s46, 7
    s_cselect_b32 s93, 0, s93
    s_add_u32 s59, s59, s93
    s_lshl_b32 s58, s93, 13
    s_add_u32 s58, s58, 69632
    v_add_u32 v13, s58, v13
    s_mul_i32 s62, s59, 52
    s_lshr_b32 s62, s62, 8
    s_add_u32 s62, s62, s43
    s_mul_i32 s63, s62, 320
    s_lshl_b32 s60, s59, 6
    s_add_u32 s60, s60, s63
    s_cmp_ge_u32 s59, 5
    s_cselect_b32 s61, s45, 0
    s_cmp_ge_u32 s59, 10
    s_cselect_b32 s61, 2, s61
    s_cmp_lt_u32 s61, 2
    s_cselect_b32 s97, 1, 0
    s_cmp_ge_u32 s59, 10
    s_cbranch_scc1 L_gemm_v
    v_lshl_add_u32 v2, v10, 7, v12
    s_lshl_b32 s58, s3, 13
    v_add_u32 v2, s58, v2
    v_xor_b32 v3, 64, v2
    v_and_b32 v14, 3, v0
    v_and_b32 v15, 1, v11
    v_xor_b32 v14, v14, v15
    v_lshl_add_u32 v4, v14, 4, v13
    v_xor_b32 v5, 8, v4
    v_xor_b32 v6, 64, v4
    v_xor_b32 v7, 64, v5
    v_lshlrev_b32 v8, 11, v11
    v_lshl_add_u32 v8, v10, 4, v8
    s_lshl_b32 s98, s60, 8
    s_mul_i32 s61, s47, 491520
    s_add_u32 s98, s98, s61
    s_lshl_b32 s61, s3, 10
    s_add_u32 s98, s98, s61
    s_cmp_lt_u32 s59, 5
    s_cselect_b32 s99, 1051011932, 1.0
    s_add_u32 s89, s98, 8192
    s_barrier
    ds_read_b128 v[128:131], v2 offset:49152
    ds_read_b64_tr_b16 v[144:145], v4 offset:32768
    ds_read_b64_tr_b16 v[146:147], v4 offset:33280
    ds_read_b128 v[132:135], v3 offset:51200
    ds_read_b64_tr_b16 v[148:149], v5 offset:32768
    ds_read_b64_tr_b16 v[150:151], v5 offset:33280
    ds_read_b128 v[136:139], v2 offset:53248
    ds_read_b64_tr_b16 v[152:153], v6 offset:32768
    ds_read_b64_tr_b16 v[154:155], v6 offset:33280
    ds_read_b128 v[140:143], v3 offset:55296
    ds_read_b64_tr_b16 v[156:157], v7 offset:32768
    ds_read_b64_tr_b16 v[158:159], v7 offset:33280
    s_waitcnt lgkmcnt(0)
    v_mfma_f32_16x16x32_bf16 v[64:67], v[144:147], v[128:131], 0
    ds_read_b128 v[164:167], v3 offset:49152
    v_mfma_f32_16x16x32_bf16 v[68:71], v[148:151], v[128:131], 0
    ds_read_b64_tr_b16 v[180:181], v4 offset:36864
    v_mfma_f32_16x16x32_bf16 v[72:75], v[152:155], v[128:131], 0
    ds_read_b64_tr_b16 v[182:183], v4 offset:37376
    v_mfma_f32_16x16x32_bf16 v[76:79], v[156:159], v[128:131], 0
    ds_read_b128 v[168:171], v2 offset:51200
    v_mfma_f32_16x16x32_bf16 v[92:95], v[156:159], v[132:135], 0
    ds_read_b64_tr_b16 v[184:185], v5 offset:36864
    v_mfma_f32_16x16x32_bf16 v[88:91], v[152:155], v[132:135], 0
    ds_read_b64_tr_b16 v[186:187], v5 offset:37376
    v_mfma_f32_16x16x32_bf16 v[84:87], v[148:151], v[132:135], 0
    ds_read_b128 v[172:175], v3 offset:53248
    v_mfma_f32_16x16x32_bf16 v[80:83], v[144:147], v[132:135], 0
    ds_read_b64_tr_b16 v[188:189], v6 offset:36864
    v_mfma_f32_16x16x32_bf16 v[96:99], v[144:147], v[136:139], 0
    ds_read_b64_tr_b16 v[190:191], v6 offset:37376
    v_mfma_f32_16x16x32_bf16 v[100:103], v[148:151], v[136:139], 0
    ds_read_b128 v[176:179], v2 offset:55296
    v_mfma_f32_16x16x32_bf16 v[104:107], v[152:155], v[136:139], 0
    ds_read_b64_tr_b16 v[192:193], v7 offset:36864
    v_mfma_f32_16x16x32_bf16 v[108:111], v[156:159], v[136:139], 0
    ds_read_b64_tr_b16 v[194:195], v7 offset:37376
    v_mfma_f32_16x16x32_bf16 v[124:127], v[156:159], v[140:143], 0
    v_mfma_f32_16x16x32_bf16 v[120:123], v[152:155], v[140:143], 0
    v_mfma_f32_16x16x32_bf16 v[116:119], v[148:151], v[140:143], 0
    v_mfma_f32_16x16x32_bf16 v[112:115], v[144:147], v[140:143], 0
    s_waitcnt lgkmcnt(0)
    v_mfma_f32_16x16x32_bf16 v[64:67], v[180:183], v[164:167], v[64:67]
    v_mfma_f32_16x16x32_bf16 v[68:71], v[184:187], v[164:167], v[68:71]
    v_mfma_f32_16x16x32_bf16 v[72:75], v[188:191], v[164:167], v[72:75]
    v_mfma_f32_16x16x32_bf16 v[76:79], v[192:195], v[164:167], v[76:79]
    v_mfma_f32_16x16x32_bf16 v[92:95], v[192:195], v[168:171], v[92:95]
    v_mfma_f32_16x16x32_bf16 v[88:91], v[188:191], v[168:171], v[88:91]
    v_mfma_f32_16x16x32_bf16 v[84:87], v[184:187], v[168:171], v[84:87]
    v_mfma_f32_16x16x32_bf16 v[80:83], v[180:183], v[168:171], v[80:83]
    s_waitcnt vmcnt(0)
    s_barrier
    v_mfma_f32_16x16x32_bf16 v[96:99], v[180:183], v[172:175], v[96:99]
    ds_read_b128 v[128:131], v2 offset:0
    ds_read_b64_tr_b16 v[144:145], v4 offset:49152
    v_mfma_f32_16x16x32_bf16 v[100:103], v[184:187], v[172:175], v[100:103]
    ds_read_b64_tr_b16 v[146:147], v4 offset:49664
    ds_read_b128 v[132:135], v3 offset:2048
    v_mfma_f32_16x16x32_bf16 v[104:107], v[188:191], v[172:175], v[104:107]
    ds_read_b64_tr_b16 v[148:149], v5 offset:49152
    ds_read_b64_tr_b16 v[150:151], v5 offset:49664
    v_mfma_f32_16x16x32_bf16 v[108:111], v[192:195], v[172:175], v[108:111]
    ds_read_b128 v[136:139], v2 offset:4096
    ds_read_b64_tr_b16 v[152:153], v6 offset:49152
    v_mfma_f32_16x16x32_bf16 v[124:127], v[192:195], v[176:179], v[124:127]
    ds_read_b64_tr_b16 v[154:155], v6 offset:49664
    ds_read_b128 v[140:143], v3 offset:6144
    v_mfma_f32_16x16x32_bf16 v[120:123], v[188:191], v[176:179], v[120:123]
    ds_read_b64_tr_b16 v[156:157], v7 offset:49152
    ds_read_b64_tr_b16 v[158:159], v7 offset:49664
    v_mfma_f32_16x16x32_bf16 v[116:119], v[184:187], v[176:179], v[116:119]
    v_mfma_f32_16x16x32_bf16 v[112:115], v[180:183], v[176:179], v[112:115]
    s_waitcnt lgkmcnt(0)
    s_cmp_lg_u32 s40, 0
    s_cbranch_scc1 L_side_1
    s_mov_b32 exec_hi, 0xff
    buffer_store_dwordx4 v[32:35], v243, s[12:15], s88 offen offset:0 sc1
    buffer_store_dwordx4 v[36:39], v243, s[12:15], s88 offen offset:640 sc1
    s_mov_b64 exec, -1
L_side_1:
    v_mfma_f32_16x16x32_bf16 v[64:67], v[144:147], v[128:131], v[64:67]
    ds_read_b128 v[164:167], v3 offset:0
    v_mfma_f32_16x16x32_bf16 v[68:71], v[148:151], v[128:131], v[68:71]
    ds_read_b64_tr_b16 v[180:181], v4 offset:53248
    v_mfma_f32_16x16x32_bf16 v[72:75], v[152:155], v[128:131], v[72:75]
    ds_read_b64_tr_b16 v[182:183], v4 offset:53760
    v_mfma_f32_16x16x32_bf16 v[76:79], v[156:159], v[128:131], v[76:79]
    ds_read_b128 v[168:171], v2 offset:2048
    v_mfma_f32_16x16x32_bf16 v[92:95], v[156:159], v[132:135], v[92:95]
    ds_read_b64_tr_b16 v[184:185], v5 offset:53248
    v_mfma_f32_16x16x32_bf16 v[88:91], v[152:155], v[132:135], v[88:91]
    ds_read_b64_tr_b16 v[186:187], v5 offset:53760
    v_mfma_f32_16x16x32_bf16 v[84:87], v[148:151], v[132:135], v[84:87]
    ds_read_b128 v[172:175], v3 offset:4096
    v_mfma_f32_16x16x32_bf16 v[80:83], v[144:147], v[132:135], v[80:83]
    ds_read_b64_tr_b16 v[188:189], v6 offset:53248
    v_mfma_f32_16x16x32_bf16 v[96:99], v[144:147], v[136:139], v[96:99]
    ds_read_b64_tr_b16 v[190:191], v6 offset:53760
    v_mfma_f32_16x16x32_bf16 v[100:103], v[148:151], v[136:139], v[100:103]
    ds_read_b128 v[176:179], v2 offset:6144
    v_mfma_f32_16x16x32_bf16 v[104:107], v[152:155], v[136:139], v[104:107]
    ds_read_b64_tr_b16 v[192:193], v7 offset:53248
    v_mfma_f32_16x16x32_bf16 v[108:111], v[156:159], v[136:139], v[108:111]
    ds_read_b64_tr_b16 v[194:195], v7 offset:53760
    v_mfma_f32_16x16x32_bf16 v[124:127], v[156:159], v[140:143], v[124:127]
    v_mfma_f32_16x16x32_bf16 v[120:123], v[152:155], v[140:143], v[120:123]
    v_mfma_f32_16x16x32_bf16 v[116:119], v[148:151], v[140:143], v[116:119]
    v_mfma_f32_16x16x32_bf16 v[112:115], v[144:147], v[140:143], v[112:115]
    s_waitcnt lgkmcnt(0)
    v_mfma_f32_16x16x32_bf16 v[64:67], v[180:183], v[164:167], v[64:67]
    v_mfma_f32_16x16x32_bf16 v[68:71], v[184:187], v[164:167], v[68:71]
    v_mfma_f32_16x16x32_bf16 v[72:75], v[188:191], v[164:167], v[72:75]
    v_mfma_f32_16x16x32_bf16 v[76:79], v[192:195], v[164:167], v[76:79]
    v_mfma_f32_16x16x32_bf16 v[92:95], v[192:195], v[168:171], v[92:95]
    v_mfma_f32_16x16x32_bf16 v[88:91], v[188:191], v[168:171], v[88:91]
    v_mfma_f32_16x16x32_bf16 v[84:87], v[184:187], v[168:171], v[84:87]
    v_mfma_f32_16x16x32_bf16 v[80:83], v[180:183], v[168:171], v[80:83]
    s_cmp_lg_u32 s40, 0
    s_cbranch_scc1 L_side_2
    s_mov_b32 exec_hi, 0xff
    buffer_store_dwordx4 v[60:63], v243, s[12:15], s88 offen offset:1280 sc1
    buffer_store_dwordx4 v[204:207], v243, s[12:15], s88 offen offset:1920 sc1
    s_mov_b64 exec, -1
L_side_2:
    s_barrier
    v_mfma_f32_16x16x32_bf16 v[96:99], v[180:183], v[172:175], v[96:99]
    ds_read_b128 v[128:131], v2 offset:16384
    ds_read_b64_tr_b16 v[144:145], v4 offset:0
    v_mfma_f32_16x16x32_bf16 v[100:103], v[184:187], v[172:175], v[100:103]
    ds_read_b64_tr_b16 v[146:147], v4 offset:512
    ds_read_b128 v[132:135], v3 offset:18432
    v_mfma_f32_16x16x32_bf16 v[104:107], v[188:191], v[172:175], v[104:107]
    ds_read_b64_tr_b16 v[148:149], v5 offset:0
    ds_read_b64_tr_b16 v[150:151], v5 offset:512
    v_mfma_f32_16x16x32_bf16 v[108:111], v[192:195], v[172:175], v[108:111]
    ds_read_b128 v[136:139], v2 offset:20480
    ds_read_b64_tr_b16 v[152:153], v6 offset:0
    v_mfma_f32_16x16x32_bf16 v[124:127], v[192:195], v[176:179], v[124:127]
    ds_read_b64_tr_b16 v[154:155], v6 offset:512
    ds_read_b128 v[140:143], v3 offset:22528
    v_mfma_f32_16x16x32_bf16 v[120:123], v[188:191], v[176:179], v[120:123]
    ds_read_b64_tr_b16 v[156:157], v7 offset:0
    ds_read_b64_tr_b16 v[158:159], v7 offset:512
    v_mfma_f32_16x16x32_bf16 v[116:119], v[184:187], v[176:179], v[116:119]
    v_mfma_f32_16x16x32_bf16 v[112:115], v[180:183], v[176:179], v[112:115]
    s_waitcnt lgkmcnt(0)
    s_cmp_lg_u32 s40, 0
    s_cbranch_scc1 L_side_3
    s_mov_b32 exec_hi, 0xff
    buffer_store_dwordx4 v[252:255], v243, s[12:15], s88 offen offset:2560 sc1
    s_mov_b64 exec, -1
L_side_3:
    v_mfma_f32_16x16x32_bf16 v[64:67], v[144:147], v[128:131], v[64:67]
    ds_read_b128 v[164:167], v3 offset:16384
    v_mfma_f32_16x16x32_bf16 v[68:71], v[148:151], v[128:131], v[68:71]
    ds_read_b64_tr_b16 v[180:181], v4 offset:4096
    v_mfma_f32_16x16x32_bf16 v[72:75], v[152:155], v[128:131], v[72:75]
    ds_read_b64_tr_b16 v[182:183], v4 offset:4608
    v_mfma_f32_16x16x32_bf16 v[76:79], v[156:159], v[128:131], v[76:79]
    ds_read_b128 v[168:171], v2 offset:18432
    v_mfma_f32_16x16x32_bf16 v[92:95], v[156:159], v[132:135], v[92:95]
    ds_read_b64_tr_b16 v[184:185], v5 offset:4096
    v_mfma_f32_16x16x32_bf16 v[88:91], v[152:155], v[132:135], v[88:91]
    ds_read_b64_tr_b16 v[186:187], v5 offset:4608
    v_mfma_f32_16x16x32_bf16 v[84:87], v[148:151], v[132:135], v[84:87]
    ds_read_b128 v[172:175], v3 offset:20480
    v_mfma_f32_16x16x32_bf16 v[80:83], v[144:147], v[132:135], v[80:83]
    ds_read_b64_tr_b16 v[188:189], v6 offset:4096
    v_mfma_f32_16x16x32_bf16 v[96:99], v[144:147], v[136:139], v[96:99]
    ds_read_b64_tr_b16 v[190:191], v6 offset:4608
    v_mfma_f32_16x16x32_bf16 v[100:103], v[148:151], v[136:139], v[100:103]
    ds_read_b128 v[176:179], v2 offset:22528
    v_mfma_f32_16x16x32_bf16 v[104:107], v[152:155], v[136:139], v[104:107]
    ds_read_b64_tr_b16 v[192:193], v7 offset:4096
    v_mfma_f32_16x16x32_bf16 v[108:111], v[156:159], v[136:139], v[108:111]
    ds_read_b64_tr_b16 v[194:195], v7 offset:4608
    v_mfma_f32_16x16x32_bf16 v[124:127], v[156:159], v[140:143], v[124:127]
    v_mfma_f32_16x16x32_bf16 v[120:123], v[152:155], v[140:143], v[120:123]
    v_mfma_f32_16x16x32_bf16 v[116:119], v[148:151], v[140:143], v[116:119]
    v_mfma_f32_16x16x32_bf16 v[112:115], v[144:147], v[140:143], v[112:115]
    s_waitcnt lgkmcnt(0)
    v_mfma_f32_16x16x32_bf16 v[64:67], v[180:183], v[164:167], v[64:67]
    v_mfma_f32_16x16x32_bf16 v[68:71], v[184:187], v[164:167], v[68:71]
    v_mfma_f32_16x16x32_bf16 v[72:75], v[188:191], v[164:167], v[72:75]
    v_mfma_f32_16x16x32_bf16 v[76:79], v[192:195], v[164:167], v[76:79]
    v_mfma_f32_16x16x32_bf16 v[92:95], v[192:195], v[168:171], v[92:95]
    v_mfma_f32_16x16x32_bf16 v[88:91], v[188:191], v[168:171], v[88:91]
    v_mfma_f32_16x16x32_bf16 v[84:87], v[184:187], v[168:171], v[84:87]
    v_mfma_f32_16x16x32_bf16 v[80:83], v[180:183], v[168:171], v[80:83]
    s_barrier
    v_mfma_f32_16x16x32_bf16 v[96:99], v[180:183], v[172:175], v[96:99]
    ds_read_b128 v[128:131], v2 offset:32768
    ds_read_b64_tr_b16 v[144:145], v4 offset:16384
    v_mfma_f32_16x16x32_bf16 v[100:103], v[184:187], v[172:175], v[100:103]
    ds_read_b64_tr_b16 v[146:147], v4 offset:16896
    ds_read_b128 v[132:135], v3 offset:34816
    v_mfma_f32_16x16x32_bf16 v[104:107], v[188:191], v[172:175], v[104:107]
    ds_read_b64_tr_b16 v[148:149], v5 offset:16384
    ds_read_b64_tr_b16 v[150:151], v5 offset:16896
    v_mfma_f32_16x16x32_bf16 v[108:111], v[192:195], v[172:175], v[108:111]
    ds_read_b128 v[136:139], v2 offset:36864
    ds_read_b64_tr_b16 v[152:153], v6 offset:16384
    v_mfma_f32_16x16x32_bf16 v[124:127], v[192:195], v[176:179], v[124:127]
    ds_read_b64_tr_b16 v[154:155], v6 offset:16896
    ds_read_b128 v[140:143], v3 offset:38912
    v_mfma_f32_16x16x32_bf16 v[120:123], v[188:191], v[176:179], v[120:123]
    ds_read_b64_tr_b16 v[156:157], v7 offset:16384
    ds_read_b64_tr_b16 v[158:159], v7 offset:16896
    v_mfma_f32_16x16x32_bf16 v[116:119], v[184:187], v[176:179], v[116:119]
    v_mfma_f32_16x16x32_bf16 v[112:115], v[180:183], v[176:179], v[112:115]
    s_waitcnt lgkmcnt(0)
    s_cmp_lg_u32 s40, 0
    s_cbranch_scc1 L_side_4
    buffer_load_dword v48, v49, s[36:39], 0 offen sc1
L_side_4:
    v_mfma_f32_16x16x32_bf16 v[64:67], v[144:147], v[128:131], v[64:67]
    ds_read_b128 v[164:167], v3 offset:32768
    v_mfma_f32_16x16x32_bf16 v[68:71], v[148:151], v[128:131], v[68:71]
    ds_read_b64_tr_b16 v[180:181], v4 offset:20480
    v_mfma_f32_16x16x32_bf16 v[72:75], v[152:155], v[128:131], v[72:75]
    ds_read_b64_tr_b16 v[182:183], v4 offset:20992
    v_mfma_f32_16x16x32_bf16 v[76:79], v[156:159], v[128:131], v[76:79]
    ds_read_b128 v[168:171], v2 offset:34816
    v_mfma_f32_16x16x32_bf16 v[92:95], v[156:159], v[132:135], v[92:95]
    ds_read_b64_tr_b16 v[184:185], v5 offset:20480
    v_mfma_f32_16x16x32_bf16 v[88:91], v[152:155], v[132:135], v[88:91]
    ds_read_b64_tr_b16 v[186:187], v5 offset:20992
    v_mfma_f32_16x16x32_bf16 v[84:87], v[148:151], v[132:135], v[84:87]
    ds_read_b128 v[172:175], v3 offset:36864
    v_mfma_f32_16x16x32_bf16 v[80:83], v[144:147], v[132:135], v[80:83]
    ds_read_b64_tr_b16 v[188:189], v6 offset:20480
    v_mfma_f32_16x16x32_bf16 v[96:99], v[144:147], v[136:139], v[96:99]
    ds_read_b64_tr_b16 v[190:191], v6 offset:20992
    v_mfma_f32_16x16x32_bf16 v[100:103], v[148:151], v[136:139], v[100:103]
    ds_read_b128 v[176:179], v2 offset:38912
    v_mfma_f32_16x16x32_bf16 v[104:107], v[152:155], v[136:139], v[104:107]
    ds_read_b64_tr_b16 v[192:193], v7 offset:20480
    v_mfma_f32_16x16x32_bf16 v[108:111], v[156:159], v[136:139], v[108:111]
    ds_read_b64_tr_b16 v[194:195], v7 offset:20992
    v_mfma_f32_16x16x32_bf16 v[124:127], v[156:159], v[140:143], v[124:127]
    v_mfma_f32_16x16x32_bf16 v[120:123], v[152:155], v[140:143], v[120:123]
    v_mfma_f32_16x16x32_bf16 v[116:119], v[148:151], v[140:143], v[116:119]
    v_mfma_f32_16x16x32_bf16 v[112:115], v[144:147], v[140:143], v[112:115]
    s_waitcnt lgkmcnt(0)
    v_mfma_f32_16x16x32_bf16 v[64:67], v[180:183], v[164:167], v[64:67]
    v_mfma_f32_16x16x32_bf16 v[68:71], v[184:187], v[164:167], v[68:71]
    v_mfma_f32_16x16x32_bf16 v[72:75], v[188:191], v[164:167], v[72:75]
    v_mfma_f32_16x16x32_bf16 v[76:79], v[192:195], v[164:167], v[76:79]
    v_mfma_f32_16x16x32_bf16 v[92:95], v[192:195], v[168:171], v[92:95]
    v_mfma_f32_16x16x32_bf16 v[88:91], v[188:191], v[168:171], v[88:91]
    v_mfma_f32_16x16x32_bf16 v[84:87], v[184:187], v[168:171], v[84:87]
    v_mfma_f32_16x16x32_bf16 v[80:83], v[180:183], v[168:171], v[80:83]
    s_barrier
    v_mfma_f32_16x16x32_bf16 v[96:99], v[180:183], v[172:175], v[96:99]
    ds_read_b128 v[128:131], v2 offset:49152
    ds_read_b64_tr_b16 v[144:145], v4 offset:32768
    v_mfma_f32_16x16x32_bf16 v[100:103], v[184:187], v[172:175], v[100:103]
    ds_read_b64_tr_b16 v[146:147], v4 offset:33280
    ds_read_b128 v[132:135], v3 offset:51200
    v_mfma_f32_16x16x32_bf16 v[104:107], v[188:191], v[172:175], v[104:107]
    ds_read_b64_tr_b16 v[148:149], v5 offset:32768
    ds_read_b64_tr_b16 v[150:151], v5 offset:33280
    v_mfma_f32_16x16x32_bf16 v[108:111], v[192:195], v[172:175], v[108:111]
    ds_read_b128 v[136:139], v2 offset:53248
    ds_read_b64_tr_b16 v[152:153], v6 offset:32768
    v_mfma_f32_16x16x32_bf16 v[124:127], v[192:195], v[176:179], v[124:127]
    ds_read_b64_tr_b16 v[154:155], v6 offset:33280
    ds_read_b128 v[140:143], v3 offset:55296
    v_mfma_f32_16x16x32_bf16 v[120:123], v[188:191], v[176:179], v[120:123]
    ds_read_b64_tr_b16 v[156:157], v7 offset:32768
    ds_read_b64_tr_b16 v[158:159], v7 offset:33280
    v_mfma_f32_16x16x32_bf16 v[116:119], v[184:187], v[176:179], v[116:119]
    v_mfma_f32_16x16x32_bf16 v[112:115], v[180:183], v[176:179], v[112:115]
    s_waitcnt lgkmcnt(0)
    v_mfma_f32_16x16x32_bf16 v[64:67], v[144:147], v[128:131], v[64:67]
    ds_read_b128 v[164:167], v3 offset:49152
    v_mfma_f32_16x16x32_bf16 v[68:71], v[148:151], v[128:131], v[68:71]
    ds_read_b64_tr_b16 v[180:181], v4 offset:36864
    v_mfma_f32_16x16x32_bf16 v[72:75], v[152:155], v[128:131], v[72:75]
    ds_read_b64_tr_b16 v[182:183], v4 offset:37376
    v_mfma_f32_16x16x32_bf16 v[76:79], v[156:159], v[128:131], v[76:79]
    ds_read_b128 v[168:171], v2 offset:51200
    v_mfma_f32_16x16x32_bf16 v[92:95], v[156:159], v[132:135], v[92:95]
    ds_read_b64_tr_b16 v[184:185], v5 offset:36864
    v_mfma_f32_16x16x32_bf16 v[88:91], v[152:155], v[132:135], v[88:91]
    ds_read_b64_tr_b16 v[186:187], v5 offset:37376
    v_mfma_f32_16x16x32_bf16 v[84:87], v[148:151], v[132:135], v[84:87]
    ds_read_b128 v[172:175], v3 offset:53248
    v_mfma_f32_16x16x32_bf16 v[80:83], v[144:147], v[132:135], v[80:83]
    ds_read_b64_tr_b16 v[188:189], v6 offset:36864
    v_mfma_f32_16x16x32_bf16 v[96:99], v[144:147], v[136:139], v[96:99]
    ds_read_b64_tr_b16 v[190:191], v6 offset:37376
    v_mfma_f32_16x16x32_bf16 v[100:103], v[148:151], v[136:139], v[100:103]
    ds_read_b128 v[176:179], v2 offset:55296
    v_mfma_f32_16x16x32_bf16 v[104:107], v[152:155], v[136:139], v[104:107]
    ds_read_b64_tr_b16 v[192:193], v7 offset:36864
    v_mfma_f32_16x16x32_bf16 v[108:111], v[156:159], v[136:139], v[108:111]
    ds_read_b64_tr_b16 v[194:195], v7 offset:37376
    v_mfma_f32_16x16x32_bf16 v[124:127], v[156:159], v[140:143], v[124:127]
    v_mfma_f32_16x16x32_bf16 v[120:123], v[152:155], v[140:143], v[120:123]
    v_mfma_f32_16x16x32_bf16 v[116:119], v[148:151], v[140:143], v[116:119]
    v_mfma_f32_16x16x32_bf16 v[112:115], v[144:147], v[140:143], v[112:115]
    s_waitcnt lgkmcnt(0)
    v_mfma_f32_16x16x32_bf16 v[64:67], v[180:183], v[164:167], v[64:67]
    v_mfma_f32_16x16x32_bf16 v[68:71], v[184:187], v[164:167], v[68:71]
    v_mfma_f32_16x16x32_bf16 v[72:75], v[188:191], v[164:167], v[72:75]
    v_mfma_f32_16x16x32_bf16 v[76:79], v[192:195], v[164:167], v[76:79]
    v_mfma_f32_16x16x32_bf16 v[92:95], v[192:195], v[168:171], v[92:95]
    v_mfma_f32_16x16x32_bf16 v[88:91], v[188:191], v[168:171], v[88:91]
    v_mfma_f32_16x16x32_bf16 v[84:87], v[184:187], v[168:171], v[84:87]
    v_mfma_f32_16x16x32_bf16 v[80:83], v[180:183], v[168:171], v[80:83]
    s_cmp_lg_u32 s40, 0
    s_cbranch_scc1 L_side_5
    s_mov_b32 s90, 0
    s_branch L_polle_8
L_poll_6:
    buffer_load_dword v48, v49, s[36:39], 0 offen sc1
L_polle_8:
    s_add_u32 s90, s90, 1
    s_cmp_gt_u32 s90, 200000
    s_waitcnt vmcnt(0)
    s_cbranch_scc1 L_polld_7
    v_cmp_eq_u32 vcc, 0, v48
    s_cbranch_vccnz L_poll_6
L_polld_7:
    s_add_u32 s58, s100, s42
    s_lshl_b32 s59, s2, 7
    s_add_u32 s59, s59, 11010048
    s_add_u32 s60, s59, 196608
    s_mov_b64 exec, 1
    buffer_store_byte v51, v49, s[12:15], s58 offen
    buffer_store_dword v51, v49, s[12:15], s60 offen sc1
    s_mov_b64 exec, 7
    buffer_load_dword v48, v50, s[12:15], s59 offen sc1
    s_mov_b64 exec, -1
L_side_5:
    s_barrier
    v_mfma_f32_16x16x32_bf16 v[96:99], v[180:183], v[172:175], v[96:99]
    ds_read_b128 v[128:131], v2 offset:0
    ds_read_b64_tr_b16 v[144:145], v4 offset:49152
    v_mfma_f32_16x16x32_bf16 v[100:103], v[184:187], v[172:175], v[100:103]
    ds_read_b64_tr_b16 v[146:147], v4 offset:49664
    ds_read_b128 v[132:135], v3 offset:2048
    v_mfma_f32_16x16x32_bf16 v[104:107], v[188:191], v[172:175], v[104:107]
    ds_read_b64_tr_b16 v[148:149], v5 offset:49152
    ds_read_b64_tr_b16 v[150:151], v5 offset:49664
    v_mfma_f32_16x16x32_bf16 v[108:111], v[192:195], v[172:175], v[108:111]
    ds_read_b128 v[136:139], v2 offset:4096
    ds_read_b64_tr_b16 v[152:153], v6 offset:49152
    v_mfma_f32_16x16x32_bf16 v[124:127], v[192:195], v[176:179], v[124:127]
    ds_read_b64_tr_b16 v[154:155], v6 offset:49664
    ds_read_b128 v[140:143], v3 offset:6144
    v_mfma_f32_16x16x32_bf16 v[120:123], v[188:191], v[176:179], v[120:123]
    ds_read_b64_tr_b16 v[156:157], v7 offset:49152
    ds_read_b64_tr_b16 v[158:159], v7 offset:49664
    v_mfma_f32_16x16x32_bf16 v[116:119], v[184:187], v[176:179], v[116:119]
    v_mfma_f32_16x16x32_bf16 v[112:115], v[180:183], v[176:179], v[112:115]
    s_waitcnt lgkmcnt(0)
    v_mfma_f32_16x16x32_bf16 v[64:67], v[144:147], v[128:131], v[64:67]
    ds_read_b128 v[164:167], v3 offset:0
    v_mfma_f32_16x16x32_bf16 v[68:71], v[148:151], v[128:131], v[68:71]
    ds_read_b64_tr_b16 v[180:181], v4 offset:53248
    v_mfma_f32_16x16x32_bf16 v[72:75], v[152:155], v[128:131], v[72:75]
    ds_read_b64_tr_b16 v[182:183], v4 offset:53760
    v_mfma_f32_16x16x32_bf16 v[76:79], v[156:159], v[128:131], v[76:79]
    ds_read_b128 v[168:171], v2 offset:2048
    v_mfma_f32_16x16x32_bf16 v[92:95], v[156:159], v[132:135], v[92:95]
    ds_read_b64_tr_b16 v[184:185], v5 offset:53248
    v_mfma_f32_16x16x32_bf16 v[88:91], v[152:155], v[132:135], v[88:91]
    ds_read_b64_tr_b16 v[186:187], v5 offset:53760
    v_mfma_f32_16x16x32_bf16 v[84:87], v[148:151], v[132:135], v[84:87]
    ds_read_b128 v[172:175], v3 offset:4096
    v_mfma_f32_16x16x32_bf16 v[80:83], v[144:147], v[132:135], v[80:83]
    ds_read_b64_tr_b16 v[188:189], v6 offset:53248
    v_mfma_f32_16x16x32_bf16 v[96:99], v[144:147], v[136:139], v[96:99]
    ds_read_b64_tr_b16 v[190:191], v6 offset:53760
    v_mfma_f32_16x16x32_bf16 v[100:103], v[148:151], v[136:139], v[100:103]
    ds_read_b128 v[176:179], v2 offset:6144
    v_mfma_f32_16x16x32_bf16 v[104:107], v[152:155], v[136:139], v[104:107]
    ds_read_b64_tr_b16 v[192:193], v7 offset:53248
    v_mfma_f32_16x16x32_bf16 v[108:111], v[156:159], v[136:139], v[108:111]
    ds_read_b64_tr_b16 v[194:195], v7 offset:53760
    v_mfma_f32_16x16x32_bf16 v[124:127], v[156:159], v[140:143], v[124:127]
    v_mfma_f32_16x16x32_bf16 v[120:123], v[152:155], v[140:143], v[120:123]
    v_mfma_f32_16x16x32_bf16 v[116:119], v[148:151], v[140:143], v[116:119]
    v_mfma_f32_16x16x32_bf16 v[112:115], v[144:147], v[140:143], v[112:115]
    s_waitcnt lgkmcnt(0)
    v_mfma_f32_16x16x32_bf16 v[64:67], v[180:183], v[164:167], v[64:67]
    v_mfma_f32_16x16x32_bf16 v[68:71], v[184:187], v[164:167], v[68:71]
    v_mfma_f32_16x16x32_bf16 v[72:75], v[188:191], v[164:167], v[72:75]
    v_mfma_f32_16x16x32_bf16 v[76:79], v[192:195], v[164:167], v[76:79]
    v_mfma_f32_16x16x32_bf16 v[92:95], v[192:195], v[168:171], v[92:95]
    v_mfma_f32_16x16x32_bf16 v[88:91], v[188:191], v[168:171], v[88:91]
    v_mfma_f32_16x16x32_bf16 v[84:87], v[184:187], v[168:171], v[84:87]
    v_mfma_f32_16x16x32_bf16 v[80:83], v[180:183], v[168:171], v[80:83]
    s_barrier
    v_mfma_f32_16x16x32_bf16 v[96:99], v[180:183], v[172:175], v[96:99]
    ds_read_b128 v[128:131], v2 offset:16384
    ds_read_b64_tr_b16 v[144:145], v4 offset:0
    v_mfma_f32_16x16x32_bf16 v[100:103], v[184:187], v[172:175], v[100:103]
    ds_read_b64_tr_b16 v[146:147], v4 offset:512
    ds_read_b128 v[132:135], v3 offset:18432
    v_mfma_f32_16x16x32_bf16 v[104:107], v[188:191], v[172:175], v[104:107]
    ds_read_b64_tr_b16 v[148:149], v5 offset:0
    ds_read_b64_tr_b16 v[150:151], v5 offset:512
    v_mfma_f32_16x16x32_bf16 v[108:111], v[192:195], v[172:175], v[108:111]
    ds_read_b128 v[136:139], v2 offset:20480
    ds_read_b64_tr_b16 v[152:153], v6 offset:0
    v_mfma_f32_16x16x32_bf16 v[124:127], v[192:195], v[176:179], v[124:127]
    ds_read_b64_tr_b16 v[154:155], v6 offset:512
    ds_read_b128 v[140:143], v3 offset:22528
    v_mfma_f32_16x16x32_bf16 v[120:123], v[188:191], v[176:179], v[120:123]
    ds_read_b64_tr_b16 v[156:157], v7 offset:0
    ds_read_b64_tr_b16 v[158:159], v7 offset:512
    v_mfma_f32_16x16x32_bf16 v[116:119], v[184:187], v[176:179], v[116:119]
    v_mfma_f32_16x16x32_bf16 v[112:115], v[180:183], v[176:179], v[112:115]
    s_waitcnt lgkmcnt(0)
    v_mfma_f32_16x16x32_bf16 v[64:67], v[144:147], v[128:131], v[64:67]
    ds_read_b128 v[164:167], v3 offset:16384
    v_mfma_f32_16x16x32_bf16 v[68:71], v[148:151], v[128:131], v[68:71]
    ds_read_b64_tr_b16 v[180:181], v4 offset:4096
    v_mfma_f32_16x16x32_bf16 v[72:75], v[152:155], v[128:131], v[72:75]
    ds_read_b64_tr_b16 v[182:183], v4 offset:4608
    v_mfma_f32_16x16x32_bf16 v[76:79], v[156:159], v[128:131], v[76:79]
    ds_read_b128 v[168:171], v2 offset:18432
    v_mfma_f32_16x16x32_bf16 v[92:95], v[156:159], v[132:135], v[92:95]
    ds_read_b64_tr_b16 v[184:185], v5 offset:4096
    v_mfma_f32_16x16x32_bf16 v[88:91], v[152:155], v[132:135], v[88:91]
    ds_read_b64_tr_b16 v[186:187], v5 offset:4608
    v_mfma_f32_16x16x32_bf16 v[84:87], v[148:151], v[132:135], v[84:87]
    ds_read_b128 v[172:175], v3 offset:20480
    v_mfma_f32_16x16x32_bf16 v[80:83], v[144:147], v[132:135], v[80:83]
    ds_read_b64_tr_b16 v[188:189], v6 offset:4096
    v_mfma_f32_16x16x32_bf16 v[96:99], v[144:147], v[136:139], v[96:99]
    ds_read_b64_tr_b16 v[190:191], v6 offset:4608
    v_mfma_f32_16x16x32_bf16 v[100:103], v[148:151], v[136:139], v[100:103]
    ds_read_b128 v[176:179], v2 offset:22528
    v_mfma_f32_16x16x32_bf16 v[104:107], v[152:155], v[136:139], v[104:107]
    ds_read_b64_tr_b16 v[192:193], v7 offset:4096
    v_mfma_f32_16x16x32_bf16 v[108:111], v[156:159], v[136:139], v[108:111]
    ds_read_b64_tr_b16 v[194:195], v7 offset:4608
    v_mfma_f32_16x16x32_bf16 v[124:127], v[156:159], v[140:143], v[124:127]
    v_mfma_f32_16x16x32_bf16 v[120:123], v[152:155], v[140:143], v[120:123]
    v_mfma_f32_16x16x32_bf16 v[116:119], v[148:151], v[140:143], v[116:119]
    v_mfma_f32_16x16x32_bf16 v[112:115], v[144:147], v[140:143], v[112:115]
    s_waitcnt lgkmcnt(0)
    v_mfma_f32_16x16x32_bf16 v[64:67], v[180:183], v[164:167], v[64:67]
    v_mfma_f32_16x16x32_bf16 v[68:71], v[184:187], v[164:167], v[68:71]
    v_mfma_f32_16x16x32_bf16 v[72:75], v[188:191], v[164:167], v[72:75]
    v_mfma_f32_16x16x32_bf16 v[76:79], v[192:195], v[164:167], v[76:79]
    v_mfma_f32_16x16x32_bf16 v[92:95], v[192:195], v[168:171], v[92:95]
    v_mfma_f32_16x16x32_bf16 v[88:91], v[188:191], v[168:171], v[88:91]
    v_mfma_f32_16x16x32_bf16 v[84:87], v[184:187], v[168:171], v[84:87]
    v_mfma_f32_16x16x32_bf16 v[80:83], v[180:183], v[168:171], v[80:83]
    s_barrier
    v_mfma_f32_16x16x32_bf16 v[96:99], v[180:183], v[172:175], v[96:99]
    ds_read_b128 v[128:131], v2 offset:32768
    ds_read_b64_tr_b16 v[144:145], v4 offset:16384
    v_mfma_f32_16x16x32_bf16 v[100:103], v[184:187], v[172:175], v[100:103]
    ds_read_b64_tr_b16 v[146:147], v4 offset:16896
    ds_read_b128 v[132:135], v3 offset:34816
    v_mfma_f32_16x16x32_bf16 v[104:107], v[188:191], v[172:175], v[104:107]
    ds_read_b64_tr_b16 v[148:149], v5 offset:16384
    ds_read_b64_tr_b16 v[150:151], v5 offset:16896
    v_mfma_f32_16x16x32_bf16 v[108:111], v[192:195], v[172:175], v[108:111]
    ds_read_b128 v[136:139], v2 offset:36864
    ds_read_b64_tr_b16 v[152:153], v6 offset:16384
    v_mfma_f32_16x16x32_bf16 v[124:127], v[192:195], v[176:179], v[124:127]
    ds_read_b64_tr_b16 v[154:155], v6 offset:16896
    ds_read_b128 v[140:143], v3 offset:38912
    v_mfma_f32_16x16x32_bf16 v[120:123], v[188:191], v[176:179], v[120:123]
    ds_read_b64_tr_b16 v[156:157], v7 offset:16384
    ds_read_b64_tr_b16 v[158:159], v7 offset:16896
    v_mfma_f32_16x16x32_bf16 v[116:119], v[184:187], v[176:179], v[116:119]
    v_mfma_f32_16x16x32_bf16 v[112:115], v[180:183], v[176:179], v[112:115]
    s_waitcnt lgkmcnt(0)
    v_mfma_f32_16x16x32_bf16 v[64:67], v[144:147], v[128:131], v[64:67]
    ds_read_b128 v[164:167], v3 offset:32768
    v_mfma_f32_16x16x32_bf16 v[68:71], v[148:151], v[128:131], v[68:71]
    ds_read_b64_tr_b16 v[180:181], v4 offset:20480
    v_mfma_f32_16x16x32_bf16 v[72:75], v[152:155], v[128:131], v[72:75]
    ds_read_b64_tr_b16 v[182:183], v4 offset:20992
    v_mfma_f32_16x16x32_bf16 v[76:79], v[156:159], v[128:131], v[76:79]
    ds_read_b128 v[168:171], v2 offset:34816
    v_mfma_f32_16x16x32_bf16 v[92:95], v[156:159], v[132:135], v[92:95]
    ds_read_b64_tr_b16 v[184:185], v5 offset:20480
    v_mfma_f32_16x16x32_bf16 v[88:91], v[152:155], v[132:135], v[88:91]
    ds_read_b64_tr_b16 v[186:187], v5 offset:20992
    v_mfma_f32_16x16x32_bf16 v[84:87], v[148:151], v[132:135], v[84:87]
    ds_read_b128 v[172:175], v3 offset:36864
    v_mfma_f32_16x16x32_bf16 v[80:83], v[144:147], v[132:135], v[80:83]
    ds_read_b64_tr_b16 v[188:189], v6 offset:20480
    v_mfma_f32_16x16x32_bf16 v[96:99], v[144:147], v[136:139], v[96:99]
    ds_read_b64_tr_b16 v[190:191], v6 offset:20992
    v_mfma_f32_16x16x32_bf16 v[100:103], v[148:151], v[136:139], v[100:103]
    ds_read_b128 v[176:179], v2 offset:38912
    v_mfma_f32_16x16x32_bf16 v[104:107], v[152:155], v[136:139], v[104:107]
    ds_read_b64_tr_b16 v[192:193], v7 offset:20480
    v_mfma_f32_16x16x32_bf16 v[108:111], v[156:159], v[136:139], v[108:111]
    ds_read_b64_tr_b16 v[194:195], v7 offset:20992
    v_mfma_f32_16x16x32_bf16 v[124:127], v[156:159], v[140:143], v[124:127]
    v_mfma_f32_16x16x32_bf16 v[120:123], v[152:155], v[140:143], v[120:123]
    v_mfma_f32_16x16x32_bf16 v[116:119], v[148:151], v[140:143], v[116:119]
    v_mfma_f32_16x16x32_bf16 v[112:115], v[144:147], v[140:143], v[112:115]
    s_waitcnt lgkmcnt(0)
    v_mfma_f32_16x16x32_bf16 v[64:67], v[180:183], v[164:167], v[64:67]
    v_mfma_f32_16x16x32_bf16 v[68:71], v[184:187], v[164:167], v[68:71]
    v_mfma_f32_16x16x32_bf16 v[72:75], v[188:191], v[164:167], v[72:75]
    v_mfma_f32_16x16x32_bf16 v[76:79], v[192:195], v[164:167], v[76:79]
    v_mfma_f32_16x16x32_bf16 v[92:95], v[192:195], v[168:171], v[92:95]
    v_mfma_f32_16x16x32_bf16 v[88:91], v[188:191], v[168:171], v[88:91]
    v_mfma_f32_16x16x32_bf16 v[84:87], v[184:187], v[168:171], v[84:87]
    v_mfma_f32_16x16x32_bf16 v[80:83], v[180:183], v[168:171], v[80:83]
    buffer_load_dword v48, v49, s[12:15], s100 offen sc1
    s_barrier
    v_mfma_f32_16x16x32_bf16 v[96:99], v[180:183], v[172:175], v[96:99]
    ds_read_b128 v[128:131], v2 offset:49152
    ds_read_b64_tr_b16 v[144:145], v4 offset:32768
    v_mfma_f32_16x16x32_bf16 v[100:103], v[184:187], v[172:175], v[100:103]
    ds_read_b64_tr_b16 v[146:147], v4 offset:33280
    ds_read_b128 v[132:135], v3 offset:51200
    v_mfma_f32_16x16x32_bf16 v[104:107], v[188:191], v[172:175], v[104:107]
    ds_read_b64_tr_b16 v[148:149], v5 offset:32768
    ds_read_b64_tr_b16 v[150:151], v5 offset:33280
    v_mfma_f32_16x16x32_bf16 v[108:111], v[192:195], v[172:175], v[108:111]
    ds_read_b128 v[136:139], v2 offset:53248
    ds_read_b64_tr_b16 v[152:153], v6 offset:32768
    v_mfma_f32_16x16x32_bf16 v[124:127], v[192:195], v[176:179], v[124:127]
    ds_read_b64_tr_b16 v[154:155], v6 offset:33280
    ds_read_b128 v[140:143], v3 offset:55296
    v_mfma_f32_16x16x32_bf16 v[120:123], v[188:191], v[176:179], v[120:123]
    ds_read_b64_tr_b16 v[156:157], v7 offset:32768
    ds_read_b64_tr_b16 v[158:159], v7 offset:33280
    v_mfma_f32_16x16x32_bf16 v[116:119], v[184:187], v[176:179], v[116:119]
    v_mfma_f32_16x16x32_bf16 v[112:115], v[180:183], v[176:179], v[112:115]
    s_waitcnt lgkmcnt(0)
    v_mfma_f32_16x16x32_bf16 v[64:67], v[144:147], v[128:131], v[64:67]
    ds_read_b128 v[164:167], v3 offset:49152
    v_mfma_f32_16x16x32_bf16 v[68:71], v[148:151], v[128:131], v[68:71]
    ds_read_b64_tr_b16 v[180:181], v4 offset:36864
    v_mfma_f32_16x16x32_bf16 v[72:75], v[152:155], v[128:131], v[72:75]
    ds_read_b64_tr_b16 v[182:183], v4 offset:37376
    v_mfma_f32_16x16x32_bf16 v[76:79], v[156:159], v[128:131], v[76:79]
    ds_read_b128 v[168:171], v2 offset:51200
    v_mfma_f32_16x16x32_bf16 v[92:95], v[156:159], v[132:135], v[92:95]
    ds_read_b64_tr_b16 v[184:185], v5 offset:36864
    v_mfma_f32_16x16x32_bf16 v[88:91], v[152:155], v[132:135], v[88:91]
    ds_read_b64_tr_b16 v[186:187], v5 offset:37376
    v_mfma_f32_16x16x32_bf16 v[84:87], v[148:151], v[132:135], v[84:87]
    ds_read_b128 v[172:175], v3 offset:53248
    v_mfma_f32_16x16x32_bf16 v[80:83], v[144:147], v[132:135], v[80:83]
    ds_read_b64_tr_b16 v[188:189], v6 offset:36864
    v_mfma_f32_16x16x32_bf16 v[96:99], v[144:147], v[136:139], v[96:99]
    ds_read_b64_tr_b16 v[190:191], v6 offset:37376
    v_mfma_f32_16x16x32_bf16 v[100:103], v[148:151], v[136:139], v[100:103]
    ds_read_b128 v[176:179], v2 offset:55296
    v_mfma_f32_16x16x32_bf16 v[104:107], v[152:155], v[136:139], v[104:107]
    ds_read_b64_tr_b16 v[192:193], v7 offset:36864
    v_mfma_f32_16x16x32_bf16 v[108:111], v[156:159], v[136:139], v[108:111]
    ds_read_b64_tr_b16 v[194:195], v7 offset:37376
    v_mfma_f32_16x16x32_bf16 v[124:127], v[156:159], v[140:143], v[124:127]
    v_mfma_f32_16x16x32_bf16 v[120:123], v[152:155], v[140:143], v[120:123]
    v_mfma_f32_16x16x32_bf16 v[116:119], v[148:151], v[140:143], v[116:119]
    v_mfma_f32_16x16x32_bf16 v[112:115], v[144:147], v[140:143], v[112:115]
    s_waitcnt lgkmcnt(0)
    v_mfma_f32_16x16x32_bf16 v[64:67], v[180:183], v[164:167], v[64:67]
    v_mfma_f32_16x16x32_bf16 v[68:71], v[184:187], v[164:167], v[68:71]
    v_mfma_f32_16x16x32_bf16 v[72:75], v[188:191], v[164:167], v[72:75]
    v_mfma_f32_16x16x32_bf16 v[76:79], v[192:195], v[164:167], v[76:79]
    v_mfma_f32_16x16x32_bf16 v[92:95], v[192:195], v[168:171], v[92:95]
    v_mfma_f32_16x16x32_bf16 v[88:91], v[188:191], v[168:171], v[88:91]
    v_mfma_f32_16x16x32_bf16 v[84:87], v[184:187], v[168:171], v[84:87]
    v_mfma_f32_16x16x32_bf16 v[80:83], v[180:183], v[168:171], v[80:83]
    s_barrier
    v_mfma_f32_16x16x32_bf16 v[96:99], v[180:183], v[172:175], v[96:99]
    ds_read_b128 v[128:131], v2 offset:0
    ds_read_b64_tr_b16 v[144:145], v4 offset:49152
    v_mfma_f32_16x16x32_bf16 v[100:103], v[184:187], v[172:175], v[100:103]
    ds_read_b64_tr_b16 v[146:147], v4 offset:49664
    ds_read_b128 v[132:135], v3 offset:2048
    v_mfma_f32_16x16x32_bf16 v[104:107], v[188:191], v[172:175], v[104:107]
    ds_read_b64_tr_b16 v[148:149], v5 offset:49152
    ds_read_b64_tr_b16 v[150:151], v5 offset:49664
    v_mfma_f32_16x16x32_bf16 v[108:111], v[192:195], v[172:175], v[108:111]
    ds_read_b128 v[136:139], v2 offset:4096
    ds_read_b64_tr_b16 v[152:153], v6 offset:49152
    v_mfma_f32_16x16x32_bf16 v[124:127], v[192:195], v[176:179], v[124:127]
    ds_read_b64_tr_b16 v[154:155], v6 offset:49664
    ds_read_b128 v[140:143], v3 offset:6144
    v_mfma_f32_16x16x32_bf16 v[120:123], v[188:191], v[176:179], v[120:123]
    ds_read_b64_tr_b16 v[156:157], v7 offset:49152
    ds_read_b64_tr_b16 v[158:159], v7 offset:49664
    v_mfma_f32_16x16x32_bf16 v[116:119], v[184:187], v[176:179], v[116:119]
    v_mfma_f32_16x16x32_bf16 v[112:115], v[180:183], v[176:179], v[112:115]
    s_waitcnt lgkmcnt(0)
    v_mfma_f32_16x16x32_bf16 v[64:67], v[144:147], v[128:131], v[64:67]
    ds_read_b128 v[164:167], v3 offset:0
    ds_read_b64_tr_b16 v[180:181], v4 offset:53248
    v_mfma_f32_16x16x32_bf16 v[68:71], v[148:151], v[128:131], v[68:71]
    ds_read_b64_tr_b16 v[182:183], v4 offset:53760
    ds_read_b128 v[168:171], v2 offset:2048
    v_mfma_f32_16x16x32_bf16 v[72:75], v[152:155], v[128:131], v[72:75]
    ds_read_b64_tr_b16 v[184:185], v5 offset:53248
    ds_read_b64_tr_b16 v[186:187], v5 offset:53760
    v_mfma_f32_16x16x32_bf16 v[76:79], v[156:159], v[128:131], v[76:79]
    ds_read_b128 v[172:175], v3 offset:4096
    ds_read_b64_tr_b16 v[188:189], v6 offset:53248
    v_mfma_f32_16x16x32_bf16 v[92:95], v[156:159], v[132:135], v[92:95]
    ds_read_b64_tr_b16 v[190:191], v6 offset:53760
    ds_read_b128 v[176:179], v2 offset:6144
    v_mfma_f32_16x16x32_bf16 v[88:91], v[152:155], v[132:135], v[88:91]
    ds_read_b64_tr_b16 v[192:193], v7 offset:53248
    ds_read_b64_tr_b16 v[194:195], v7 offset:53760
    v_mfma_f32_16x16x32_bf16 v[84:87], v[148:151], v[132:135], v[84:87]
    v_mfma_f32_16x16x32_bf16 v[80:83], v[144:147], v[132:135], v[80:83]
    s_mul_i32 s60, s101, 0x01010101
    s_waitcnt vmcnt(0)
    v_cmp_ne_u32 vcc, s60, v48
    s_cmp_lg_u64 vcc, 0
    s_cbranch_scc1 L_rare_9
L_rare_9_b:
    s_cmp_eq_u64 vcc, 0
    s_cselect_b32 s50, 1, 0
    s_and_b32 s97, s97, s50
    v_mfma_f32_16x16x32_bf16 v[96:99], v[144:147], v[136:139], v[96:99]
    v_mfma_f32_16x16x32_bf16 v[100:103], v[148:151], v[136:139], v[100:103]
    v_mfma_f32_16x16x32_bf16 v[104:107], v[152:155], v[136:139], v[104:107]
    v_mfma_f32_16x16x32_bf16 v[108:111], v[156:159], v[136:139], v[108:111]
    s_waitcnt lgkmcnt(0)
    v_mfma_f32_16x16x32_bf16 v[64:67], v[180:183], v[164:167], v[64:67]
    v_mfma_f32_16x16x32_bf16 v[68:71], v[184:187], v[164:167], v[68:71]
    v_mfma_f32_16x16x32_bf16 v[72:75], v[188:191], v[164:167], v[72:75]
    v_mfma_f32_16x16x32_bf16 v[76:79], v[192:195], v[164:167], v[76:79]
    v_mfma_f32_16x16x32_bf16 v[92:95], v[192:195], v[168:171], v[92:95]
    v_mfma_f32_16x16x32_bf16 v[88:91], v[188:191], v[168:171], v[88:91]
    v_mfma_f32_16x16x32_bf16 v[84:87], v[184:187], v[168:171], v[84:87]
    v_mfma_f32_16x16x32_bf16 v[80:83], v[180:183], v[168:171], v[80:83]
    s_cmp_eq_u32 s97, 0
    s_cbranch_scc1 L_wt_10
    v_mfma_f32_16x16x32_bf16 v[124:127], v[156:159], v[140:143], v[124:127]
    v_mfma_f32_16x16x32_bf16 v[120:123], v[152:155], v[140:143], v[120:123]
    s_mov_b32 s58, s99
    s_mov_b32 s59, s99
    v_pk_mul_f32 v[64:65], v[64:65], s[58:59]
    v_cvt_pk_bf16_f32 v16, v64, v65
    v_mfma_f32_16x16x32_bf16 v[116:119], v[148:151], v[140:143], v[116:119]
    v_pk_mul_f32 v[66:67], v[66:67], s[58:59]
    v_cvt_pk_bf16_f32 v17, v66, v67
    v_pk_mul_f32 v[68:69], v[68:69], s[58:59]
    v_cvt_pk_bf16_f32 v18, v68, v69
    v_mfma_f32_16x16x32_bf16 v[112:115], v[144:147], v[140:143], v[112:115]
    v_pk_mul_f32 v[70:71], v[70:71], s[58:59]
    v_cvt_pk_bf16_f32 v19, v70, v71
    buffer_store_dwordx4 v[16:19], v8, s[12:15], s98 offen offset:0
    v_pk_mul_f32 v[72:73], v[72:73], s[58:59]
    v_mfma_f32_16x16x32_bf16 v[96:99], v[180:183], v[172:175], v[96:99]
    v_cvt_pk_bf16_f32 v24, v72, v73
    v_pk_mul_f32 v[74:75], v[74:75], s[58:59]
    v_cvt_pk_bf16_f32 v25, v74, v75
    v_pk_mul_f32 v[76:77], v[76:77], s[58:59]
    v_mfma_f32_16x16x32_bf16 v[100:103], v[184:187], v[172:175], v[100:103]
    v_cvt_pk_bf16_f32 v26, v76, v77
    v_pk_mul_f32 v[78:79], v[78:79], s[58:59]
    v_cvt_pk_bf16_f32 v27, v78, v79
    buffer_store_dwordx4 v[24:27], v8, s[12:15], s89 offen offset:0
    v_mfma_f32_16x16x32_bf16 v[104:107], v[188:191], v[172:175], v[104:107]
    v_pk_mul_f32 v[80:81], v[80:81], s[58:59]
    v_cvt_pk_bf16_f32 v28, v80, v81
    v_pk_mul_f32 v[82:83], v[82:83], s[58:59]
    v_mfma_f32_16x16x32_bf16 v[108:111], v[192:195], v[172:175], v[108:111]
    v_cvt_pk_bf16_f32 v29, v82, v83
    v_pk_mul_f32 v[84:85], v[84:85], s[58:59]
    v_cvt_pk_bf16_f32 v30, v84, v85
    v_mfma_f32_16x16x32_bf16 v[124:127], v[192:195], v[176:179], v[124:127]
    v_pk_mul_f32 v[86:87], v[86:87], s[58:59]
    v_cvt_pk_bf16_f32 v31, v86, v87
    buffer_store_dwordx4 v[28:31], v8, s[12:15], s98 offen offset:256
    v_mfma_f32_16x16x32_bf16 v[120:123], v[188:191], v[176:179], v[120:123]
    v_pk_mul_f32 v[88:89], v[88:89], s[58:59]
    v_cvt_pk_bf16_f32 v40, v88, v89
    v_pk_mul_f32 v[90:91], v[90:91], s[58:59]
    v_mfma_f32_16x16x32_bf16 v[116:119], v[184:187], v[176:179], v[116:119]
    v_cvt_pk_bf16_f32 v41, v90, v91
    v_pk_mul_f32 v[92:93], v[92:93], s[58:59]
    v_cvt_pk_bf16_f32 v42, v92, v93
    v_mfma_f32_16x16x32_bf16 v[112:115], v[180:183], v[176:179], v[112:115]
    v_pk_mul_f32 v[94:95], v[94:95], s[58:59]
    v_cvt_pk_bf16_f32 v43, v94, v95
    buffer_store_dwordx4 v[40:43], v8, s[12:15], s89 offen offset:256
    v_pk_mul_f32 v[96:97], v[96:97], s[58:59]
    v_cvt_pk_bf16_f32 v128, v96, v97
    v_pk_mul_f32 v[98:99], v[98:99], s[58:59]
    v_cvt_pk_bf16_f32 v129, v98, v99
    v_pk_mul_f32 v[100:101], v[100:101], s[58:59]
    v_cvt_pk_bf16_f32 v130, v100, v101
    v_pk_mul_f32 v[102:103], v[102:103], s[58:59]
    v_cvt_pk_bf16_f32 v131, v102, v103
    buffer_store_dwordx4 v[128:131], v8, s[12:15], s98 offen offset:512
    v_pk_mul_f32 v[104:105], v[104:105], s[58:59]
    v_cvt_pk_bf16_f32 v132, v104, v105
    v_pk_mul_f32 v[106:107], v[106:107], s[58:59]
    v_cvt_pk_bf16_f32 v133, v106, v107
    v_pk_mul_f32 v[108:109], v[108:109], s[58:59]
    v_cvt_pk_bf16_f32 v134, v108, v109
    v_pk_mul_f32 v[110:111], v[110:111], s[58:59]
    v_cvt_pk_bf16_f32 v135, v110, v111
    buffer_store_dwordx4 v[132:135], v8, s[12:15], s89 offen offset:512
    v_pk_mul_f32 v[112:113], v[112:113], s[58:59]
    v_cvt_pk_bf16_f32 v136, v112, v113
    v_pk_mul_f32 v[114:115], v[114:115], s[58:59]
    v_cvt_pk_bf16_f32 v137, v114, v115
    v_pk_mul_f32 v[116:117], v[116:117], s[58:59]
    v_cvt_pk_bf16_f32 v138, v116, v117
    v_pk_mul_f32 v[118:119], v[118:119], s[58:59]
    v_cvt_pk_bf16_f32 v139, v118, v119
    buffer_store_dwordx4 v[136:139], v8, s[12:15], s98 offen offset:768
    v_pk_mul_f32 v[120:121], v[120:121], s[58:59]
    v_cvt_pk_bf16_f32 v140, v120, v121
    v_pk_mul_f32 v[122:123], v[122:123], s[58:59]
    v_cvt_pk_bf16_f32 v141, v122, v123
    v_pk_mul_f32 v[124:125], v[124:125], s[58:59]
    v_cvt_pk_bf16_f32 v142, v124, v125
    v_pk_mul_f32 v[126:127], v[126:127], s[58:59]
    v_cvt_pk_bf16_f32 v143, v126, v127
    buffer_store_dwordx4 v[140:143], v8, s[12:15], s89 offen offset:768
    s_branch L_wtd_11
L_wt_10:
    v_mfma_f32_16x16x32_bf16 v[124:127], v[156:159], v[140:143], v[124:127]
    v_mfma_f32_16x16x32_bf16 v[120:123], v[152:155], v[140:143], v[120:123]
    s_mov_b32 s58, s99
    s_mov_b32 s59, s99
    v_pk_mul_f32 v[64:65], v[64:65], s[58:59]
    v_cvt_pk_bf16_f32 v16, v64, v65
    v_mfma_f32_16x16x32_bf16 v[116:119], v[148:151], v[140:143], v[116:119]
    v_pk_mul_f32 v[66:67], v[66:67], s[58:59]
    v_cvt_pk_bf16_f32 v17, v66, v67
    v_pk_mul_f32 v[68:69], v[68:69], s[58:59]
    v_cvt_pk_bf16_f32 v18, v68, v69
    v_mfma_f32_16x16x32_bf16 v[112:115], v[144:147], v[140:143], v[112:115]
    v_pk_mul_f32 v[70:71], v[70:71], s[58:59]
    v_cvt_pk_bf16_f32 v19, v70, v71
    buffer_store_dwordx4 v[16:19], v8, s[12:15], s98 offen offset:0 sc1
    v_pk_mul_f32 v[72:73], v[72:73], s[58:59]
    v_mfma_f32_16x16x32_bf16 v[96:99], v[180:183], v[172:175], v[96:99]
    v_cvt_pk_bf16_f32 v24, v72, v73
    v_pk_mul_f32 v[74:75], v[74:75], s[58:59]
    v_cvt_pk_bf16_f32 v25, v74, v75
    v_pk_mul_f32 v[76:77], v[76:77], s[58:59]
    v_mfma_f32_16x16x32_bf16 v[100:103], v[184:187], v[172:175], v[100:103]
    v_cvt_pk_bf16_f32 v26, v76, v77
    v_pk_mul_f32 v[78:79], v[78:79], s[58:59]
    v_cvt_pk_bf16_f32 v27, v78, v79
    buffer_store_dwordx4 v[24:27], v8, s[12:15], s89 offen offset:0 sc1
    v_mfma_f32_16x16x32_bf16 v[104:107], v[188:191], v[172:175], v[104:107]
    v_pk_mul_f32 v[80:81], v[80:81], s[58:59]
    v_cvt_pk_bf16_f32 v28, v80, v81
    v_pk_mul_f32 v[82:83], v[82:83], s[58:59]
    v_mfma_f32_16x16x32_bf16 v[108:111], v[192:195], v[172:175], v[108:111]
    v_cvt_pk_bf16_f32 v29, v82, v83
    v_pk_mul_f32 v[84:85], v[84:85], s[58:59]
    v_cvt_pk_bf16_f32 v30, v84, v85
    v_mfma_f32_16x16x32_bf16 v[124:127], v[192:195], v[176:179], v[124:127]
    v_pk_mul_f32 v[86:87], v[86:87], s[58:59]
    v_cvt_pk_bf16_f32 v31, v86, v87
    buffer_store_dwordx4 v[28:31], v8, s[12:15], s98 offen offset:256 sc1
    v_mfma_f32_16x16x32_bf16 v[120:123], v[188:191], v[176:179], v[120:123]
    v_pk_mul_f32 v[88:89], v[88:89], s[58:59]
    v_cvt_pk_bf16_f32 v40, v88, v89
    v_pk_mul_f32 v[90:91], v[90:91], s[58:59]
    v_mfma_f32_16x16x32_bf16 v[116:119], v[184:187], v[176:179], v[116:119]
    v_cvt_pk_bf16_f32 v41, v90, v91
    v_pk_mul_f32 v[92:93], v[92:93], s[58:59]
    v_cvt_pk_bf16_f32 v42, v92, v93
    v_mfma_f32_16x16x32_bf16 v[112:115], v[180:183], v[176:179], v[112:115]
    v_pk_mul_f32 v[94:95], v[94:95], s[58:59]
    v_cvt_pk_bf16_f32 v43, v94, v95
    buffer_store_dwordx4 v[40:43], v8, s[12:15], s89 offen offset:256 sc1
    v_pk_mul_f32 v[96:97], v[96:97], s[58:59]
    v_cvt_pk_bf16_f32 v128, v96, v97
    v_pk_mul_f32 v[98:99], v[98:99], s[58:59]
    v_cvt_pk_bf16_f32 v129, v98, v99
    v_pk_mul_f32 v[100:101], v[100:101], s[58:59]
    v_cvt_pk_bf16_f32 v130, v100, v101
    v_pk_mul_f32 v[102:103], v[102:103], s[58:59]
    v_cvt_pk_bf16_f32 v131, v102, v103
    buffer_store_dwordx4 v[128:131], v8, s[12:15], s98 offen offset:512 sc1
    v_pk_mul_f32 v[104:105], v[104:105], s[58:59]
    v_cvt_pk_bf16_f32 v132, v104, v105
    v_pk_mul_f32 v[106:107], v[106:107], s[58:59]
    v_cvt_pk_bf16_f32 v133, v106, v107
    v_pk_mul_f32 v[108:109], v[108:109], s[58:59]
    v_cvt_pk_bf16_f32 v134, v108, v109
    v_pk_mul_f32 v[110:111], v[110:111], s[58:59]
    v_cvt_pk_bf16_f32 v135, v110, v111
    buffer_store_dwordx4 v[132:135], v8, s[12:15], s89 offen offset:512 sc1
    v_pk_mul_f32 v[112:113], v[112:113], s[58:59]
    v_cvt_pk_bf16_f32 v136, v112, v113
    v_pk_mul_f32 v[114:115], v[114:115], s[58:59]
    v_cvt_pk_bf16_f32 v137, v114, v115
    v_pk_mul_f32 v[116:117], v[116:117], s[58:59]
    v_cvt_pk_bf16_f32 v138, v116, v117
    v_pk_mul_f32 v[118:119], v[118:119], s[58:59]
    v_cvt_pk_bf16_f32 v139, v118, v119
    buffer_store_dwordx4 v[136:139], v8, s[12:15], s98 offen offset:768 sc1
    v_pk_mul_f32 v[120:121], v[120:121], s[58:59]
    v_cvt_pk_bf16_f32 v140, v120, v121
    v_pk_mul_f32 v[122:123], v[122:123], s[58:59]
    v_cvt_pk_bf16_f32 v141, v122, v123
    v_pk_mul_f32 v[124:125], v[124:125], s[58:59]
    v_cvt_pk_bf16_f32 v142, v124, v125
    v_pk_mul_f32 v[126:127], v[126:127], s[58:59]
    v_cvt_pk_bf16_f32 v143, v126, v127
    buffer_store_dwordx4 v[140:143], v8, s[12:15], s89 offen offset:768 sc1
L_wtd_11:
    s_branch L_g1done
L_gemm_v:
    v_and_b32 v14, 8, v10
    v_add_u32 v14, v14, v10
    v_lshl_add_u32 v2, v14, 7, v12
    v_bfe_u32 v14, v0, 1, 1
    v_and_b32 v15, 1, v11
    v_lshl_add_u32 v14, v15, 1, v14
    v_lshl_add_u32 v4, v14, 4, v13
    v_xor_b32 v5, 32, v4
    v_xor_b32 v6, 64, v4
    v_xor_b32 v7, 96, v4
    s_sub_u32 s60, s60, 1280
    v_add_u32 v14, s60, v10
    v_mul_u32_u24 v15, 3277, v14
    v_lshrrev_b32 v15, 16, v15
    v_mul_u32_u24 v15, 4800, v15
    v_lshl_add_u32 v15, v14, 4, v15
    v_mul_u32_u24 v14, 320, v11
    v_add_u32 v56, v15, v14
    v_add_u32 v14, s60, v10
    v_add_u32 v14, 16, v14
    v_mul_u32_u24 v15, 3277, v14
    v_lshrrev_b32 v15, 16, v15
    v_mul_u32_u24 v15, 4800, v15
    v_lshl_add_u32 v15, v14, 4, v15
    v_mul_u32_u24 v14, 320, v11
    v_add_u32 v57, v15, v14
    v_add_u32 v14, s60, v10
    v_add_u32 v14, 32, v14
    v_mul_u32_u24 v15, 3277, v14
    v_lshrrev_b32 v15, 16, v15
    v_mul_u32_u24 v15, 4800, v15
    v_lshl_add_u32 v15, v14, 4, v15
    v_mul_u32_u24 v14, 320, v11
    v_add_u32 v58, v15, v14
    v_add_u32 v14, s60, v10
    v_add_u32 v14, 48, v14
    v_mul_u32_u24 v15, 3277, v14
    v_lshrrev_b32 v15, 16, v15
    v_mul_u32_u24 v15, 4800, v15
    v_lshl_add_u32 v15, v14, 4, v15
    v_mul_u32_u24 v14, 320, v11
    v_add_u32 v59, v15, v14
    s_cmp_eq_u32 s46, 7
    s_cbranch_scc1 L_gemm_h
    s_lshl_b32 s58, s3, 13
    v_add_u32 v2, s58, v2
    v_xor_b32 v3, 64, v2
    s_mul_i32 s61, s47, 491520
    s_mul_i32 s98, s3, 2560
    s_add_u32 s98, s98, s61
    s_add_u32 s98, s98, 327680
    s_barrier
    ds_read_b128 v[128:131], v2 offset:49152
    ds_read_b64_tr_b16 v[144:145], v4 offset:32768
    ds_read_b64_tr_b16 v[146:147], v4 offset:33280
    ds_read_b128 v[132:135], v3 offset:50176
    ds_read_b64_tr_b16 v[148:149], v5 offset:32768
    ds_read_b64_tr_b16 v[150:151], v5 offset:33280
    ds_read_b128 v[136:139], v2 offset:53248
    ds_read_b64_tr_b16 v[152:153], v6 offset:32768
    ds_read_b64_tr_b16 v[154:155], v6 offset:33280
    ds_read_b128 v[140:143], v3 offset:54272
    ds_read_b64_tr_b16 v[156:157], v7 offset:32768
    ds_read_b64_tr_b16 v[158:159], v7 offset:33280
    s_waitcnt lgkmcnt(0)
    v_mfma_f32_16x16x32_bf16 v[64:67], v[128:131], v[144:147], 0
    ds_read_b128 v[164:167], v3 offset:49152
    v_mfma_f32_16x16x32_bf16 v[68:71], v[128:131], v[148:151], 0
    ds_read_b64_tr_b16 v[180:181], v4 offset:36864
    v_mfma_f32_16x16x32_bf16 v[72:75], v[128:131], v[152:155], 0
    ds_read_b64_tr_b16 v[182:183], v4 offset:37376
    v_mfma_f32_16x16x32_bf16 v[76:79], v[128:131], v[156:159], 0
    ds_read_b128 v[168:171], v2 offset:50176
    v_mfma_f32_16x16x32_bf16 v[92:95], v[132:135], v[156:159], 0
    ds_read_b64_tr_b16 v[184:185], v5 offset:36864
    v_mfma_f32_16x16x32_bf16 v[88:91], v[132:135], v[152:155], 0
    ds_read_b64_tr_b16 v[186:187], v5 offset:37376
    v_mfma_f32_16x16x32_bf16 v[84:87], v[132:135], v[148:151], 0
    ds_read_b128 v[172:175], v3 offset:53248
    v_mfma_f32_16x16x32_bf16 v[80:83], v[132:135], v[144:147], 0
    ds_read_b64_tr_b16 v[188:189], v6 offset:36864
    v_mfma_f32_16x16x32_bf16 v[96:99], v[136:139], v[144:147], 0
    ds_read_b64_tr_b16 v[190:191], v6 offset:37376
    v_mfma_f32_16x16x32_bf16 v[100:103], v[136:139], v[148:151], 0
    ds_read_b128 v[176:179], v2 offset:54272
    v_mfma_f32_16x16x32_bf16 v[104:107], v[136:139], v[152:155], 0
    ds_read_b64_tr_b16 v[192:193], v7 offset:36864
    v_mfma_f32_16x16x32_bf16 v[108:111], v[136:139], v[156:159], 0
    ds_read_b64_tr_b16 v[194:195], v7 offset:37376
    v_mfma_f32_16x16x32_bf16 v[124:127], v[140:143], v[156:159], 0
    v_mfma_f32_16x16x32_bf16 v[120:123], v[140:143], v[152:155], 0
    v_mfma_f32_16x16x32_bf16 v[116:119], v[140:143], v[148:151], 0
    v_mfma_f32_16x16x32_bf16 v[112:115], v[140:143], v[144:147], 0
    s_waitcnt lgkmcnt(0)
    v_mfma_f32_16x16x32_bf16 v[64:67], v[164:167], v[180:183], v[64:67]
    v_mfma_f32_16x16x32_bf16 v[68:71], v[164:167], v[184:187], v[68:71]
    v_mfma_f32_16x16x32_bf16 v[72:75], v[164:167], v[188:191], v[72:75]
    v_mfma_f32_16x16x32_bf16 v[76:79], v[164:167], v[192:195], v[76:79]
    v_mfma_f32_16x16x32_bf16 v[92:95], v[168:171], v[192:195], v[92:95]
    v_mfma_f32_16x16x32_bf16 v[88:91], v[168:171], v[188:191], v[88:91]
    v_mfma_f32_16x16x32_bf16 v[84:87], v[168:171], v[184:187], v[84:87]
    v_mfma_f32_16x16x32_bf16 v[80:83], v[168:171], v[180:183], v[80:83]
    s_waitcnt vmcnt(0)
    s_barrier
    v_mfma_f32_16x16x32_bf16 v[96:99], v[172:175], v[180:183], v[96:99]
    ds_read_b128 v[128:131], v2 offset:0
    ds_read_b64_tr_b16 v[144:145], v4 offset:49152
    v_mfma_f32_16x16x32_bf16 v[100:103], v[172:175], v[184:187], v[100:103]
    ds_read_b64_tr_b16 v[146:147], v4 offset:49664
    ds_read_b128 v[132:135], v3 offset:1024
    v_mfma_f32_16x16x32_bf16 v[104:107], v[172:175], v[188:191], v[104:107]
    ds_read_b64_tr_b16 v[148:149], v5 offset:49152
    ds_read_b64_tr_b16 v[150:151], v5 offset:49664
    v_mfma_f32_16x16x32_bf16 v[108:111], v[172:175], v[192:195], v[108:111]
    ds_read_b128 v[136:139], v2 offset:4096
    ds_read_b64_tr_b16 v[152:153], v6 offset:49152
    v_mfma_f32_16x16x32_bf16 v[124:127], v[176:179], v[192:195], v[124:127]
    ds_read_b64_tr_b16 v[154:155], v6 offset:49664
    ds_read_b128 v[140:143], v3 offset:5120
    v_mfma_f32_16x16x32_bf16 v[120:123], v[176:179], v[188:191], v[120:123]
    ds_read_b64_tr_b16 v[156:157], v7 offset:49152
    ds_read_b64_tr_b16 v[158:159], v7 offset:49664
    v_mfma_f32_16x16x32_bf16 v[116:119], v[176:179], v[184:187], v[116:119]
    v_mfma_f32_16x16x32_bf16 v[112:115], v[176:179], v[180:183], v[112:115]
    s_waitcnt lgkmcnt(0)
    s_cmp_lg_u32 s40, 0
    s_cbranch_scc1 L_side_12
    s_mov_b32 exec_hi, 0xff
    buffer_store_dwordx4 v[32:35], v243, s[12:15], s88 offen offset:0 sc1
    buffer_store_dwordx4 v[36:39], v243, s[12:15], s88 offen offset:640 sc1
    s_mov_b64 exec, -1
L_side_12:
    v_mfma_f32_16x16x32_bf16 v[64:67], v[128:131], v[144:147], v[64:67]
    ds_read_b128 v[164:167], v3 offset:0
    v_mfma_f32_16x16x32_bf16 v[68:71], v[128:131], v[148:151], v[68:71]
    ds_read_b64_tr_b16 v[180:181], v4 offset:53248
    v_mfma_f32_16x16x32_bf16 v[72:75], v[128:131], v[152:155], v[72:75]
    ds_read_b64_tr_b16 v[182:183], v4 offset:53760
    v_mfma_f32_16x16x32_bf16 v[76:79], v[128:131], v[156:159], v[76:79]
    ds_read_b128 v[168:171], v2 offset:1024
    v_mfma_f32_16x16x32_bf16 v[92:95], v[132:135], v[156:159], v[92:95]
    ds_read_b64_tr_b16 v[184:185], v5 offset:53248
    v_mfma_f32_16x16x32_bf16 v[88:91], v[132:135], v[152:155], v[88:91]
    ds_read_b64_tr_b16 v[186:187], v5 offset:53760
    v_mfma_f32_16x16x32_bf16 v[84:87], v[132:135], v[148:151], v[84:87]
    ds_read_b128 v[172:175], v3 offset:4096
    v_mfma_f32_16x16x32_bf16 v[80:83], v[132:135], v[144:147], v[80:83]
    ds_read_b64_tr_b16 v[188:189], v6 offset:53248
    v_mfma_f32_16x16x32_bf16 v[96:99], v[136:139], v[144:147], v[96:99]
    ds_read_b64_tr_b16 v[190:191], v6 offset:53760
    v_mfma_f32_16x16x32_bf16 v[100:103], v[136:139], v[148:151], v[100:103]
    ds_read_b128 v[176:179], v2 offset:5120
    v_mfma_f32_16x16x32_bf16 v[104:107], v[136:139], v[152:155], v[104:107]
    ds_read_b64_tr_b16 v[192:193], v7 offset:53248
    v_mfma_f32_16x16x32_bf16 v[108:111], v[136:139], v[156:159], v[108:111]
    ds_read_b64_tr_b16 v[194:195], v7 offset:53760
    v_mfma_f32_16x16x32_bf16 v[124:127], v[140:143], v[156:159], v[124:127]
    v_mfma_f32_16x16x32_bf16 v[120:123], v[140:143], v[152:155], v[120:123]
    v_mfma_f32_16x16x32_bf16 v[116:119], v[140:143], v[148:151], v[116:119]
    v_mfma_f32_16x16x32_bf16 v[112:115], v[140:143], v[144:147], v[112:115]
    s_waitcnt lgkmcnt(0)
    v_mfma_f32_16x16x32_bf16 v[64:67], v[164:167], v[180:183], v[64:67]
    v_mfma_f32_16x16x32_bf16 v[68:71], v[164:167], v[184:187], v[68:71]
    v_mfma_f32_16x16x32_bf16 v[72:75], v[164:167], v[188:191], v[72:75]
    v_mfma_f32_16x16x32_bf16 v[76:79], v[164:167], v[192:195], v[76:79]
    v_mfma_f32_16x16x32_bf16 v[92:95], v[168:171], v[192:195], v[92:95]
    v_mfma_f32_16x16x32_bf16 v[88:91], v[168:171], v[188:191], v[88:91]
    v_mfma_f32_16x16x32_bf16 v[84:87], v[168:171], v[184:187], v[84:87]
    v_mfma_f32_16x16x32_bf16 v[80:83], v[168:171], v[180:183], v[80:83]
    s_cmp_lg_u32 s40, 0
    s_cbranch_scc1 L_side_13
    s_mov_b32 exec_hi, 0xff
    buffer_store_dwordx4 v[60:63], v243, s[12:15], s88 offen offset:1280 sc1
    buffer_store_dwordx4 v[204:207], v243, s[12:15], s88 offen offset:1920 sc1
    s_mov_b64 exec, -1
L_side_13:
    s_barrier
    v_mfma_f32_16x16x32_bf16 v[96:99], v[172:175], v[180:183], v[96:99]
    ds_read_b128 v[128:131], v2 offset:16384
    ds_read_b64_tr_b16 v[144:145], v4 offset:0
    v_mfma_f32_16x16x32_bf16 v[100:103], v[172:175], v[184:187], v[100:103]
    ds_read_b64_tr_b16 v[146:147], v4 offset:512
    ds_read_b128 v[132:135], v3 offset:17408
    v_mfma_f32_16x16x32_bf16 v[104:107], v[172:175], v[188:191], v[104:107]
    ds_read_b64_tr_b16 v[148:149], v5 offset:0
    ds_read_b64_tr_b16 v[150:151], v5 offset:512
    v_mfma_f32_16x16x32_bf16 v[108:111], v[172:175], v[192:195], v[108:111]
    ds_read_b128 v[136:139], v2 offset:20480
    ds_read_b64_tr_b16 v[152:153], v6 offset:0
    v_mfma_f32_16x16x32_bf16 v[124:127], v[176:179], v[192:195], v[124:127]
    ds_read_b64_tr_b16 v[154:155], v6 offset:512
    ds_read_b128 v[140:143], v3 offset:21504
    v_mfma_f32_16x16x32_bf16 v[120:123], v[176:179], v[188:191], v[120:123]
    ds_read_b64_tr_b16 v[156:157], v7 offset:0
    ds_read_b64_tr_b16 v[158:159], v7 offset:512
    v_mfma_f32_16x16x32_bf16 v[116:119], v[176:179], v[184:187], v[116:119]
    v_mfma_f32_16x16x32_bf16 v[112:115], v[176:179], v[180:183], v[112:115]
    s_waitcnt lgkmcnt(0)
    s_cmp_lg_u32 s40, 0
    s_cbranch_scc1 L_side_14
    s_mov_b32 exec_hi, 0xff
    buffer_store_dwordx4 v[252:255], v243, s[12:15], s88 offen offset:2560 sc1
    s_mov_b64 exec, -1
L_side_14:
    v_mfma_f32_16x16x32_bf16 v[64:67], v[128:131], v[144:147], v[64:67]
    ds_read_b128 v[164:167], v3 offset:16384
    v_mfma_f32_16x16x32_bf16 v[68:71], v[128:131], v[148:151], v[68:71]
    ds_read_b64_tr_b16 v[180:181], v4 offset:4096
    v_mfma_f32_16x16x32_bf16 v[72:75], v[128:131], v[152:155], v[72:75]
    ds_read_b64_tr_b16 v[182:183], v4 offset:4608
    v_mfma_f32_16x16x32_bf16 v[76:79], v[128:131], v[156:159], v[76:79]
    ds_read_b128 v[168:171], v2 offset:17408
    v_mfma_f32_16x16x32_bf16 v[92:95], v[132:135], v[156:159], v[92:95]
    ds_read_b64_tr_b16 v[184:185], v5 offset:4096
    v_mfma_f32_16x16x32_bf16 v[88:91], v[132:135], v[152:155], v[88:91]
    ds_read_b64_tr_b16 v[186:187], v5 offset:4608
    v_mfma_f32_16x16x32_bf16 v[84:87], v[132:135], v[148:151], v[84:87]
    ds_read_b128 v[172:175], v3 offset:20480
    v_mfma_f32_16x16x32_bf16 v[80:83], v[132:135], v[144:147], v[80:83]
    ds_read_b64_tr_b16 v[188:189], v6 offset:4096
    v_mfma_f32_16x16x32_bf16 v[96:99], v[136:139], v[144:147], v[96:99]
    ds_read_b64_tr_b16 v[190:191], v6 offset:4608
    v_mfma_f32_16x16x32_bf16 v[100:103], v[136:139], v[148:151], v[100:103]
    ds_read_b128 v[176:179], v2 offset:21504
    v_mfma_f32_16x16x32_bf16 v[104:107], v[136:139], v[152:155], v[104:107]
    ds_read_b64_tr_b16 v[192:193], v7 offset:4096
    v_mfma_f32_16x16x32_bf16 v[108:111], v[136:139], v[156:159], v[108:111]
    ds_read_b64_tr_b16 v[194:195], v7 offset:4608
    v_mfma_f32_16x16x32_bf16 v[124:127], v[140:143], v[156:159], v[124:127]
    v_mfma_f32_16x16x32_bf16 v[120:123], v[140:143], v[152:155], v[120:123]
    v_mfma_f32_16x16x32_bf16 v[116:119], v[140:143], v[148:151], v[116:119]
    v_mfma_f32_16x16x32_bf16 v[112:115], v[140:143], v[144:147], v[112:115]
    s_waitcnt lgkmcnt(0)
    v_mfma_f32_16x16x32_bf16 v[64:67], v[164:167], v[180:183], v[64:67]
    v_mfma_f32_16x16x32_bf16 v[68:71], v[164:167], v[184:187], v[68:71]
    v_mfma_f32_16x16x32_bf16 v[72:75], v[164:167], v[188:191], v[72:75]
    v_mfma_f32_16x16x32_bf16 v[76:79], v[164:167], v[192:195], v[76:79]
    v_mfma_f32_16x16x32_bf16 v[92:95], v[168:171], v[192:195], v[92:95]
    v_mfma_f32_16x16x32_bf16 v[88:91], v[168:171], v[188:191], v[88:91]
    v_mfma_f32_16x16x32_bf16 v[84:87], v[168:171], v[184:187], v[84:87]
    v_mfma_f32_16x16x32_bf16 v[80:83], v[168:171], v[180:183], v[80:83]
    s_barrier
    v_mfma_f32_16x16x32_bf16 v[96:99], v[172:175], v[180:183], v[96:99]
    ds_read_b128 v[128:131], v2 offset:32768
    ds_read_b64_tr_b16 v[144:145], v4 offset:16384
    v_mfma_f32_16x16x32_bf16 v[100:103], v[172:175], v[184:187], v[100:103]
    ds_read_b64_tr_b16 v[146:147], v4 offset:16896
    ds_read_b128 v[132:135], v3 offset:33792
    v_mfma_f32_16x16x32_bf16 v[104:107], v[172:175], v[188:191], v[104:107]
    ds_read_b64_tr_b16 v[148:149], v5 offset:16384
    ds_read_b64_tr_b16 v[150:151], v5 offset:16896
    v_mfma_f32_16x16x32_bf16 v[108:111], v[172:175], v[192:195], v[108:111]
    ds_read_b128 v[136:139], v2 offset:36864
    ds_read_b64_tr_b16 v[152:153], v6 offset:16384
    v_mfma_f32_16x16x32_bf16 v[124:127], v[176:179], v[192:195], v[124:127]
    ds_read_b64_tr_b16 v[154:155], v6 offset:16896
    ds_read_b128 v[140:143], v3 offset:37888
    v_mfma_f32_16x16x32_bf16 v[120:123], v[176:179], v[188:191], v[120:123]
    ds_read_b64_tr_b16 v[156:157], v7 offset:16384
    ds_read_b64_tr_b16 v[158:159], v7 offset:16896
    v_mfma_f32_16x16x32_bf16 v[116:119], v[176:179], v[184:187], v[116:119]
    v_mfma_f32_16x16x32_bf16 v[112:115], v[176:179], v[180:183], v[112:115]
    s_waitcnt lgkmcnt(0)
    s_cmp_lg_u32 s40, 0
    s_cbranch_scc1 L_side_15
    buffer_load_dword v48, v49, s[36:39], 0 offen sc1
L_side_15:
    v_mfma_f32_16x16x32_bf16 v[64:67], v[128:131], v[144:147], v[64:67]
    ds_read_b128 v[164:167], v3 offset:32768
    v_mfma_f32_16x16x32_bf16 v[68:71], v[128:131], v[148:151], v[68:71]
    ds_read_b64_tr_b16 v[180:181], v4 offset:20480
    v_mfma_f32_16x16x32_bf16 v[72:75], v[128:131], v[152:155], v[72:75]
    ds_read_b64_tr_b16 v[182:183], v4 offset:20992
    v_mfma_f32_16x16x32_bf16 v[76:79], v[128:131], v[156:159], v[76:79]
    ds_read_b128 v[168:171], v2 offset:33792
    v_mfma_f32_16x16x32_bf16 v[92:95], v[132:135], v[156:159], v[92:95]
    ds_read_b64_tr_b16 v[184:185], v5 offset:20480
    v_mfma_f32_16x16x32_bf16 v[88:91], v[132:135], v[152:155], v[88:91]
    ds_read_b64_tr_b16 v[186:187], v5 offset:20992
    v_mfma_f32_16x16x32_bf16 v[84:87], v[132:135], v[148:151], v[84:87]
    ds_read_b128 v[172:175], v3 offset:36864
    v_mfma_f32_16x16x32_bf16 v[80:83], v[132:135], v[144:147], v[80:83]
    ds_read_b64_tr_b16 v[188:189], v6 offset:20480
    v_mfma_f32_16x16x32_bf16 v[96:99], v[136:139], v[144:147], v[96:99]
    ds_read_b64_tr_b16 v[190:191], v6 offset:20992
    v_mfma_f32_16x16x32_bf16 v[100:103], v[136:139], v[148:151], v[100:103]
    ds_read_b128 v[176:179], v2 offset:37888
    v_mfma_f32_16x16x32_bf16 v[104:107], v[136:139], v[152:155], v[104:107]
    ds_read_b64_tr_b16 v[192:193], v7 offset:20480
    v_mfma_f32_16x16x32_bf16 v[108:111], v[136:139], v[156:159], v[108:111]
    ds_read_b64_tr_b16 v[194:195], v7 offset:20992
    v_mfma_f32_16x16x32_bf16 v[124:127], v[140:143], v[156:159], v[124:127]
    v_mfma_f32_16x16x32_bf16 v[120:123], v[140:143], v[152:155], v[120:123]
    v_mfma_f32_16x16x32_bf16 v[116:119], v[140:143], v[148:151], v[116:119]
    v_mfma_f32_16x16x32_bf16 v[112:115], v[140:143], v[144:147], v[112:115]
    s_waitcnt lgkmcnt(0)
    v_mfma_f32_16x16x32_bf16 v[64:67], v[164:167], v[180:183], v[64:67]
    v_mfma_f32_16x16x32_bf16 v[68:71], v[164:167], v[184:187], v[68:71]
    v_mfma_f32_16x16x32_bf16 v[72:75], v[164:167], v[188:191], v[72:75]
    v_mfma_f32_16x16x32_bf16 v[76:79], v[164:167], v[192:195], v[76:79]
    v_mfma_f32_16x16x32_bf16 v[92:95], v[168:171], v[192:195], v[92:95]
    v_mfma_f32_16x16x32_bf16 v[88:91], v[168:171], v[188:191], v[88:91]
    v_mfma_f32_16x16x32_bf16 v[84:87], v[168:171], v[184:187], v[84:87]
    v_mfma_f32_16x16x32_bf16 v[80:83], v[168:171], v[180:183], v[80:83]
    s_barrier
    v_mfma_f32_16x16x32_bf16 v[96:99], v[172:175], v[180:183], v[96:99]
    ds_read_b128 v[128:131], v2 offset:49152
    ds_read_b64_tr_b16 v[144:145], v4 offset:32768
    v_mfma_f32_16x16x32_bf16 v[100:103], v[172:175], v[184:187], v[100:103]
    ds_read_b64_tr_b16 v[146:147], v4 offset:33280
    ds_read_b128 v[132:135], v3 offset:50176
    v_mfma_f32_16x16x32_bf16 v[104:107], v[172:175], v[188:191], v[104:107]
    ds_read_b64_tr_b16 v[148:149], v5 offset:32768
    ds_read_b64_tr_b16 v[150:151], v5 offset:33280
    v_mfma_f32_16x16x32_bf16 v[108:111], v[172:175], v[192:195], v[108:111]
    ds_read_b128 v[136:139], v2 offset:53248
    ds_read_b64_tr_b16 v[152:153], v6 offset:32768
    v_mfma_f32_16x16x32_bf16 v[124:127], v[176:179], v[192:195], v[124:127]
    ds_read_b64_tr_b16 v[154:155], v6 offset:33280
    ds_read_b128 v[140:143], v3 offset:54272
    v_mfma_f32_16x16x32_bf16 v[120:123], v[176:179], v[188:191], v[120:123]
    ds_read_b64_tr_b16 v[156:157], v7 offset:32768
    ds_read_b64_tr_b16 v[158:159], v7 offset:33280
    v_mfma_f32_16x16x32_bf16 v[116:119], v[176:179], v[184:187], v[116:119]
    v_mfma_f32_16x16x32_bf16 v[112:115], v[176:179], v[180:183], v[112:115]
    s_waitcnt lgkmcnt(0)
    v_mfma_f32_16x16x32_bf16 v[64:67], v[128:131], v[144:147], v[64:67]
    ds_read_b128 v[164:167], v3 offset:49152
    v_mfma_f32_16x16x32_bf16 v[68:71], v[128:131], v[148:151], v[68:71]
    ds_read_b64_tr_b16 v[180:181], v4 offset:36864
    v_mfma_f32_16x16x32_bf16 v[72:75], v[128:131], v[152:155], v[72:75]
    ds_read_b64_tr_b16 v[182:183], v4 offset:37376
    v_mfma_f32_16x16x32_bf16 v[76:79], v[128:131], v[156:159], v[76:79]
    ds_read_b128 v[168:171], v2 offset:50176
    v_mfma_f32_16x16x32_bf16 v[92:95], v[132:135], v[156:159], v[92:95]
    ds_read_b64_tr_b16 v[184:185], v5 offset:36864
    v_mfma_f32_16x16x32_bf16 v[88:91], v[132:135], v[152:155], v[88:91]
    ds_read_b64_tr_b16 v[186:187], v5 offset:37376
    v_mfma_f32_16x16x32_bf16 v[84:87], v[132:135], v[148:151], v[84:87]
    ds_read_b128 v[172:175], v3 offset:53248
    v_mfma_f32_16x16x32_bf16 v[80:83], v[132:135], v[144:147], v[80:83]
    ds_read_b64_tr_b16 v[188:189], v6 offset:36864
    v_mfma_f32_16x16x32_bf16 v[96:99], v[136:139], v[144:147], v[96:99]
    ds_read_b64_tr_b16 v[190:191], v6 offset:37376
    v_mfma_f32_16x16x32_bf16 v[100:103], v[136:139], v[148:151], v[100:103]
    ds_read_b128 v[176:179], v2 offset:54272
    v_mfma_f32_16x16x32_bf16 v[104:107], v[136:139], v[152:155], v[104:107]
    ds_read_b64_tr_b16 v[192:193], v7 offset:36864
    v_mfma_f32_16x16x32_bf16 v[108:111], v[136:139], v[156:159], v[108:111]
    ds_read_b64_tr_b16 v[194:195], v7 offset:37376
    v_mfma_f32_16x16x32_bf16 v[124:127], v[140:143], v[156:159], v[124:127]
    v_mfma_f32_16x16x32_bf16 v[120:123], v[140:143], v[152:155], v[120:123]
    v_mfma_f32_16x16x32_bf16 v[116:119], v[140:143], v[148:151], v[116:119]
    v_mfma_f32_16x16x32_bf16 v[112:115], v[140:143], v[144:147], v[112:115]
    s_waitcnt lgkmcnt(0)
    v_mfma_f32_16x16x32_bf16 v[64:67], v[164:167], v[180:183], v[64:67]
    v_mfma_f32_16x16x32_bf16 v[68:71], v[164:167], v[184:187], v[68:71]
    v_mfma_f32_16x16x32_bf16 v[72:75], v[164:167], v[188:191], v[72:75]
    v_mfma_f32_16x16x32_bf16 v[76:79], v[164:167], v[192:195], v[76:79]
    v_mfma_f32_16x16x32_bf16 v[92:95], v[168:171], v[192:195], v[92:95]
    v_mfma_f32_16x16x32_bf16 v[88:91], v[168:171], v[188:191], v[88:91]
    v_mfma_f32_16x16x32_bf16 v[84:87], v[168:171], v[184:187], v[84:87]
    v_mfma_f32_16x16x32_bf16 v[80:83], v[168:171], v[180:183], v[80:83]
    s_cmp_lg_u32 s40, 0
    s_cbranch_scc1 L_side_16
    s_mov_b32 s90, 0
    s_branch L_polle_19
L_poll_17:
    buffer_load_dword v48, v49, s[36:39], 0 offen sc1
L_polle_19:
    s_add_u32 s90, s90, 1
    s_cmp_gt_u32 s90, 200000
    s_waitcnt vmcnt(0)
    s_cbranch_scc1 L_polld_18
    v_cmp_eq_u32 vcc, 0, v48
    s_cbranch_vccnz L_poll_17
L_polld_18:
    s_add_u32 s58, s100, s42
    s_lshl_b32 s59, s2, 7
    s_add_u32 s59, s59, 11010048
    s_add_u32 s60, s59, 196608
    s_mov_b64 exec, 1
    buffer_store_byte v51, v49, s[12:15], s58 offen
    buffer_store_dword v51, v49, s[12:15], s60 offen sc1
    s_mov_b64 exec, 7
    buffer_load_dword v48, v50, s[12:15], s59 offen sc1
    s_mov_b64 exec, -1
L_side_16:
    s_barrier
    v_mfma_f32_16x16x32_bf16 v[96:99], v[172:175], v[180:183], v[96:99]
    ds_read_b128 v[128:131], v2 offset:0
    ds_read_b64_tr_b16 v[144:145], v4 offset:49152
    v_mfma_f32_16x16x32_bf16 v[100:103], v[172:175], v[184:187], v[100:103]
    ds_read_b64_tr_b16 v[146:147], v4 offset:49664
    ds_read_b128 v[132:135], v3 offset:1024
    v_mfma_f32_16x16x32_bf16 v[104:107], v[172:175], v[188:191], v[104:107]
    ds_read_b64_tr_b16 v[148:149], v5 offset:49152
    ds_read_b64_tr_b16 v[150:151], v5 offset:49664
    v_mfma_f32_16x16x32_bf16 v[108:111], v[172:175], v[192:195], v[108:111]
    ds_read_b128 v[136:139], v2 offset:4096
    ds_read_b64_tr_b16 v[152:153], v6 offset:49152
    v_mfma_f32_16x16x32_bf16 v[124:127], v[176:179], v[192:195], v[124:127]
    ds_read_b64_tr_b16 v[154:155], v6 offset:49664
    ds_read_b128 v[140:143], v3 offset:5120
    v_mfma_f32_16x16x32_bf16 v[120:123], v[176:179], v[188:191], v[120:123]
    ds_read_b64_tr_b16 v[156:157], v7 offset:49152
    ds_read_b64_tr_b16 v[158:159], v7 offset:49664
    v_mfma_f32_16x16x32_bf16 v[116:119], v[176:179], v[184:187], v[116:119]
    v_mfma_f32_16x16x32_bf16 v[112:115], v[176:179], v[180:183], v[112:115]
    s_waitcnt lgkmcnt(0)
    v_mfma_f32_16x16x32_bf16 v[64:67], v[128:131], v[144:147], v[64:67]
    ds_read_b128 v[164:167], v3 offset:0
    v_mfma_f32_16x16x32_bf16 v[68:71], v[128:131], v[148:151], v[68:71]
    ds_read_b64_tr_b16 v[180:181], v4 offset:53248
    v_mfma_f32_16x16x32_bf16 v[72:75], v[128:131], v[152:155], v[72:75]
    ds_read_b64_tr_b16 v[182:183], v4 offset:53760
    v_mfma_f32_16x16x32_bf16 v[76:79], v[128:131], v[156:159], v[76:79]
    ds_read_b128 v[168:171], v2 offset:1024
    v_mfma_f32_16x16x32_bf16 v[92:95], v[132:135], v[156:159], v[92:95]
    ds_read_b64_tr_b16 v[184:185], v5 offset:53248
    v_mfma_f32_16x16x32_bf16 v[88:91], v[132:135], v[152:155], v[88:91]
    ds_read_b64_tr_b16 v[186:187], v5 offset:53760
    v_mfma_f32_16x16x32_bf16 v[84:87], v[132:135], v[148:151], v[84:87]
    ds_read_b128 v[172:175], v3 offset:4096
    v_mfma_f32_16x16x32_bf16 v[80:83], v[132:135], v[144:147], v[80:83]
    ds_read_b64_tr_b16 v[188:189], v6 offset:53248
    v_mfma_f32_16x16x32_bf16 v[96:99], v[136:139], v[144:147], v[96:99]
    ds_read_b64_tr_b16 v[190:191], v6 offset:53760
    v_mfma_f32_16x16x32_bf16 v[100:103], v[136:139], v[148:151], v[100:103]
    ds_read_b128 v[176:179], v2 offset:5120
    v_mfma_f32_16x16x32_bf16 v[104:107], v[136:139], v[152:155], v[104:107]
    ds_read_b64_tr_b16 v[192:193], v7 offset:53248
    v_mfma_f32_16x16x32_bf16 v[108:111], v[136:139], v[156:159], v[108:111]
    ds_read_b64_tr_b16 v[194:195], v7 offset:53760
    v_mfma_f32_16x16x32_bf16 v[124:127], v[140:143], v[156:159], v[124:127]
    v_mfma_f32_16x16x32_bf16 v[120:123], v[140:143], v[152:155], v[120:123]
    v_mfma_f32_16x16x32_bf16 v[116:119], v[140:143], v[148:151], v[116:119]
    v_mfma_f32_16x16x32_bf16 v[112:115], v[140:143], v[144:147], v[112:115]
    s_waitcnt lgkmcnt(0)
    v_mfma_f32_16x16x32_bf16 v[64:67], v[164:167], v[180:183], v[64:67]
    v_mfma_f32_16x16x32_bf16 v[68:71], v[164:167], v[184:187], v[68:71]
    v_mfma_f32_16x16x32_bf16 v[72:75], v[164:167], v[188:191], v[72:75]
    v_mfma_f32_16x16x32_bf16 v[76:79], v[164:167], v[192:195], v[76:79]
    v_mfma_f32_16x16x32_bf16 v[92:95], v[168:171], v[192:195], v[92:95]
    v_mfma_f32_16x16x32_bf16 v[88:91], v[168:171], v[188:191], v[88:91]
    v_mfma_f32_16x16x32_bf16 v[84:87], v[168:171], v[184:187], v[84:87]
    v_mfma_f32_16x16x32_bf16 v[80:83], v[168:171], v[180:183], v[80:83]
    s_barrier
    v_mfma_f32_16x16x32_bf16 v[96:99], v[172:175], v[180:183], v[96:99]
    ds_read_b128 v[128:131], v2 offset:16384
    ds_read_b64_tr_b16 v[144:145], v4 offset:0
    v_mfma_f32_16x16x32_bf16 v[100:103], v[172:175], v[184:187], v[100:103]
    ds_read_b64_tr_b16 v[146:147], v4 offset:512
    ds_read_b128 v[132:135], v3 offset:17408
    v_mfma_f32_16x16x32_bf16 v[104:107], v[172:175], v[188:191], v[104:107]
    ds_read_b64_tr_b16 v[148:149], v5 offset:0
    ds_read_b64_tr_b16 v[150:151], v5 offset:512
    v_mfma_f32_16x16x32_bf16 v[108:111], v[172:175], v[192:195], v[108:111]
    ds_read_b128 v[136:139], v2 offset:20480
    ds_read_b64_tr_b16 v[152:153], v6 offset:0
    v_mfma_f32_16x16x32_bf16 v[124:127], v[176:179], v[192:195], v[124:127]
    ds_read_b64_tr_b16 v[154:155], v6 offset:512
    ds_read_b128 v[140:143], v3 offset:21504
    v_mfma_f32_16x16x32_bf16 v[120:123], v[176:179], v[188:191], v[120:123]
    ds_read_b64_tr_b16 v[156:157], v7 offset:0
    ds_read_b64_tr_b16 v[158:159], v7 offset:512
    v_mfma_f32_16x16x32_bf16 v[116:119], v[176:179], v[184:187], v[116:119]
    v_mfma_f32_16x16x32_bf16 v[112:115], v[176:179], v[180:183], v[112:115]
    s_waitcnt lgkmcnt(0)
    v_mfma_f32_16x16x32_bf16 v[64:67], v[128:131], v[144:147], v[64:67]
    ds_read_b128 v[164:167], v3 offset:16384
    v_mfma_f32_16x16x32_bf16 v[68:71], v[128:131], v[148:151], v[68:71]
    ds_read_b64_tr_b16 v[180:181], v4 offset:4096
    v_mfma_f32_16x16x32_bf16 v[72:75], v[128:131], v[152:155], v[72:75]
    ds_read_b64_tr_b16 v[182:183], v4 offset:4608
    v_mfma_f32_16x16x32_bf16 v[76:79], v[128:131], v[156:159], v[76:79]
    ds_read_b128 v[168:171], v2 offset:17408
    v_mfma_f32_16x16x32_bf16 v[92:95], v[132:135], v[156:159], v[92:95]
    ds_read_b64_tr_b16 v[184:185], v5 offset:4096
    v_mfma_f32_16x16x32_bf16 v[88:91], v[132:135], v[152:155], v[88:91]
    ds_read_b64_tr_b16 v[186:187], v5 offset:4608
    v_mfma_f32_16x16x32_bf16 v[84:87], v[132:135], v[148:151], v[84:87]
    ds_read_b128 v[172:175], v3 offset:20480
    v_mfma_f32_16x16x32_bf16 v[80:83], v[132:135], v[144:147], v[80:83]
    ds_read_b64_tr_b16 v[188:189], v6 offset:4096
    v_mfma_f32_16x16x32_bf16 v[96:99], v[136:139], v[144:147], v[96:99]
    ds_read_b64_tr_b16 v[190:191], v6 offset:4608
    v_mfma_f32_16x16x32_bf16 v[100:103], v[136:139], v[148:151], v[100:103]
    ds_read_b128 v[176:179], v2 offset:21504
    v_mfma_f32_16x16x32_bf16 v[104:107], v[136:139], v[152:155], v[104:107]
    ds_read_b64_tr_b16 v[192:193], v7 offset:4096
    v_mfma_f32_16x16x32_bf16 v[108:111], v[136:139], v[156:159], v[108:111]
    ds_read_b64_tr_b16 v[194:195], v7 offset:4608
    v_mfma_f32_16x16x32_bf16 v[124:127], v[140:143], v[156:159], v[124:127]
    v_mfma_f32_16x16x32_bf16 v[120:123], v[140:143], v[152:155], v[120:123]
    v_mfma_f32_16x16x32_bf16 v[116:119], v[140:143], v[148:151], v[116:119]
    v_mfma_f32_16x16x32_bf16 v[112:115], v[140:143], v[144:147], v[112:115]
    s_waitcnt lgkmcnt(0)
    v_mfma_f32_16x16x32_bf16 v[64:67], v[164:167], v[180:183], v[64:67]
    v_mfma_f32_16x16x32_bf16 v[68:71], v[164:167], v[184:187], v[68:71]
    v_mfma_f32_16x16x32_bf16 v[72:75], v[164:167], v[188:191], v[72:75]
    v_mfma_f32_16x16x32_bf16 v[76:79], v[164:167], v[192:195], v[76:79]
    v_mfma_f32_16x16x32_bf16 v[92:95], v[168:171], v[192:195], v[92:95]
    v_mfma_f32_16x16x32_bf16 v[88:91], v[168:171], v[188:191], v[88:91]
    v_mfma_f32_16x16x32_bf16 v[84:87], v[168:171], v[184:187], v[84:87]
    v_mfma_f32_16x16x32_bf16 v[80:83], v[168:171], v[180:183], v[80:83]
    s_barrier
    v_mfma_f32_16x16x32_bf16 v[96:99], v[172:175], v[180:183], v[96:99]
    ds_read_b128 v[128:131], v2 offset:32768
    ds_read_b64_tr_b16 v[144:145], v4 offset:16384
    v_mfma_f32_16x16x32_bf16 v[100:103], v[172:175], v[184:187], v[100:103]
    ds_read_b64_tr_b16 v[146:147], v4 offset:16896
    ds_read_b128 v[132:135], v3 offset:33792
    v_mfma_f32_16x16x32_bf16 v[104:107], v[172:175], v[188:191], v[104:107]
    ds_read_b64_tr_b16 v[148:149], v5 offset:16384
    ds_read_b64_tr_b16 v[150:151], v5 offset:16896
    v_mfma_f32_16x16x32_bf16 v[108:111], v[172:175], v[192:195], v[108:111]
    ds_read_b128 v[136:139], v2 offset:36864
    ds_read_b64_tr_b16 v[152:153], v6 offset:16384
    v_mfma_f32_16x16x32_bf16 v[124:127], v[176:179], v[192:195], v[124:127]
    ds_read_b64_tr_b16 v[154:155], v6 offset:16896
    ds_read_b128 v[140:143], v3 offset:37888
    v_mfma_f32_16x16x32_bf16 v[120:123], v[176:179], v[188:191], v[120:123]
    ds_read_b64_tr_b16 v[156:157], v7 offset:16384
    ds_read_b64_tr_b16 v[158:159], v7 offset:16896
    v_mfma_f32_16x16x32_bf16 v[116:119], v[176:179], v[184:187], v[116:119]
    v_mfma_f32_16x16x32_bf16 v[112:115], v[176:179], v[180:183], v[112:115]
    s_waitcnt lgkmcnt(0)
    v_mfma_f32_16x16x32_bf16 v[64:67], v[128:131], v[144:147], v[64:67]
    ds_read_b128 v[164:167], v3 offset:32768
    v_mfma_f32_16x16x32_bf16 v[68:71], v[128:131], v[148:151], v[68:71]
    ds_read_b64_tr_b16 v[180:181], v4 offset:20480
    v_mfma_f32_16x16x32_bf16 v[72:75], v[128:131], v[152:155], v[72:75]
    ds_read_b64_tr_b16 v[182:183], v4 offset:20992
    v_mfma_f32_16x16x32_bf16 v[76:79], v[128:131], v[156:159], v[76:79]
    ds_read_b128 v[168:171], v2 offset:33792
    v_mfma_f32_16x16x32_bf16 v[92:95], v[132:135], v[156:159], v[92:95]
    ds_read_b64_tr_b16 v[184:185], v5 offset:20480
    v_mfma_f32_16x16x32_bf16 v[88:91], v[132:135], v[152:155], v[88:91]
    ds_read_b64_tr_b16 v[186:187], v5 offset:20992
    v_mfma_f32_16x16x32_bf16 v[84:87], v[132:135], v[148:151], v[84:87]
    ds_read_b128 v[172:175], v3 offset:36864
    v_mfma_f32_16x16x32_bf16 v[80:83], v[132:135], v[144:147], v[80:83]
    ds_read_b64_tr_b16 v[188:189], v6 offset:20480
    v_mfma_f32_16x16x32_bf16 v[96:99], v[136:139], v[144:147], v[96:99]
    ds_read_b64_tr_b16 v[190:191], v6 offset:20992
    v_mfma_f32_16x16x32_bf16 v[100:103], v[136:139], v[148:151], v[100:103]
    ds_read_b128 v[176:179], v2 offset:37888
    v_mfma_f32_16x16x32_bf16 v[104:107], v[136:139], v[152:155], v[104:107]
    ds_read_b64_tr_b16 v[192:193], v7 offset:20480
    v_mfma_f32_16x16x32_bf16 v[108:111], v[136:139], v[156:159], v[108:111]
    ds_read_b64_tr_b16 v[194:195], v7 offset:20992
    v_mfma_f32_16x16x32_bf16 v[124:127], v[140:143], v[156:159], v[124:127]
    v_mfma_f32_16x16x32_bf16 v[120:123], v[140:143], v[152:155], v[120:123]
    v_mfma_f32_16x16x32_bf16 v[116:119], v[140:143], v[148:151], v[116:119]
    v_mfma_f32_16x16x32_bf16 v[112:115], v[140:143], v[144:147], v[112:115]
    s_waitcnt lgkmcnt(0)
    v_mfma_f32_16x16x32_bf16 v[64:67], v[164:167], v[180:183], v[64:67]
    v_mfma_f32_16x16x32_bf16 v[68:71], v[164:167], v[184:187], v[68:71]
    v_mfma_f32_16x16x32_bf16 v[72:75], v[164:167], v[188:191], v[72:75]
    v_mfma_f32_16x16x32_bf16 v[76:79], v[164:167], v[192:195], v[76:79]
    v_mfma_f32_16x16x32_bf16 v[92:95], v[168:171], v[192:195], v[92:95]
    v_mfma_f32_16x16x32_bf16 v[88:91], v[168:171], v[188:191], v[88:91]
    v_mfma_f32_16x16x32_bf16 v[84:87], v[168:171], v[184:187], v[84:87]
    v_mfma_f32_16x16x32_bf16 v[80:83], v[168:171], v[180:183], v[80:83]
    buffer_load_dword v48, v49, s[12:15], s100 offen sc1
    s_barrier
    v_mfma_f32_16x16x32_bf16 v[96:99], v[172:175], v[180:183], v[96:99]
    ds_read_b128 v[128:131], v2 offset:49152
    ds_read_b64_tr_b16 v[144:145], v4 offset:32768
    v_mfma_f32_16x16x32_bf16 v[100:103], v[172:175], v[184:187], v[100:103]
    ds_read_b64_tr_b16 v[146:147], v4 offset:33280
    ds_read_b128 v[132:135], v3 offset:50176
    v_mfma_f32_16x16x32_bf16 v[104:107], v[172:175], v[188:191], v[104:107]
    ds_read_b64_tr_b16 v[148:149], v5 offset:32768
    ds_read_b64_tr_b16 v[150:151], v5 offset:33280
    v_mfma_f32_16x16x32_bf16 v[108:111], v[172:175], v[192:195], v[108:111]
    ds_read_b128 v[136:139], v2 offset:53248
    ds_read_b64_tr_b16 v[152:153], v6 offset:32768
    v_mfma_f32_16x16x32_bf16 v[124:127], v[176:179], v[192:195], v[124:127]
    ds_read_b64_tr_b16 v[154:155], v6 offset:33280
    ds_read_b128 v[140:143], v3 offset:54272
    v_mfma_f32_16x16x32_bf16 v[120:123], v[176:179], v[188:191], v[120:123]
    ds_read_b64_tr_b16 v[156:157], v7 offset:32768
    ds_read_b64_tr_b16 v[158:159], v7 offset:33280
    v_mfma_f32_16x16x32_bf16 v[116:119], v[176:179], v[184:187], v[116:119]
    v_mfma_f32_16x16x32_bf16 v[112:115], v[176:179], v[180:183], v[112:115]
    s_waitcnt lgkmcnt(0)
    v_mfma_f32_16x16x32_bf16 v[64:67], v[128:131], v[144:147], v[64:67]
    ds_read_b128 v[164:167], v3 offset:49152
    v_mfma_f32_16x16x32_bf16 v[68:71], v[128:131], v[148:151], v[68:71]
    ds_read_b64_tr_b16 v[180:181], v4 offset:36864
    v_mfma_f32_16x16x32_bf16 v[72:75], v[128:131], v[152:155], v[72:75]
    ds_read_b64_tr_b16 v[182:183], v4 offset:37376
    v_mfma_f32_16x16x32_bf16 v[76:79], v[128:131], v[156:159], v[76:79]
    ds_read_b128 v[168:171], v2 offset:50176
    v_mfma_f32_16x16x32_bf16 v[92:95], v[132:135], v[156:159], v[92:95]
    ds_read_b64_tr_b16 v[184:185], v5 offset:36864
    v_mfma_f32_16x16x32_bf16 v[88:91], v[132:135], v[152:155], v[88:91]
    ds_read_b64_tr_b16 v[186:187], v5 offset:37376
    v_mfma_f32_16x16x32_bf16 v[84:87], v[132:135], v[148:151], v[84:87]
    ds_read_b128 v[172:175], v3 offset:53248
    v_mfma_f32_16x16x32_bf16 v[80:83], v[132:135], v[144:147], v[80:83]
    ds_read_b64_tr_b16 v[188:189], v6 offset:36864
    v_mfma_f32_16x16x32_bf16 v[96:99], v[136:139], v[144:147], v[96:99]
    ds_read_b64_tr_b16 v[190:191], v6 offset:37376
    v_mfma_f32_16x16x32_bf16 v[100:103], v[136:139], v[148:151], v[100:103]
    ds_read_b128 v[176:179], v2 offset:54272
    v_mfma_f32_16x16x32_bf16 v[104:107], v[136:139], v[152:155], v[104:107]
    ds_read_b64_tr_b16 v[192:193], v7 offset:36864
    v_mfma_f32_16x16x32_bf16 v[108:111], v[136:139], v[156:159], v[108:111]
    ds_read_b64_tr_b16 v[194:195], v7 offset:37376
    v_mfma_f32_16x16x32_bf16 v[124:127], v[140:143], v[156:159], v[124:127]
    v_mfma_f32_16x16x32_bf16 v[120:123], v[140:143], v[152:155], v[120:123]
    v_mfma_f32_16x16x32_bf16 v[116:119], v[140:143], v[148:151], v[116:119]
    v_mfma_f32_16x16x32_bf16 v[112:115], v[140:143], v[144:147], v[112:115]
    s_waitcnt lgkmcnt(0)
    v_mfma_f32_16x16x32_bf16 v[64:67], v[164:167], v[180:183], v[64:67]
    v_mfma_f32_16x16x32_bf16 v[68:71], v[164:167], v[184:187], v[68:71]
    v_mfma_f32_16x16x32_bf16 v[72:75], v[164:167], v[188:191], v[72:75]
    v_mfma_f32_16x16x32_bf16 v[76:79], v[164:167], v[192:195], v[76:79]
    v_mfma_f32_16x16x32_bf16 v[92:95], v[168:171], v[192:195], v[92:95]
    v_mfma_f32_16x16x32_bf16 v[88:91], v[168:171], v[188:191], v[88:91]
    v_mfma_f32_16x16x32_bf16 v[84:87], v[168:171], v[184:187], v[84:87]
    v_mfma_f32_16x16x32_bf16 v[80:83], v[168:171], v[180:183], v[80:83]
    s_barrier
    v_mfma_f32_16x16x32_bf16 v[96:99], v[172:175], v[180:183], v[96:99]
    ds_read_b128 v[128:131], v2 offset:0
    ds_read_b64_tr_b16 v[144:145], v4 offset:49152
    v_mfma_f32_16x16x32_bf16 v[100:103], v[172:175], v[184:187], v[100:103]
    ds_read_b64_tr_b16 v[146:147], v4 offset:49664
    ds_read_b128 v[132:135], v3 offset:1024
    v_mfma_f32_16x16x32_bf16 v[104:107], v[172:175], v[188:191], v[104:107]
    ds_read_b64_tr_b16 v[148:149], v5 offset:49152
    ds_read_b64_tr_b16 v[150:151], v5 offset:49664
    v_mfma_f32_16x16x32_bf16 v[108:111], v[172:175], v[192:195], v[108:111]
    ds_read_b128 v[136:139], v2 offset:4096
    ds_read_b64_tr_b16 v[152:153], v6 offset:49152
    v_mfma_f32_16x16x32_bf16 v[124:127], v[176:179], v[192:195], v[124:127]
    ds_read_b64_tr_b16 v[154:155], v6 offset:49664
    ds_read_b128 v[140:143], v3 offset:5120
    v_mfma_f32_16x16x32_bf16 v[120:123], v[176:179], v[188:191], v[120:123]
    ds_read_b64_tr_b16 v[156:157], v7 offset:49152
    ds_read_b64_tr_b16 v[158:159], v7 offset:49664
    v_mfma_f32_16x16x32_bf16 v[116:119], v[176:179], v[184:187], v[116:119]
    v_mfma_f32_16x16x32_bf16 v[112:115], v[176:179], v[180:183], v[112:115]
    s_waitcnt lgkmcnt(0)
    v_mfma_f32_16x16x32_bf16 v[64:67], v[128:131], v[144:147], v[64:67]
    ds_read_b128 v[164:167], v3 offset:0
    ds_read_b64_tr_b16 v[180:181], v4 offset:53248
    v_mfma_f32_16x16x32_bf16 v[68:71], v[128:131], v[148:151], v[68:71]
    ds_read_b64_tr_b16 v[182:183], v4 offset:53760
    ds_read_b128 v[168:171], v2 offset:1024
    v_mfma_f32_16x16x32_bf16 v[72:75], v[128:131], v[152:155], v[72:75]
    ds_read_b64_tr_b16 v[184:185], v5 offset:53248
    ds_read_b64_tr_b16 v[186:187], v5 offset:53760
    v_mfma_f32_16x16x32_bf16 v[76:79], v[128:131], v[156:159], v[76:79]
    ds_read_b128 v[172:175], v3 offset:4096
    ds_read_b64_tr_b16 v[188:189], v6 offset:53248
    v_mfma_f32_16x16x32_bf16 v[92:95], v[132:135], v[156:159], v[92:95]
    ds_read_b64_tr_b16 v[190:191], v6 offset:53760
    ds_read_b128 v[176:179], v2 offset:5120
    v_mfma_f32_16x16x32_bf16 v[88:91], v[132:135], v[152:155], v[88:91]
    ds_read_b64_tr_b16 v[192:193], v7 offset:53248
    ds_read_b64_tr_b16 v[194:195], v7 offset:53760
    v_mfma_f32_16x16x32_bf16 v[84:87], v[132:135], v[148:151], v[84:87]
    v_mfma_f32_16x16x32_bf16 v[80:83], v[132:135], v[144:147], v[80:83]
    s_mul_i32 s60, s101, 0x01010101
    s_waitcnt vmcnt(0)
    v_cmp_ne_u32 vcc, s60, v48
    s_cmp_lg_u64 vcc, 0
    s_cbranch_scc1 L_rare_20
L_rare_20_b:
    s_cmp_eq_u64 vcc, 0
    s_cselect_b32 s50, 1, 0
    s_and_b32 s97, s97, s50
    v_mfma_f32_16x16x32_bf16 v[96:99], v[136:139], v[144:147], v[96:99]
    v_mfma_f32_16x16x32_bf16 v[100:103], v[136:139], v[148:151], v[100:103]
    v_mfma_f32_16x16x32_bf16 v[104:107], v[136:139], v[152:155], v[104:107]
    v_mfma_f32_16x16x32_bf16 v[108:111], v[136:139], v[156:159], v[108:111]
    s_waitcnt lgkmcnt(0)
    v_mfma_f32_16x16x32_bf16 v[64:67], v[164:167], v[180:183], v[64:67]
    v_mfma_f32_16x16x32_bf16 v[68:71], v[164:167], v[184:187], v[68:71]
    v_mfma_f32_16x16x32_bf16 v[72:75], v[164:167], v[188:191], v[72:75]
    v_mfma_f32_16x16x32_bf16 v[76:79], v[164:167], v[192:195], v[76:79]
    v_mfma_f32_16x16x32_bf16 v[92:95], v[168:171], v[192:195], v[92:95]
    v_mfma_f32_16x16x32_bf16 v[88:91], v[168:171], v[188:191], v[88:91]
    v_mfma_f32_16x16x32_bf16 v[84:87], v[168:171], v[184:187], v[84:87]
    v_mfma_f32_16x16x32_bf16 v[80:83], v[168:171], v[180:183], v[80:83]
    s_cmp_eq_u32 s97, 0
    s_cbranch_scc1 L_wt_21
    v_mfma_f32_16x16x32_bf16 v[124:127], v[140:143], v[156:159], v[124:127]
    v_mfma_f32_16x16x32_bf16 v[120:123], v[140:143], v[152:155], v[120:123]
    v_cvt_pk_bf16_f32 v16, v64, v65
    v_cvt_pk_bf16_f32 v17, v66, v67
    v_mfma_f32_16x16x32_bf16 v[116:119], v[140:143], v[148:151], v[116:119]
    s_nop 0
    v_cvt_pk_bf16_f32 v18, v80, v81
    v_cvt_pk_bf16_f32 v19, v82, v83
    v_mfma_f32_16x16x32_bf16 v[112:115], v[140:143], v[144:147], v[112:115]
    buffer_store_dwordx4 v[16:19], v56, s[12:15], s98 offen offset:0
    v_cvt_pk_bf16_f32 v24, v68, v69
    v_mfma_f32_16x16x32_bf16 v[96:99], v[172:175], v[180:183], v[96:99]
    v_cvt_pk_bf16_f32 v25, v70, v71
    v_cvt_pk_bf16_f32 v26, v84, v85
    v_mfma_f32_16x16x32_bf16 v[100:103], v[172:175], v[184:187], v[100:103]
    v_cvt_pk_bf16_f32 v27, v86, v87
    buffer_store_dwordx4 v[24:27], v57, s[12:15], s98 offen offset:0
    v_mfma_f32_16x16x32_bf16 v[104:107], v[172:175], v[188:191], v[104:107]
    v_cvt_pk_bf16_f32 v28, v72, v73
    v_cvt_pk_bf16_f32 v29, v74, v75
    v_mfma_f32_16x16x32_bf16 v[108:111], v[172:175], v[192:195], v[108:111]
    v_cvt_pk_bf16_f32 v30, v88, v89
    v_cvt_pk_bf16_f32 v31, v90, v91
    v_mfma_f32_16x16x32_bf16 v[124:127], v[176:179], v[192:195], v[124:127]
    buffer_store_dwordx4 v[28:31], v58, s[12:15], s98 offen offset:0
    v_cvt_pk_bf16_f32 v40, v76, v77
    v_mfma_f32_16x16x32_bf16 v[120:123], v[176:179], v[188:191], v[120:123]
    v_cvt_pk_bf16_f32 v41, v78, v79
    v_cvt_pk_bf16_f32 v42, v92, v93
    v_mfma_f32_16x16x32_bf16 v[116:119], v[176:179], v[184:187], v[116:119]
    v_cvt_pk_bf16_f32 v43, v94, v95
    v_mfma_f32_16x16x32_bf16 v[112:115], v[176:179], v[180:183], v[112:115]
    buffer_store_dwordx4 v[40:43], v59, s[12:15], s98 offen offset:0
    v_cvt_pk_bf16_f32 v128, v96, v97
    v_cvt_pk_bf16_f32 v129, v98, v99
    s_nop 4
    v_cvt_pk_bf16_f32 v130, v112, v113
    v_cvt_pk_bf16_f32 v131, v114, v115
    buffer_store_dwordx4 v[128:131], v56, s[12:15], s98 offen offset:1280
    v_cvt_pk_bf16_f32 v132, v100, v101
    v_cvt_pk_bf16_f32 v133, v102, v103
    v_cvt_pk_bf16_f32 v134, v116, v117
    v_cvt_pk_bf16_f32 v135, v118, v119
    buffer_store_dwordx4 v[132:135], v57, s[12:15], s98 offen offset:1280
    v_cvt_pk_bf16_f32 v136, v104, v105
    v_cvt_pk_bf16_f32 v137, v106, v107
    v_cvt_pk_bf16_f32 v138, v120, v121
    v_cvt_pk_bf16_f32 v139, v122, v123
    buffer_store_dwordx4 v[136:139], v58, s[12:15], s98 offen offset:1280
    v_cvt_pk_bf16_f32 v140, v108, v109
    v_cvt_pk_bf16_f32 v141, v110, v111
    v_cvt_pk_bf16_f32 v142, v124, v125
    v_cvt_pk_bf16_f32 v143, v126, v127
    buffer_store_dwordx4 v[140:143], v59, s[12:15], s98 offen offset:1280
    s_branch L_wtd_22
L_wt_21:
    v_mfma_f32_16x16x32_bf16 v[124:127], v[140:143], v[156:159], v[124:127]
    v_mfma_f32_16x16x32_bf16 v[120:123], v[140:143], v[152:155], v[120:123]
    v_cvt_pk_bf16_f32 v16, v64, v65
    v_cvt_pk_bf16_f32 v17, v66, v67
    v_mfma_f32_16x16x32_bf16 v[116:119], v[140:143], v[148:151], v[116:119]
    s_nop 0
    v_cvt_pk_bf16_f32 v18, v80, v81
    v_cvt_pk_bf16_f32 v19, v82, v83
    v_mfma_f32_16x16x32_bf16 v[112:115], v[140:143], v[144:147], v[112:115]
    buffer_store_dwordx4 v[16:19], v56, s[12:15], s98 offen offset:0 sc1
    v_cvt_pk_bf16_f32 v24, v68, v69
    v_mfma_f32_16x16x32_bf16 v[96:99], v[172:175], v[180:183], v[96:99]
    v_cvt_pk_bf16_f32 v25, v70, v71
    v_cvt_pk_bf16_f32 v26, v84, v85
    v_mfma_f32_16x16x32_bf16 v[100:103], v[172:175], v[184:187], v[100:103]
    v_cvt_pk_bf16_f32 v27, v86, v87
    buffer_store_dwordx4 v[24:27], v57, s[12:15], s98 offen offset:0 sc1
    v_mfma_f32_16x16x32_bf16 v[104:107], v[172:175], v[188:191], v[104:107]
    v_cvt_pk_bf16_f32 v28, v72, v73
    v_cvt_pk_bf16_f32 v29, v74, v75
    v_mfma_f32_16x16x32_bf16 v[108:111], v[172:175], v[192:195], v[108:111]
    v_cvt_pk_bf16_f32 v30, v88, v89
    v_cvt_pk_bf16_f32 v31, v90, v91
    v_mfma_f32_16x16x32_bf16 v[124:127], v[176:179], v[192:195], v[124:127]
    buffer_store_dwordx4 v[28:31], v58, s[12:15], s98 offen offset:0 sc1
    v_cvt_pk_bf16_f32 v40, v76, v77
    v_mfma_f32_16x16x32_bf16 v[120:123], v[176:179], v[188:191], v[120:123]
    v_cvt_pk_bf16_f32 v41, v78, v79
    v_cvt_pk_bf16_f32 v42, v92, v93
    v_mfma_f32_16x16x32_bf16 v[116:119], v[176:179], v[184:187], v[116:119]
    v_cvt_pk_bf16_f32 v43, v94, v95
    v_mfma_f32_16x16x32_bf16 v[112:115], v[176:179], v[180:183], v[112:115]
    buffer_store_dwordx4 v[40:43], v59, s[12:15], s98 offen offset:0 sc1
    v_cvt_pk_bf16_f32 v128, v96, v97
    v_cvt_pk_bf16_f32 v129, v98, v99
    s_nop 4
    v_cvt_pk_bf16_f32 v130, v112, v113
    v_cvt_pk_bf16_f32 v131, v114, v115
    buffer_store_dwordx4 v[128:131], v56, s[12:15], s98 offen offset:1280 sc1
    v_cvt_pk_bf16_f32 v132, v100, v101
    v_cvt_pk_bf16_f32 v133, v102, v103
    v_cvt_pk_bf16_f32 v134, v116, v117
    v_cvt_pk_bf16_f32 v135, v118, v119
    buffer_store_dwordx4 v[132:135], v57, s[12:15], s98 offen offset:1280 sc1
    v_cvt_pk_bf16_f32 v136, v104, v105
    v_cvt_pk_bf16_f32 v137, v106, v107
    v_cvt_pk_bf16_f32 v138, v120, v121
    v_cvt_pk_bf16_f32 v139, v122, v123
    buffer_store_dwordx4 v[136:139], v58, s[12:15], s98 offen offset:1280 sc1
    v_cvt_pk_bf16_f32 v140, v108, v109
    v_cvt_pk_bf16_f32 v141, v110, v111
    v_cvt_pk_bf16_f32 v142, v124, v125
    v_cvt_pk_bf16_f32 v143, v126, v127
    buffer_store_dwordx4 v[140:143], v59, s[12:15], s98 offen offset:1280 sc1
L_wtd_22:
    s_branch L_g1done
L_gemm_h:
    s_lshl_b32 s58, s40, 12
    v_add_u32 v2, s58, v2
    v_xor_b32 v3, 64, v2
    s_mul_i32 s61, s47, 491520
    s_mul_i32 s98, s40, 1280
    s_add_u32 s98, s98, s61
    s_add_u32 s98, s98, 327680
    s_lshl_b32 s61, s47, 2
    s_add_u32 s61, s61, s40
    s_lshl_b32 s99, s61, 5
    v_and_b32 v14, 1, v0
    v_mul_u32_u24 v14, 1280, v14
    v_lshl_add_u32 v14, v11, 4, v14
    v_add_u32 v15, 159744, v14
    s_and_b32 s58, s48, 15
    s_lshr_b64 s[48:49], s[48:49], 4
    s_add_u32 s58, s58, s50
    s_sub_u32 s63, s58, 10
    s_min_u32 s58, s58, s63
    s_lshl_b32 s58, s58, 7
    v_add_u32 v9, s58, v15
    s_cmp_lg_u32 s96, 113
    s_cbranch_scc1 L_ann_23
    s_lshl_b32 s58, s41, 2
    s_mov_b64 exec, 1
    s_waitcnt vmcnt(0) lgkmcnt(0)
    buffer_store_dword v51, v49, s[36:39], s58 offen sc1
    s_mov_b64 exec, -1
L_ann_23:
    s_barrier
    ds_read_b128 v[128:131], v2 offset:49152
    ds_read_b64_tr_b16 v[144:145], v4 offset:32768
    ds_read_b64_tr_b16 v[146:147], v4 offset:33280
    ds_read_b128 v[132:135], v3 offset:50176
    ds_read_b64_tr_b16 v[148:149], v5 offset:32768
    ds_read_b64_tr_b16 v[150:151], v5 offset:33280
    ds_read_b64_tr_b16 v[152:153], v6 offset:32768
    ds_read_b64_tr_b16 v[154:155], v6 offset:33280
    ds_read_b64_tr_b16 v[156:157], v7 offset:32768
    ds_read_b64_tr_b16 v[158:159], v7 offset:33280
    ds_read_b128 v[160:163], v9 offset:0
    s_waitcnt lgkmcnt(0)
    v_mfma_f32_16x16x32_bf16 v[64:67], v[128:131], v[144:147], 0
    ds_read_b128 v[164:167], v3 offset:49152
    ds_read_b64_tr_b16 v[180:181], v4 offset:36864
    v_mfma_f32_16x16x32_bf16 v[68:71], v[128:131], v[148:151], 0
    ds_read_b64_tr_b16 v[182:183], v4 offset:37376
    ds_read_b128 v[168:171], v2 offset:50176
    v_mfma_f32_16x16x32_bf16 v[72:75], v[128:131], v[152:155], 0
    ds_read_b64_tr_b16 v[184:185], v5 offset:36864
    ds_read_b64_tr_b16 v[186:187], v5 offset:37376
    v_mfma_f32_16x16x32_bf16 v[76:79], v[128:131], v[156:159], 0
    ds_read_b64_tr_b16 v[188:189], v6 offset:36864
    ds_read_b64_tr_b16 v[190:191], v6 offset:37376
    v_mfma_f32_16x16x32_bf16 v[92:95], v[132:135], v[156:159], 0
    ds_read_b64_tr_b16 v[192:193], v7 offset:36864
    ds_read_b64_tr_b16 v[194:195], v7 offset:37376
    v_mfma_f32_16x16x32_bf16 v[88:91], v[132:135], v[152:155], 0
    ds_read_b128 v[196:199], v9 offset:64
    v_mfma_f32_16x16x32_bf16 v[84:87], v[132:135], v[148:151], 0
    v_mfma_f32_16x16x32_bf16 v[80:83], v[132:135], v[144:147], 0
    v_mfma_f32_16x16x32_bf16 v[96:99], v[160:163], v[128:131], 0
    v_mfma_f32_16x16x32_bf16 v[100:103], v[160:163], v[132:135], 0
    s_waitcnt lgkmcnt(0)
    v_mfma_f32_16x16x32_bf16 v[64:67], v[164:167], v[180:183], v[64:67]
    v_mfma_f32_16x16x32_bf16 v[68:71], v[164:167], v[184:187], v[68:71]
    v_mfma_f32_16x16x32_bf16 v[72:75], v[164:167], v[188:191], v[72:75]
    v_mfma_f32_16x16x32_bf16 v[76:79], v[164:167], v[192:195], v[76:79]
    v_mfma_f32_16x16x32_bf16 v[92:95], v[168:171], v[192:195], v[92:95]
    s_waitcnt vmcnt(0)
    s_and_b32 s58, s48, 15
    s_lshr_b64 s[48:49], s[48:49], 4
    s_add_u32 s58, s58, s50
    s_sub_u32 s63, s58, 10
    s_min_u32 s58, s58, s63
    s_lshl_b32 s58, s58, 7
    v_add_u32 v9, s58, v15
    s_barrier
    v_mfma_f32_16x16x32_bf16 v[88:91], v[168:171], v[188:191], v[88:91]
    ds_read_b128 v[128:131], v2 offset:0
    ds_read_b64_tr_b16 v[144:145], v4 offset:49152
    ds_read_b64_tr_b16 v[146:147], v4 offset:49664
    v_mfma_f32_16x16x32_bf16 v[84:87], v[168:171], v[184:187], v[84:87]
    ds_read_b128 v[132:135], v3 offset:1024
    ds_read_b64_tr_b16 v[148:149], v5 offset:49152
    ds_read_b64_tr_b16 v[150:151], v5 offset:49664
    v_mfma_f32_16x16x32_bf16 v[80:83], v[168:171], v[180:183], v[80:83]
    ds_read_b64_tr_b16 v[152:153], v6 offset:49152
    ds_read_b64_tr_b16 v[154:155], v6 offset:49664
    ds_read_b64_tr_b16 v[156:157], v7 offset:49152
    v_mfma_f32_16x16x32_bf16 v[96:99], v[196:199], v[164:167], v[96:99]
    ds_read_b64_tr_b16 v[158:159], v7 offset:49664
    ds_read_b128 v[160:163], v9 offset:0
    v_mfma_f32_16x16x32_bf16 v[100:103], v[196:199], v[168:171], v[100:103]
    s_waitcnt lgkmcnt(0)
    s_cmp_lg_u32 s40, 0
    s_cbranch_scc1 L_side_24
    s_mov_b32 exec_hi, 0xff
    buffer_store_dwordx4 v[32:35], v243, s[12:15], s88 offen offset:0 sc1
    buffer_store_dwordx4 v[36:39], v243, s[12:15], s88 offen offset:640 sc1
    s_mov_b64 exec, -1
L_side_24:
    v_mfma_f32_16x16x32_bf16 v[64:67], v[128:131], v[144:147], v[64:67]
    ds_read_b128 v[164:167], v3 offset:0
    ds_read_b64_tr_b16 v[180:181], v4 offset:53248
    v_mfma_f32_16x16x32_bf16 v[68:71], v[128:131], v[148:151], v[68:71]
    ds_read_b64_tr_b16 v[182:183], v4 offset:53760
    ds_read_b128 v[168:171], v2 offset:1024
    v_mfma_f32_16x16x32_bf16 v[72:75], v[128:131], v[152:155], v[72:75]
    ds_read_b64_tr_b16 v[184:185], v5 offset:53248
    ds_read_b64_tr_b16 v[186:187], v5 offset:53760
    v_mfma_f32_16x16x32_bf16 v[76:79], v[128:131], v[156:159], v[76:79]
    ds_read_b64_tr_b16 v[188:189], v6 offset:53248
    ds_read_b64_tr_b16 v[190:191], v6 offset:53760
    v_mfma_f32_16x16x32_bf16 v[92:95], v[132:135], v[156:159], v[92:95]
    ds_read_b64_tr_b16 v[192:193], v7 offset:53248
    ds_read_b64_tr_b16 v[194:195], v7 offset:53760
    v_mfma_f32_16x16x32_bf16 v[88:91], v[132:135], v[152:155], v[88:91]
    ds_read_b128 v[196:199], v9 offset:64
    v_mfma_f32_16x16x32_bf16 v[84:87], v[132:135], v[148:151], v[84:87]
    v_mfma_f32_16x16x32_bf16 v[80:83], v[132:135], v[144:147], v[80:83]
    v_mfma_f32_16x16x32_bf16 v[96:99], v[160:163], v[128:131], v[96:99]
    v_mfma_f32_16x16x32_bf16 v[100:103], v[160:163], v[132:135], v[100:103]
    s_waitcnt lgkmcnt(0)
    v_mfma_f32_16x16x32_bf16 v[64:67], v[164:167], v[180:183], v[64:67]
    v_mfma_f32_16x16x32_bf16 v[68:71], v[164:167], v[184:187], v[68:71]
    v_mfma_f32_16x16x32_bf16 v[72:75], v[164:167], v[188:191], v[72:75]
    v_mfma_f32_16x16x32_bf16 v[76:79], v[164:167], v[192:195], v[76:79]
    v_mfma_f32_16x16x32_bf16 v[92:95], v[168:171], v[192:195], v[92:95]
    s_cmp_lg_u32 s40, 0
    s_cbranch_scc1 L_side_25
    s_mov_b32 exec_hi, 0xff
    buffer_store_dwordx4 v[60:63], v243, s[12:15], s88 offen offset:1280 sc1
    buffer_store_dwordx4 v[204:207], v243, s[12:15], s88 offen offset:1920 sc1
    s_mov_b64 exec, -1
L_side_25:
    s_and_b32 s58, s48, 15
    s_lshr_b64 s[48:49], s[48:49], 4
    s_add_u32 s58, s58, s50
    s_sub_u32 s63, s58, 10
    s_min_u32 s58, s58, s63
    s_lshl_b32 s58, s58, 7
    v_add_u32 v9, s58, v15
    s_barrier
    v_mfma_f32_16x16x32_bf16 v[88:91], v[168:171], v[188:191], v[88:91]
    ds_read_b128 v[128:131], v2 offset:16384
    ds_read_b64_tr_b16 v[144:145], v4 offset:0
    ds_read_b64_tr_b16 v[146:147], v4 offset:512
    v_mfma_f32_16x16x32_bf16 v[84:87], v[168:171], v[184:187], v[84:87]
    ds_read_b128 v[132:135], v3 offset:17408
    ds_read_b64_tr_b16 v[148:149], v5 offset:0
    ds_read_b64_tr_b16 v[150:151], v5 offset:512
    v_mfma_f32_16x16x32_bf16 v[80:83], v[168:171], v[180:183], v[80:83]
    ds_read_b64_tr_b16 v[152:153], v6 offset:0
    ds_read_b64_tr_b16 v[154:155], v6 offset:512
    ds_read_b64_tr_b16 v[156:157], v7 offset:0
    v_mfma_f32_16x16x32_bf16 v[96:99], v[196:199], v[164:167], v[96:99]
    ds_read_b64_tr_b16 v[158:159], v7 offset:512
    ds_read_b128 v[160:163], v9 offset:0
    v_mfma_f32_16x16x32_bf16 v[100:103], v[196:199], v[168:171], v[100:103]
    s_waitcnt lgkmcnt(0)
    s_cmp_lg_u32 s40, 0
    s_cbranch_scc1 L_side_26
    s_mov_b32 exec_hi, 0xff
    buffer_store_dwordx4 v[252:255], v243, s[12:15], s88 offen offset:2560 sc1
    s_mov_b64 exec, -1
L_side_26:
    v_mfma_f32_16x16x32_bf16 v[64:67], v[128:131], v[144:147], v[64:67]
    ds_read_b128 v[164:167], v3 offset:16384
    ds_read_b64_tr_b16 v[180:181], v4 offset:4096
    v_mfma_f32_16x16x32_bf16 v[68:71], v[128:131], v[148:151], v[68:71]
    ds_read_b64_tr_b16 v[182:183], v4 offset:4608
    ds_read_b128 v[168:171], v2 offset:17408
    v_mfma_f32_16x16x32_bf16 v[72:75], v[128:131], v[152:155], v[72:75]
    ds_read_b64_tr_b16 v[184:185], v5 offset:4096
    ds_read_b64_tr_b16 v[186:187], v5 offset:4608
    v_mfma_f32_16x16x32_bf16 v[76:79], v[128:131], v[156:159], v[76:79]
    ds_read_b64_tr_b16 v[188:189], v6 offset:4096
    ds_read_b64_tr_b16 v[190:191], v6 offset:4608
    v_mfma_f32_16x16x32_bf16 v[92:95], v[132:135], v[156:159], v[92:95]
    ds_read_b64_tr_b16 v[192:193], v7 offset:4096
    ds_read_b64_tr_b16 v[194:195], v7 offset:4608
    v_mfma_f32_16x16x32_bf16 v[88:91], v[132:135], v[152:155], v[88:91]
    ds_read_b128 v[196:199], v9 offset:64
    v_mfma_f32_16x16x32_bf16 v[84:87], v[132:135], v[148:151], v[84:87]
    v_mfma_f32_16x16x32_bf16 v[80:83], v[132:135], v[144:147], v[80:83]
    v_mfma_f32_16x16x32_bf16 v[96:99], v[160:163], v[128:131], v[96:99]
    v_mfma_f32_16x16x32_bf16 v[100:103], v[160:163], v[132:135], v[100:103]
    s_waitcnt lgkmcnt(0)
    v_mfma_f32_16x16x32_bf16 v[64:67], v[164:167], v[180:183], v[64:67]
    v_mfma_f32_16x16x32_bf16 v[68:71], v[164:167], v[184:187], v[68:71]
    v_mfma_f32_16x16x32_bf16 v[72:75], v[164:167], v[188:191], v[72:75]
    v_mfma_f32_16x16x32_bf16 v[76:79], v[164:167], v[192:195], v[76:79]
    v_mfma_f32_16x16x32_bf16 v[92:95], v[168:171], v[192:195], v[92:95]
    s_and_b32 s58, s48, 15
    s_lshr_b64 s[48:49], s[48:49], 4
    s_add_u32 s58, s58, s50
    s_sub_u32 s63, s58, 10
    s_min_u32 s58, s58, s63
    s_lshl_b32 s58, s58, 7
    v_add_u32 v9, s58, v15
    s_barrier
    v_mfma_f32_16x16x32_bf16 v[88:91], v[168:171], v[188:191], v[88:91]
    ds_read_b128 v[128:131], v2 offset:32768
    ds_read_b64_tr_b16 v[144:145], v4 offset:16384
    ds_read_b64_tr_b16 v[146:147], v4 offset:16896
    v_mfma_f32_16x16x32_bf16 v[84:87], v[168:171], v[184:187], v[84:87]
    ds_read_b128 v[132:135], v3 offset:33792
    ds_read_b64_tr_b16 v[148:149], v5 offset:16384
    ds_read_b64_tr_b16 v[150:151], v5 offset:16896
    v_mfma_f32_16x16x32_bf16 v[80:83], v[168:171], v[180:183], v[80:83]
    ds_read_b64_tr_b16 v[152:153], v6 offset:16384
    ds_read_b64_tr_b16 v[154:155], v6 offset:16896
    ds_read_b64_tr_b16 v[156:157], v7 offset:16384
    v_mfma_f32_16x16x32_bf16 v[96:99], v[196:199], v[164:167], v[96:99]
    ds_read_b64_tr_b16 v[158:159], v7 offset:16896
    ds_read_b128 v[160:163], v9 offset:0
    v_mfma_f32_16x16x32_bf16 v[100:103], v[196:199], v[168:171], v[100:103]
    s_waitcnt lgkmcnt(0)
    v_mfma_f32_16x16x32_bf16 v[64:67], v[128:131], v[144:147], v[64:67]
    ds_read_b128 v[164:167], v3 offset:32768
    ds_read_b64_tr_b16 v[180:181], v4 offset:20480
    v_mfma_f32_16x16x32_bf16 v[68:71], v[128:131], v[148:151], v[68:71]
    ds_read_b64_tr_b16 v[182:183], v4 offset:20992
    ds_read_b128 v[168:171], v2 offset:33792
    v_mfma_f32_16x16x32_bf16 v[72:75], v[128:131], v[152:155], v[72:75]
    ds_read_b64_tr_b16 v[184:185], v5 offset:20480
    ds_read_b64_tr_b16 v[186:187], v5 offset:20992
    v_mfma_f32_16x16x32_bf16 v[76:79], v[128:131], v[156:159], v[76:79]
    ds_read_b64_tr_b16 v[188:189], v6 offset:20480
    ds_read_b64_tr_b16 v[190:191], v6 offset:20992
    v_mfma_f32_16x16x32_bf16 v[92:95], v[132:135], v[156:159], v[92:95]
    ds_read_b64_tr_b16 v[192:193], v7 offset:20480
    ds_read_b64_tr_b16 v[194:195], v7 offset:20992
    v_mfma_f32_16x16x32_bf16 v[88:91], v[132:135], v[152:155], v[88:91]
    ds_read_b128 v[196:199], v9 offset:64
    v_mfma_f32_16x16x32_bf16 v[84:87], v[132:135], v[148:151], v[84:87]
    v_mfma_f32_16x16x32_bf16 v[80:83], v[132:135], v[144:147], v[80:83]
    v_mfma_f32_16x16x32_bf16 v[96:99], v[160:163], v[128:131], v[96:99]
    v_mfma_f32_16x16x32_bf16 v[100:103], v[160:163], v[132:135], v[100:103]
    s_waitcnt lgkmcnt(0)
    v_mfma_f32_16x16x32_bf16 v[64:67], v[164:167], v[180:183], v[64:67]
    v_mfma_f32_16x16x32_bf16 v[68:71], v[164:167], v[184:187], v[68:71]
    v_mfma_f32_16x16x32_bf16 v[72:75], v[164:167], v[188:191], v[72:75]
    v_mfma_f32_16x16x32_bf16 v[76:79], v[164:167], v[192:195], v[76:79]
    v_mfma_f32_16x16x32_bf16 v[92:95], v[168:171], v[192:195], v[92:95]
    s_and_b32 s58, s48, 15
    s_lshr_b64 s[48:49], s[48:49], 4
    s_add_u32 s58, s58, s50
    s_sub_u32 s63, s58, 10
    s_min_u32 s58, s58, s63
    s_lshl_b32 s58, s58, 7
    v_add_u32 v9, s58, v15
    s_barrier
    v_mfma_f32_16x16x32_bf16 v[88:91], v[168:171], v[188:191], v[88:91]
    ds_read_b128 v[128:131], v2 offset:49152
    ds_read_b64_tr_b16 v[144:145], v4 offset:32768
    ds_read_b64_tr_b16 v[146:147], v4 offset:33280
    v_mfma_f32_16x16x32_bf16 v[84:87], v[168:171], v[184:187], v[84:87]
    ds_read_b128 v[132:135], v3 offset:50176
    ds_read_b64_tr_b16 v[148:149], v5 offset:32768
    ds_read_b64_tr_b16 v[150:151], v5 offset:33280
    v_mfma_f32_16x16x32_bf16 v[80:83], v[168:171], v[180:183], v[80:83]
    ds_read_b64_tr_b16 v[152:153], v6 offset:32768
    ds_read_b64_tr_b16 v[154:155], v6 offset:33280
    ds_read_b64_tr_b16 v[156:157], v7 offset:32768
    v_mfma_f32_16x16x32_bf16 v[96:99], v[196:199], v[164:167], v[96:99]
    ds_read_b64_tr_b16 v[158:159], v7 offset:33280
    ds_read_b128 v[160:163], v9 offset:0
    v_mfma_f32_16x16x32_bf16 v[100:103], v[196:199], v[168:171], v[100:103]
    s_waitcnt lgkmcnt(0)
    s_cmp_lg_u32 s40, 0
    s_cbranch_scc1 L_side_27
    buffer_load_dword v48, v49, s[36:39], 0 offen sc1
L_side_27:
    v_mfma_f32_16x16x32_bf16 v[64:67], v[128:131], v[144:147], v[64:67]
    ds_read_b128 v[164:167], v3 offset:49152
    ds_read_b64_tr_b16 v[180:181], v4 offset:36864
    v_mfma_f32_16x16x32_bf16 v[68:71], v[128:131], v[148:151], v[68:71]
    ds_read_b64_tr_b16 v[182:183], v4 offset:37376
    ds_read_b128 v[168:171], v2 offset:50176
    v_mfma_f32_16x16x32_bf16 v[72:75], v[128:131], v[152:155], v[72:75]
    ds_read_b64_tr_b16 v[184:185], v5 offset:36864
    ds_read_b64_tr_b16 v[186:187], v5 offset:37376
    v_mfma_f32_16x16x32_bf16 v[76:79], v[128:131], v[156:159], v[76:79]
    ds_read_b64_tr_b16 v[188:189], v6 offset:36864
    ds_read_b64_tr_b16 v[190:191], v6 offset:37376
    v_mfma_f32_16x16x32_bf16 v[92:95], v[132:135], v[156:159], v[92:95]
    ds_read_b64_tr_b16 v[192:193], v7 offset:36864
    ds_read_b64_tr_b16 v[194:195], v7 offset:37376
    v_mfma_f32_16x16x32_bf16 v[88:91], v[132:135], v[152:155], v[88:91]
    ds_read_b128 v[196:199], v9 offset:64
    v_mfma_f32_16x16x32_bf16 v[84:87], v[132:135], v[148:151], v[84:87]
    v_mfma_f32_16x16x32_bf16 v[80:83], v[132:135], v[144:147], v[80:83]
    v_mfma_f32_16x16x32_bf16 v[96:99], v[160:163], v[128:131], v[96:99]
    v_mfma_f32_16x16x32_bf16 v[100:103], v[160:163], v[132:135], v[100:103]
    s_waitcnt lgkmcnt(0)
    v_mfma_f32_16x16x32_bf16 v[64:67], v[164:167], v[180:183], v[64:67]
    v_mfma_f32_16x16x32_bf16 v[68:71], v[164:167], v[184:187], v[68:71]
    v_mfma_f32_16x16x32_bf16 v[72:75], v[164:167], v[188:191], v[72:75]
    v_mfma_f32_16x16x32_bf16 v[76:79], v[164:167], v[192:195], v[76:79]
    v_mfma_f32_16x16x32_bf16 v[92:95], v[168:171], v[192:195], v[92:95]
    s_and_b32 s58, s48, 15
    s_lshr_b64 s[48:49], s[48:49], 4
    s_add_u32 s58, s58, s50
    s_sub_u32 s63, s58, 10
    s_min_u32 s58, s58, s63
    s_lshl_b32 s58, s58, 7
    v_add_u32 v9, s58, v15
    s_barrier
    v_mfma_f32_16x16x32_bf16 v[88:91], v[168:171], v[188:191], v[88:91]
    ds_read_b128 v[128:131], v2 offset:0
    ds_read_b64_tr_b16 v[144:145], v4 offset:49152
    ds_read_b64_tr_b16 v[146:147], v4 offset:49664
    v_mfma_f32_16x16x32_bf16 v[84:87], v[168:171], v[184:187], v[84:87]
    ds_read_b128 v[132:135], v3 offset:1024
    ds_read_b64_tr_b16 v[148:149], v5 offset:49152
    ds_read_b64_tr_b16 v[150:151], v5 offset:49664
    v_mfma_f32_16x16x32_bf16 v[80:83], v[168:171], v[180:183], v[80:83]
    ds_read_b64_tr_b16 v[152:153], v6 offset:49152
    ds_read_b64_tr_b16 v[154:155], v6 offset:49664
    ds_read_b64_tr_b16 v[156:157], v7 offset:49152
    v_mfma_f32_16x16x32_bf16 v[96:99], v[196:199], v[164:167], v[96:99]
    ds_read_b64_tr_b16 v[158:159], v7 offset:49664
    ds_read_b128 v[160:163], v9 offset:0
    v_mfma_f32_16x16x32_bf16 v[100:103], v[196:199], v[168:171], v[100:103]
    s_waitcnt lgkmcnt(0)
    v_mfma_f32_16x16x32_bf16 v[64:67], v[128:131], v[144:147], v[64:67]
    ds_read_b128 v[164:167], v3 offset:0
    ds_read_b64_tr_b16 v[180:181], v4 offset:53248
    v_mfma_f32_16x16x32_bf16 v[68:71], v[128:131], v[148:151], v[68:71]
    ds_read_b64_tr_b16 v[182:183], v4 offset:53760
    ds_read_b128 v[168:171], v2 offset:1024
    v_mfma_f32_16x16x32_bf16 v[72:75], v[128:131], v[152:155], v[72:75]
    ds_read_b64_tr_b16 v[184:185], v5 offset:53248
    ds_read_b64_tr_b16 v[186:187], v5 offset:53760
    v_mfma_f32_16x16x32_bf16 v[76:79], v[128:131], v[156:159], v[76:79]
    ds_read_b64_tr_b16 v[188:189], v6 offset:53248
    ds_read_b64_tr_b16 v[190:191], v6 offset:53760
    v_mfma_f32_16x16x32_bf16 v[92:95], v[132:135], v[156:159], v[92:95]
    ds_read_b64_tr_b16 v[192:193], v7 offset:53248
    ds_read_b64_tr_b16 v[194:195], v7 offset:53760
    v_mfma_f32_16x16x32_bf16 v[88:91], v[132:135], v[152:155], v[88:91]
    ds_read_b128 v[196:199], v9 offset:64
    v_mfma_f32_16x16x32_bf16 v[84:87], v[132:135], v[148:151], v[84:87]
    v_mfma_f32_16x16x32_bf16 v[80:83], v[132:135], v[144:147], v[80:83]
    v_mfma_f32_16x16x32_bf16 v[96:99], v[160:163], v[128:131], v[96:99]
    v_mfma_f32_16x16x32_bf16 v[100:103], v[160:163], v[132:135], v[100:103]
    s_waitcnt lgkmcnt(0)
    v_mfma_f32_16x16x32_bf16 v[64:67], v[164:167], v[180:183], v[64:67]
    v_mfma_f32_16x16x32_bf16 v[68:71], v[164:167], v[184:187], v[68:71]
    v_mfma_f32_16x16x32_bf16 v[72:75], v[164:167], v[188:191], v[72:75]
    v_mfma_f32_16x16x32_bf16 v[76:79], v[164:167], v[192:195], v[76:79]
    v_mfma_f32_16x16x32_bf16 v[92:95], v[168:171], v[192:195], v[92:95]
    s_cmp_lg_u32 s40, 0
    s_cbranch_scc1 L_side_28
    s_mov_b32 s90, 0
    s_branch L_polle_31
L_poll_29:
    buffer_load_dword v48, v49, s[36:39], 0 offen sc1
L_polle_31:
    s_add_u32 s90, s90, 1
    s_cmp_gt_u32 s90, 200000
    s_waitcnt vmcnt(0)
    s_cbranch_scc1 L_polld_30
    v_cmp_eq_u32 vcc, 0, v48
    s_cbranch_vccnz L_poll_29
L_polld_30:
    s_add_u32 s58, s100, s42
    s_lshl_b32 s59, s2, 7
    s_add_u32 s59, s59, 11010048
    s_add_u32 s60, s59, 196608
    s_mov_b64 exec, 1
    buffer_store_byte v51, v49, s[12:15], s58 offen
    buffer_store_dword v51, v49, s[12:15], s60 offen sc1
    s_mov_b64 exec, 7
    buffer_load_dword v48, v50, s[12:15], s59 offen sc1
    s_mov_b64 exec, -1
L_side_28:
    s_and_b32 s58, s48, 15
    s_lshr_b64 s[48:49], s[48:49], 4
    s_add_u32 s58, s58, s50
    s_sub_u32 s63, s58, 10
    s_min_u32 s58, s58, s63
    s_lshl_b32 s58, s58, 7
    v_add_u32 v9, s58, v15
    s_barrier
    v_mfma_f32_16x16x32_bf16 v[88:91], v[168:171], v[188:191], v[88:91]
    ds_read_b128 v[128:131], v2 offset:16384
    ds_read_b64_tr_b16 v[144:145], v4 offset:0
    ds_read_b64_tr_b16 v[146:147], v4 offset:512
    v_mfma_f32_16x16x32_bf16 v[84:87], v[168:171], v[184:187], v[84:87]
    ds_read_b128 v[132:135], v3 offset:17408
    ds_read_b64_tr_b16 v[148:149], v5 offset:0
    ds_read_b64_tr_b16 v[150:151], v5 offset:512
    v_mfma_f32_16x16x32_bf16 v[80:83], v[168:171], v[180:183], v[80:83]
    ds_read_b64_tr_b16 v[152:153], v6 offset:0
    ds_read_b64_tr_b16 v[154:155], v6 offset:512
    ds_read_b64_tr_b16 v[156:157], v7 offset:0
    v_mfma_f32_16x16x32_bf16 v[96:99], v[196:199], v[164:167], v[96:99]
    ds_read_b64_tr_b16 v[158:159], v7 offset:512
    ds_read_b128 v[160:163], v9 offset:0
    v_mfma_f32_16x16x32_bf16 v[100:103], v[196:199], v[168:171], v[100:103]
    s_waitcnt lgkmcnt(0)
    v_mfma_f32_16x16x32_bf16 v[64:67], v[128:131], v[144:147], v[64:67]
    ds_read_b128 v[164:167], v3 offset:16384
    ds_read_b64_tr_b16 v[180:181], v4 offset:4096
    v_mfma_f32_16x16x32_bf16 v[68:71], v[128:131], v[148:151], v[68:71]
    ds_read_b64_tr_b16 v[182:183], v4 offset:4608
    ds_read_b128 v[168:171], v2 offset:17408
    v_mfma_f32_16x16x32_bf16 v[72:75], v[128:131], v[152:155], v[72:75]
    ds_read_b64_tr_b16 v[184:185], v5 offset:4096
    ds_read_b64_tr_b16 v[186:187], v5 offset:4608
    v_mfma_f32_16x16x32_bf16 v[76:79], v[128:131], v[156:159], v[76:79]
    ds_read_b64_tr_b16 v[188:189], v6 offset:4096
    ds_read_b64_tr_b16 v[190:191], v6 offset:4608
    v_mfma_f32_16x16x32_bf16 v[92:95], v[132:135], v[156:159], v[92:95]
    ds_read_b64_tr_b16 v[192:193], v7 offset:4096
    ds_read_b64_tr_b16 v[194:195], v7 offset:4608
    v_mfma_f32_16x16x32_bf16 v[88:91], v[132:135], v[152:155], v[88:91]
    ds_read_b128 v[196:199], v9 offset:64
    v_mfma_f32_16x16x32_bf16 v[84:87], v[132:135], v[148:151], v[84:87]
    v_mfma_f32_16x16x32_bf16 v[80:83], v[132:135], v[144:147], v[80:83]
    v_mfma_f32_16x16x32_bf16 v[96:99], v[160:163], v[128:131], v[96:99]
    v_mfma_f32_16x16x32_bf16 v[100:103], v[160:163], v[132:135], v[100:103]
    s_waitcnt lgkmcnt(0)
    v_mfma_f32_16x16x32_bf16 v[64:67], v[164:167], v[180:183], v[64:67]
    v_mfma_f32_16x16x32_bf16 v[68:71], v[164:167], v[184:187], v[68:71]
    v_mfma_f32_16x16x32_bf16 v[72:75], v[164:167], v[188:191], v[72:75]
    v_mfma_f32_16x16x32_bf16 v[76:79], v[164:167], v[192:195], v[76:79]
    v_mfma_f32_16x16x32_bf16 v[92:95], v[168:171], v[192:195], v[92:95]
    s_and_b32 s58, s48, 15
    s_lshr_b64 s[48:49], s[48:49], 4
    s_add_u32 s58, s58, s50
    s_sub_u32 s63, s58, 10
    s_min_u32 s58, s58, s63
    s_lshl_b32 s58, s58, 7
    v_add_u32 v9, s58, v15
    s_barrier
    v_mfma_f32_16x16x32_bf16 v[88:91], v[168:171], v[188:191], v[88:91]
    ds_read_b128 v[128:131], v2 offset:32768
    ds_read_b64_tr_b16 v[144:145], v4 offset:16384
    ds_read_b64_tr_b16 v[146:147], v4 offset:16896
    v_mfma_f32_16x16x32_bf16 v[84:87], v[168:171], v[184:187], v[84:87]
    ds_read_b128 v[132:135], v3 offset:33792
    ds_read_b64_tr_b16 v[148:149], v5 offset:16384
    ds_read_b64_tr_b16 v[150:151], v5 offset:16896
    v_mfma_f32_16x16x32_bf16 v[80:83], v[168:171], v[180:183], v[80:83]
    ds_read_b64_tr_b16 v[152:153], v6 offset:16384
    ds_read_b64_tr_b16 v[154:155], v6 offset:16896
    ds_read_b64_tr_b16 v[156:157], v7 offset:16384
    v_mfma_f32_16x16x32_bf16 v[96:99], v[196:199], v[164:167], v[96:99]
    ds_read_b64_tr_b16 v[158:159], v7 offset:16896
    ds_read_b128 v[160:163], v9 offset:0
    v_mfma_f32_16x16x32_bf16 v[100:103], v[196:199], v[168:171], v[100:103]
    s_waitcnt lgkmcnt(0)
    v_mfma_f32_16x16x32_bf16 v[64:67], v[128:131], v[144:147], v[64:67]
    ds_read_b128 v[164:167], v3 offset:32768
    ds_read_b64_tr_b16 v[180:181], v4 offset:20480
    v_mfma_f32_16x16x32_bf16 v[68:71], v[128:131], v[148:151], v[68:71]
    ds_read_b64_tr_b16 v[182:183], v4 offset:20992
    ds_read_b128 v[168:171], v2 offset:33792
    v_mfma_f32_16x16x32_bf16 v[72:75], v[128:131], v[152:155], v[72:75]
    ds_read_b64_tr_b16 v[184:185], v5 offset:20480
    ds_read_b64_tr_b16 v[186:187], v5 offset:20992
    v_mfma_f32_16x16x32_bf16 v[76:79], v[128:131], v[156:159], v[76:79]
    ds_read_b64_tr_b16 v[188:189], v6 offset:20480
    ds_read_b64_tr_b16 v[190:191], v6 offset:20992
    v_mfma_f32_16x16x32_bf16 v[92:95], v[132:135], v[156:159], v[92:95]
    ds_read_b64_tr_b16 v[192:193], v7 offset:20480
    ds_read_b64_tr_b16 v[194:195], v7 offset:20992
    v_mfma_f32_16x16x32_bf16 v[88:91], v[132:135], v[152:155], v[88:91]
    ds_read_b128 v[196:199], v9 offset:64
    v_mfma_f32_16x16x32_bf16 v[84:87], v[132:135], v[148:151], v[84:87]
    v_mfma_f32_16x16x32_bf16 v[80:83], v[132:135], v[144:147], v[80:83]
    v_mfma_f32_16x16x32_bf16 v[96:99], v[160:163], v[128:131], v[96:99]
    v_mfma_f32_16x16x32_bf16 v[100:103], v[160:163], v[132:135], v[100:103]
    s_waitcnt lgkmcnt(0)
    v_mfma_f32_16x16x32_bf16 v[64:67], v[164:167], v[180:183], v[64:67]
    v_mfma_f32_16x16x32_bf16 v[68:71], v[164:167], v[184:187], v[68:71]
    v_mfma_f32_16x16x32_bf16 v[72:75], v[164:167], v[188:191], v[72:75]
    v_mfma_f32_16x16x32_bf16 v[76:79], v[164:167], v[192:195], v[76:79]
    v_mfma_f32_16x16x32_bf16 v[92:95], v[168:171], v[192:195], v[92:95]
    s_and_b32 s58, s48, 15
    s_lshr_b64 s[48:49], s[48:49], 4
    s_add_u32 s58, s58, s50
    s_sub_u32 s63, s58, 10
    s_min_u32 s58, s58, s63
    s_lshl_b32 s58, s58, 7
    v_add_u32 v9, s58, v15
    s_barrier
    v_mfma_f32_16x16x32_bf16 v[88:91], v[168:171], v[188:191], v[88:91]
    ds_read_b128 v[128:131], v2 offset:49152
    ds_read_b64_tr_b16 v[144:145], v4 offset:32768
    ds_read_b64_tr_b16 v[146:147], v4 offset:33280
    v_mfma_f32_16x16x32_bf16 v[84:87], v[168:171], v[184:187], v[84:87]
    ds_read_b128 v[132:135], v3 offset:50176
    ds_read_b64_tr_b16 v[148:149], v5 offset:32768
    ds_read_b64_tr_b16 v[150:151], v5 offset:33280
    v_mfma_f32_16x16x32_bf16 v[80:83], v[168:171], v[180:183], v[80:83]
    ds_read_b64_tr_b16 v[152:153], v6 offset:32768
    ds_read_b64_tr_b16 v[154:155], v6 offset:33280
    ds_read_b64_tr_b16 v[156:157], v7 offset:32768
    v_mfma_f32_16x16x32_bf16 v[96:99], v[196:199], v[164:167], v[96:99]
    ds_read_b64_tr_b16 v[158:159], v7 offset:33280
    ds_read_b128 v[160:163], v9 offset:0
    v_mfma_f32_16x16x32_bf16 v[100:103], v[196:199], v[168:171], v[100:103]
    s_waitcnt lgkmcnt(0)
    v_mfma_f32_16x16x32_bf16 v[64:67], v[128:131], v[144:147], v[64:67]
    ds_read_b128 v[164:167], v3 offset:49152
    ds_read_b64_tr_b16 v[180:181], v4 offset:36864
    v_mfma_f32_16x16x32_bf16 v[68:71], v[128:131], v[148:151], v[68:71]
    ds_read_b64_tr_b16 v[182:183], v4 offset:37376
    ds_read_b128 v[168:171], v2 offset:50176
    v_mfma_f32_16x16x32_bf16 v[72:75], v[128:131], v[152:155], v[72:75]
    ds_read_b64_tr_b16 v[184:185], v5 offset:36864
    ds_read_b64_tr_b16 v[186:187], v5 offset:37376
    v_mfma_f32_16x16x32_bf16 v[76:79], v[128:131], v[156:159], v[76:79]
    ds_read_b64_tr_b16 v[188:189], v6 offset:36864
    ds_read_b64_tr_b16 v[190:191], v6 offset:37376
    v_mfma_f32_16x16x32_bf16 v[92:95], v[132:135], v[156:159], v[92:95]
    ds_read_b64_tr_b16 v[192:193], v7 offset:36864
    ds_read_b64_tr_b16 v[194:195], v7 offset:37376
    v_mfma_f32_16x16x32_bf16 v[88:91], v[132:135], v[152:155], v[88:91]
    ds_read_b128 v[196:199], v9 offset:64
    v_mfma_f32_16x16x32_bf16 v[84:87], v[132:135], v[148:151], v[84:87]
    v_mfma_f32_16x16x32_bf16 v[80:83], v[132:135], v[144:147], v[80:83]
    v_mfma_f32_16x16x32_bf16 v[96:99], v[160:163], v[128:131], v[96:99]
    v_mfma_f32_16x16x32_bf16 v[100:103], v[160:163], v[132:135], v[100:103]
    s_waitcnt lgkmcnt(0)
    v_mfma_f32_16x16x32_bf16 v[64:67], v[164:167], v[180:183], v[64:67]
    v_mfma_f32_16x16x32_bf16 v[68:71], v[164:167], v[184:187], v[68:71]
    v_mfma_f32_16x16x32_bf16 v[72:75], v[164:167], v[188:191], v[72:75]
    v_mfma_f32_16x16x32_bf16 v[76:79], v[164:167], v[192:195], v[76:79]
    v_mfma_f32_16x16x32_bf16 v[92:95], v[168:171], v[192:195], v[92:95]
    s_and_b32 s58, s48, 15
    s_lshr_b64 s[48:49], s[48:49], 4
    s_add_u32 s58, s58, s50
    s_sub_u32 s63, s58, 10
    s_min_u32 s58, s58, s63
    s_lshl_b32 s58, s58, 7
    v_add_u32 v9, s58, v15
    s_barrier
    v_mfma_f32_16x16x32_bf16 v[88:91], v[168:171], v[188:191], v[88:91]
    ds_read_b128 v[128:131], v2 offset:0
    ds_read_b64_tr_b16 v[144:145], v4 offset:49152
    ds_read_b64_tr_b16 v[146:147], v4 offset:49664
    v_mfma_f32_16x16x32_bf16 v[84:87], v[168:171], v[184:187], v[84:87]
    ds_read_b128 v[132:135], v3 offset:1024
    ds_read_b64_tr_b16 v[148:149], v5 offset:49152
    ds_read_b64_tr_b16 v[150:151], v5 offset:49664
    v_mfma_f32_16x16x32_bf16 v[80:83], v[168:171], v[180:183], v[80:83]
    ds_read_b64_tr_b16 v[152:153], v6 offset:49152
    ds_read_b64_tr_b16 v[154:155], v6 offset:49664
    ds_read_b64_tr_b16 v[156:157], v7 offset:49152
    v_mfma_f32_16x16x32_bf16 v[96:99], v[196:199], v[164:167], v[96:99]
    ds_read_b64_tr_b16 v[158:159], v7 offset:49664
    ds_read_b128 v[160:163], v9 offset:0
    v_mfma_f32_16x16x32_bf16 v[100:103], v[196:199], v[168:171], v[100:103]
    s_waitcnt lgkmcnt(0)
    buffer_load_dword v48, v49, s[12:15], s100 offen sc1
    v_mfma_f32_16x16x32_bf16 v[64:67], v[128:131], v[144:147], v[64:67]
    ds_read_b128 v[164:167], v3 offset:0
    ds_read_b64_tr_b16 v[180:181], v4 offset:53248
    v_mfma_f32_16x16x32_bf16 v[68:71], v[128:131], v[148:151], v[68:71]
    ds_read_b64_tr_b16 v[182:183], v4 offset:53760
    ds_read_b128 v[168:171], v2 offset:1024
    v_mfma_f32_16x16x32_bf16 v[72:75], v[128:131], v[152:155], v[72:75]
    ds_read_b64_tr_b16 v[184:185], v5 offset:53248
    ds_read_b64_tr_b16 v[186:187], v5 offset:53760
    v_mfma_f32_16x16x32_bf16 v[76:79], v[128:131], v[156:159], v[76:79]
    ds_read_b64_tr_b16 v[188:189], v6 offset:53248
    ds_read_b64_tr_b16 v[190:191], v6 offset:53760
    v_mfma_f32_16x16x32_bf16 v[92:95], v[132:135], v[156:159], v[92:95]
    ds_read_b64_tr_b16 v[192:193], v7 offset:53248
    ds_read_b64_tr_b16 v[194:195], v7 offset:53760
    v_mfma_f32_16x16x32_bf16 v[88:91], v[132:135], v[152:155], v[88:91]
    ds_read_b128 v[196:199], v9 offset:64
    v_mfma_f32_16x16x32_bf16 v[84:87], v[132:135], v[148:151], v[84:87]
    v_mfma_f32_16x16x32_bf16 v[80:83], v[132:135], v[144:147], v[80:83]
    v_mfma_f32_16x16x32_bf16 v[96:99], v[160:163], v[128:131], v[96:99]
    v_mfma_f32_16x16x32_bf16 v[100:103], v[160:163], v[132:135], v[100:103]
    s_waitcnt lgkmcnt(0)
    v_mfma_f32_16x16x32_bf16 v[64:67], v[164:167], v[180:183], v[64:67]
    v_mfma_f32_16x16x32_bf16 v[68:71], v[164:167], v[184:187], v[68:71]
    v_mfma_f32_16x16x32_bf16 v[72:75], v[164:167], v[188:191], v[72:75]
    v_mfma_f32_16x16x32_bf16 v[76:79], v[164:167], v[192:195], v[76:79]
    v_mfma_f32_16x16x32_bf16 v[92:95], v[168:171], v[192:195], v[92:95]
    v_mfma_f32_16x16x32_bf16 v[88:91], v[168:171], v[188:191], v[88:91]
    v_mfma_f32_16x16x32_bf16 v[84:87], v[168:171], v[184:187], v[84:87]
    v_mfma_f32_16x16x32_bf16 v[80:83], v[168:171], v[180:183], v[80:83]
    v_mfma_f32_16x16x32_bf16 v[96:99], v[196:199], v[164:167], v[96:99]
    v_mfma_f32_16x16x32_bf16 v[100:103], v[196:199], v[168:171], v[100:103]
    s_mul_i32 s60, s101, 0x01010101
    s_waitcnt vmcnt(0)
    v_cmp_ne_u32 vcc, s60, v48
    s_cmp_lg_u64 vcc, 0
    s_cbranch_scc1 L_rare_32
L_rare_32_b:
    s_cmp_eq_u64 vcc, 0
    s_cselect_b32 s50, 1, 0
    s_and_b32 s97, s97, s50
    s_cmp_ge_u32 s42, 30
    s_cbranch_scc1 L_h_aux
    s_cmp_eq_u32 s97, 0
    s_cbranch_scc1 L_wt_33
    v_cvt_pk_bf16_f32 v16, v64, v65
    v_cvt_pk_bf16_f32 v17, v66, v67
    v_cvt_pk_bf16_f32 v18, v80, v81
    v_cvt_pk_bf16_f32 v19, v82, v83
    buffer_store_dwordx4 v[16:19], v56, s[12:15], s98 offen offset:0
    v_cvt_pk_bf16_f32 v24, v68, v69
    v_cvt_pk_bf16_f32 v25, v70, v71
    v_cvt_pk_bf16_f32 v26, v84, v85
    v_cvt_pk_bf16_f32 v27, v86, v87
    buffer_store_dwordx4 v[24:27], v57, s[12:15], s98 offen offset:0
    v_cvt_pk_bf16_f32 v28, v72, v73
    v_cvt_pk_bf16_f32 v29, v74, v75
    v_cvt_pk_bf16_f32 v30, v88, v89
    v_cvt_pk_bf16_f32 v31, v90, v91
    buffer_store_dwordx4 v[28:31], v58, s[12:15], s98 offen offset:0
    v_cvt_pk_bf16_f32 v40, v76, v77
    v_cvt_pk_bf16_f32 v41, v78, v79
    v_cvt_pk_bf16_f32 v42, v92, v93
    v_cvt_pk_bf16_f32 v43, v94, v95
    buffer_store_dwordx4 v[40:43], v59, s[12:15], s98 offen offset:0
    s_branch L_wtd_34
L_wt_33:
    v_cvt_pk_bf16_f32 v16, v64, v65
    v_cvt_pk_bf16_f32 v17, v66, v67
    v_cvt_pk_bf16_f32 v18, v80, v81
    v_cvt_pk_bf16_f32 v19, v82, v83
    buffer_store_dwordx4 v[16:19], v56, s[12:15], s98 offen offset:0 sc1
    v_cvt_pk_bf16_f32 v24, v68, v69
    v_cvt_pk_bf16_f32 v25, v70, v71
    v_cvt_pk_bf16_f32 v26, v84, v85
    v_cvt_pk_bf16_f32 v27, v86, v87
    buffer_store_dwordx4 v[24:27], v57, s[12:15], s98 offen offset:0 sc1
    v_cvt_pk_bf16_f32 v28, v72, v73
    v_cvt_pk_bf16_f32 v29, v74, v75
    v_cvt_pk_bf16_f32 v30, v88, v89
    v_cvt_pk_bf16_f32 v31, v90, v91
    buffer_store_dwordx4 v[28:31], v58, s[12:15], s98 offen offset:0 sc1
    v_cvt_pk_bf16_f32 v40, v76, v77
    v_cvt_pk_bf16_f32 v41, v78, v79
    v_cvt_pk_bf16_f32 v42, v92, v93
    v_cvt_pk_bf16_f32 v43, v94, v95
    buffer_store_dwordx4 v[40:43], v59, s[12:15], s98 offen offset:0 sc1
L_wtd_34:
    s_branch L_h_noaux
L_h_aux:
    v_and_b32 v14, 1, v11
    v_cmp_eq_u32 vcc, 1, v14
    s_nop 1
    v_cndmask_b32 v166, v96, v100, vcc
    v_cndmask_b32 v168, v97, v101, vcc
    v_and_b32 v170, 8, v10
    v_add_u32 v170, v170, v10
    v_lshl_add_u32 v170, v14, 3, v170
    v_add_u32 v170, s99, v170
    s_mov_b32 exec_hi, 0
    v_mul_f32 v168, 3216550459, v168
    v_exp_f32 v168, v168
    s_nop 0
    v_add_f32 v168, 1.0, v168
    v_rcp_f32 v168, v168
    v_lshlrev_b32 v169, 2, v170
    s_mov_b32 s59, 10485760
    buffer_store_dword v168, v169, s[12:15], s59 offen sc1
    s_mov_b64 exec, -1
    s_cmp_eq_u32 s97, 0
    s_cbranch_scc1 L_wt_35
    v_cvt_pk_bf16_f32 v16, v64, v65
    v_cvt_pk_bf16_f32 v17, v66, v67
    v_cvt_pk_bf16_f32 v18, v80, v81
    v_cvt_pk_bf16_f32 v19, v82, v83
    buffer_store_dwordx4 v[16:19], v56, s[12:15], s98 offen offset:0
    v_cvt_pk_bf16_f32 v24, v68, v69
    v_cvt_pk_bf16_f32 v25, v70, v71
    v_cvt_pk_bf16_f32 v26, v84, v85
    v_cvt_pk_bf16_f32 v27, v86, v87
    buffer_store_dwordx4 v[24:27], v57, s[12:15], s98 offen offset:0
    v_cvt_pk_bf16_f32 v28, v72, v73
    v_cvt_pk_bf16_f32 v29, v74, v75
    v_cvt_pk_bf16_f32 v30, v88, v89
    v_cvt_pk_bf16_f32 v31, v90, v91
    buffer_store_dwordx4 v[28:31], v58, s[12:15], s98 offen offset:0
    v_cvt_pk_bf16_f32 v40, v76, v77
    v_cvt_pk_bf16_f32 v41, v78, v79
    v_cvt_pk_bf16_f32 v42, v92, v93
    v_cvt_pk_bf16_f32 v43, v94, v95
    buffer_store_dwordx4 v[40:43], v59, s[12:15], s98 offen offset:0
    s_branch L_wtd_36
L_wt_35:
    v_cvt_pk_bf16_f32 v16, v64, v65
    v_cvt_pk_bf16_f32 v17, v66, v67
    v_cvt_pk_bf16_f32 v18, v80, v81
    v_cvt_pk_bf16_f32 v19, v82, v83
    buffer_store_dwordx4 v[16:19], v56, s[12:15], s98 offen offset:0 sc1
    v_cvt_pk_bf16_f32 v24, v68, v69
    v_cvt_pk_bf16_f32 v25, v70, v71
    v_cvt_pk_bf16_f32 v26, v84, v85
    v_cvt_pk_bf16_f32 v27, v86, v87
    buffer_store_dwordx4 v[24:27], v57, s[12:15], s98 offen offset:0 sc1
    v_cvt_pk_bf16_f32 v28, v72, v73
    v_cvt_pk_bf16_f32 v29, v74, v75
    v_cvt_pk_bf16_f32 v30, v88, v89
    v_cvt_pk_bf16_f32 v31, v90, v91
    buffer_store_dwordx4 v[28:31], v58, s[12:15], s98 offen offset:0 sc1
    v_cvt_pk_bf16_f32 v40, v76, v77
    v_cvt_pk_bf16_f32 v41, v78, v79
    v_cvt_pk_bf16_f32 v42, v92, v93
    v_cvt_pk_bf16_f32 v43, v94, v95
    buffer_store_dwordx4 v[40:43], v59, s[12:15], s98 offen offset:0 sc1
L_wtd_36:
    v_cvt_pk_bf16_f32 v171, 0, v166
    v_ashrrev_i32 v172, 31, v171
    v_or_b32 v172, 0x80000000, v172
    v_xor_b32 v171, v171, v172
    v_and_b32 v171, 0xffff0000, v171
    v_sub_u32 v172, 34815, v170
    v_or_b32 v174, v171, v172
    s_nop 1
    v_max_u32_dpp v178, v174, v174 row_ror:8 row_mask:0xf bank_mask:0xf
    s_nop 1
    v_max_u32_dpp v178, v178, v178 row_ror:4 row_mask:0xf bank_mask:0xf
    s_nop 1
    v_max_u32_dpp v178, v178, v178 row_ror:2 row_mask:0xf bank_mask:0xf
    s_nop 1
    v_max_u32_dpp v178, v178, v178 row_ror:1 row_mask:0xf bank_mask:0xf
    s_nop 0
    v_readlane_b32 s58, v178, 0
    v_readlane_b32 s63, v178, 16
    s_max_u32 s58, s58, s63
    v_cmp_ne_u32 vcc, s58, v174
    s_nop 1
    v_cndmask_b32 v174, 0, v174, vcc
    s_nop 1
    v_max_u32_dpp v178, v174, v174 row_ror:8 row_mask:0xf bank_mask:0xf
    s_nop 1
    v_max_u32_dpp v178, v178, v178 row_ror:4 row_mask:0xf bank_mask:0xf
    s_nop 1
    v_max_u32_dpp v178, v178, v178 row_ror:2 row_mask:0xf bank_mask:0xf
    s_nop 1
    v_max_u32_dpp v178, v178, v178 row_ror:1 row_mask:0xf bank_mask:0xf
    s_nop 0
    v_readlane_b32 s59, v178, 0
    v_readlane_b32 s63, v178, 16
    s_max_u32 s59, s59, s63
    v_mov_b32 v178, s58
    v_mov_b32 v179, s59
    s_lshl_b32 s60, s40, 3
    s_add_u32 s60, s60, 162848
    v_mov_b32 v180, s60
    v_mov_b32 v181, 162816
    v_mov_b32 v182, 1
    s_mov_b64 exec, 1
    s_waitcnt vmcnt(4)
    ds_write_b64 v180, v[178:179]
    ds_add_rtn_u32 v182, v181, v182 offset:12
    s_mov_b64 exec, 0xffff
    v_and_b32 v180, 1, v0
    v_lshl_add_u32 v181, v180, 4, v181
    v_lshrrev_b32 v183, 1, v0
    v_lshlrev_b32 v183, 11, v183
    v_lshl_add_u32 v183, v180, 4, v183
    s_lshl_b32 s59, s47, 7
    s_add_u32 s59, s59, 11173888
    s_waitcnt lgkmcnt(0)
    v_readfirstlane_b32 s58, v182
    s_cmp_lg_u32 s58, 3
    s_cbranch_scc1 L_h_nolast
    ds_read_b128 v[186:189], v181 offset:32
    s_waitcnt lgkmcnt(0)
    buffer_store_dwordx4 v[186:189], v183, s[12:15], s59 offen sc1
L_h_nolast:
    s_mov_b64 exec, -1
L_h_noaux:
L_g1done:
    v_mov_b32 v14, 0
    v_mov_b32 v15, 1
    s_lshl_b32 s60, s46, 2
    s_add_u32 s60, s60, s45
    s_lshl_b32 s60, s60, 3
    s_add_u32 s60, s60, s41
    s_lshl_b32 s60, s60, 7
    s_add_u32 s60, s60, 11010048
    s_add_u32 s61, s60, 98304
    s_min_u32 s59, s45, s46
    s_cmp_ge_u32 s59, 2
    s_cselect_b32 s59, 2, 9
    v_mov_b32 v37, 0
    s_cmp_eq_u32 s40, 1
    s_cbranch_scc1 L_sig1
    s_cmp_lg_u32 s40, s59
    s_cbranch_scc1 L_sig0
    s_mov_b64 exec, 1
    s_waitcnt vmcnt(0)
    s_barrier
    buffer_store_dword v15, v14, s[12:15], s61 offen sc1
    s_mov_b64 exec, -1
    s_branch L_nosig
L_sig0:
    s_waitcnt vmcnt(0)
    s_barrier
L_nosig:
    s_cmp_eq_u32 s40, 3
    s_cbranch_scc1 L_rare_37
L_rare_37_b:
    s_mul_i32 s99, s46, 160
    s_lshr_b32 s62, s40, 2
    s_xor_b32 s62, s62, s43
    s_and_b32 s63, s40, 3
    v_lshrrev_b32 v11, 4, v0
    v_lshrrev_b32 v1, 5, v0
    v_bfe_u32 v13, v0, 2, 2
    v_and_b32 v14, 1, v11
    v_lshl_add_u32 v12, v14, 2, v13
    v_mad_u32_u24 v12, v1, 20, v12
    v_mul_u32_u24 v12, 160, v12
    v_and_b32 v15, 3, v0
    v_lshlrev_b32 v15, 3, v15
    s_mul_i32 s59, s62, 51200
    s_add_u32 s59, s59, 16384
    v_add3_u32 v7, v12, v15, s59
    v_mad_u32_u24 v12, v11, 40, v13
    v_mul_u32_u24 v12, 160, v12
    v_add3_u32 v12, v12, v15, s59
    v_mul_u32_u24 v15, 3200, v14
    v_add_u32 v8, v12, v15
    v_sub_u32 v9, v12, v15
    v_add_u32 v9, 3200, v9
    s_mul_i32 s60, s63, 5440
    s_add_u32 s60, s60, 118784
    v_and_b32 v15, 48, v0
    v_add3_u32 v6, s60, v243, v15
    v_mul_u32_u24 v12, 26, v0
    v_lshrrev_b32 v12, 8, v12
    v_mul_u32_u24 v12, 1120, v12
    v_and_b32 v13, -16, v246
    v_mul_u32_u24 v13, 1280, v13
    v_add3_u32 v5, v12, v13, v243
    v_and_b32 v13, 127, v246
    s_lshl_b32 s60, s44, 1
    s_add_u32 s60, s60, s43
    s_lshl_b32 s60, s60, 1
    s_lshr_b32 s61, s45, 1
    s_add_u32 s60, s60, s61
    v_add_u32 v12, v11, v1
    v_lshlrev_b32 v13, 4, v13
    v_lshl_add_u32 v2, v12, 11, v13
    v_mul_u32_u24 v12, 10240, v11
    v_add_u32 v3, v12, v13
    s_mul_i32 s88, s60, 491520
    s_mul_i32 s60, s62, 81920
    s_add_u32 s88, s88, s60
    s_add_u32 s89, s88, 4096
    v_mov_b32 v4, 0
    s_lshl_b32 s59, s63, 3
    s_lshr_b32 s59, 656018688, s59
    s_and_b32 s59, s59, 255
    s_lshl_b32 s59, s59, 10
    s_add_u32 s93, s59, 16384
    s_mul_i32 s97, s46, 102400
    s_add_u32 s97, s97, s59
    s_add_u32 s97, s97, 11796480
    s_branch L_ba
L_sig1:
    s_mov_b64 exec, 1
    s_cmp_eq_u32 s50, 0
    s_cbranch_scc1 L_wt_38
    s_waitcnt vmcnt(0)
    s_barrier
    buffer_store_dword v15, v14, s[12:15], s60 offen
    s_mov_b64 exec, 0xfff
    buffer_load_dword v123, v245, s[12:15], s35 offen sc1
    s_branch L_wtd_39
L_wt_38:
    s_waitcnt vmcnt(0)
    s_barrier
    buffer_store_dword v15, v14, s[12:15], s60 offen sc1
    s_mov_b64 exec, 0xfff
    buffer_load_dword v123, v245, s[12:15], s35 offen sc1
L_wtd_39:
    s_add_u32 s61, s9, s10
    s_add_u32 s60, s9, 163840
    s_lshl_b32 s58, s91, 9
    s_add_u32 s58, s58, 139264
    s_mul_i32 s59, s91, 1280
    s_add_u32 s59, s59, 153600
    s_mov_b32 s90, 0
    s_branch L_polle_42
L_poll_40:
    buffer_load_dword v123, v245, s[12:15], s35 offen sc1
L_polle_42:
    s_add_u32 s90, s90, 1
    s_cmp_gt_u32 s90, 200000
    s_waitcnt vmcnt(0)
    s_cbranch_scc1 L_polld_41
    v_cmp_ne_u32 vcc, 1, v123
    s_cbranch_vccnz L_poll_40
L_polld_41:
    s_mov_b64 exec, -1
    s_barrier
    s_branch L_ba2
L_att:
    v_and_b32 v41, 31, v0
    v_lshrrev_b32 v42, 5, v0
    s_mul_i32 s60, s51, 983040
    s_mul_i32 s8, s52, 5
    s_add_u32 s8, s8, s53
    s_lshl_b32 s8, s8, 10
    s_add_u32 s8, s8, s60
    s_lshr_b32 s58, s52, 1
    s_mul_i32 s9, s58, 10240
    s_add_u32 s9, s9, s60
    s_add_u32 s9, s9, 4096
    s_xor_b32 s10, s58, s53
    s_and_b32 s10, s10, 1
    s_lshl_b32 s10, s10, 3
    s_mul_i32 s11, s52, 5120
    s_add_u32 s11, s11, s60
    s_add_u32 s11, s11, 327680
    s_lshl_b32 s58, s91, 9
    s_add_u32 s58, s58, 118784
    v_lshlrev_b32 v40, 4, v41
    s_lshl_b32 s59, s91, 10
    s_add_u32 s59, s59, 118784
    v_lshl_add_u32 v240, v0, 4, s59
    s_add_u32 s58, s58, s10
    s_add_u32 s58, s58, 16384
    v_add_u32 v241, s58, v40
    s_mul_i32 s58, s91, 1280
    s_add_u32 s58, s58, 143360
    v_mul_u32_u24 v43, 320, v42
    v_add3_u32 v242, v40, v43, s58
    s_lshr_b32 s58, s91, 2
    s_mul_i32 s58, s58, 489472
    s_lshl_b32 s59, s91, 9
    s_add_u32 s58, s58, s59
    v_lshl_add_u32 v244, v42, 11, v40
    v_add_u32 v244, s58, v244
    v_lshlrev_b32 v243, 4, v0
    v_lshlrev_b32 v40, 2, v42
    v_sub_u32 v40, v41, v40
    v_mov_b32 v43, 0xff800000
    v_mov_b32 v44, 0
    v_cmp_gt_i32 vcc, 0, v40
    v_cmp_gt_i32 s[58:59], 1, v40
    s_nop 0
    v_cndmask_b32 v208, v44, v43, vcc
    v_cndmask_b32 v224, v43, v44, vcc
    v_cndmask_b32 v209, v44, v43, s[58:59]
    v_cndmask_b32 v225, v43, v44, s[58:59]
    v_cmp_gt_i32 vcc, 2, v40
    v_cmp_gt_i32 s[58:59], 3, v40
    s_nop 0
    v_cndmask_b32 v210, v44, v43, vcc
    v_cndmask_b32 v226, v43, v44, vcc
    v_cndmask_b32 v211, v44, v43, s[58:59]
    v_cndmask_b32 v227, v43, v44, s[58:59]
    v_cmp_gt_i32 vcc, 8, v40
    v_cmp_gt_i32 s[58:59], 9, v40
    s_nop 0
    v_cndmask_b32 v212, v44, v43, vcc
    v_cndmask_b32 v228, v43, v44, vcc
    v_cndmask_b32 v213, v44, v43, s[58:59]
    v_cndmask_b32 v229, v43, v44, s[58:59]
    v_cmp_gt_i32 vcc, 10, v40
    v_cmp_gt_i32 s[58:59], 11, v40
    s_nop 0
    v_cndmask_b32 v214, v44, v43, vcc
    v_cndmask_b32 v230, v43, v44, vcc
    v_cndmask_b32 v215, v44, v43, s[58:59]
    v_cndmask_b32 v231, v43, v44, s[58:59]
    v_cmp_gt_i32 vcc, 16, v40
    v_cmp_gt_i32 s[58:59], 17, v40
    s_nop 0
    v_cndmask_b32 v216, v44, v43, vcc
    v_cndmask_b32 v232, v43, v44, vcc
    v_cndmask_b32 v217, v44, v43, s[58:59]
    v_cndmask_b32 v233, v43, v44, s[58:59]
    v_cmp_gt_i32 vcc, 18, v40
    v_cmp_gt_i32 s[58:59], 19, v40
    s_nop 0
    v_cndmask_b32 v218, v44, v43, vcc
    v_cndmask_b32 v234, v43, v44, vcc
    v_cndmask_b32 v219, v44, v43, s[58:59]
    v_cndmask_b32 v235, v43, v44, s[58:59]
    v_cmp_gt_i32 vcc, 24, v40
    v_cmp_gt_i32 s[58:59], 25, v40
    s_nop 0
    v_cndmask_b32 v220, v44, v43, vcc
    v_cndmask_b32 v236, v43, v44, vcc
    v_cndmask_b32 v221, v44, v43, s[58:59]
    v_cndmask_b32 v237, v43, v44, s[58:59]
    v_cmp_gt_i32 vcc, 26, v40
    v_cmp_gt_i32 s[58:59], 27, v40
    s_nop 0
    v_cndmask_b32 v222, v44, v43, vcc
    v_cndmask_b32 v238, v43, v44, vcc
    v_cndmask_b32 v223, v44, v43, s[58:59]
    v_cndmask_b32 v239, v43, v44, s[58:59]
    v_mov_b32 v22, 0
    v_mov_b32 v23, 0
    v_cmp_gt_u32 vcc, 32, v0
    v_cmp_gt_u32 s[58:59], 20, v41
    v_mov_b32 v43, 1040
    v_and_b32 v44, 27, v41
    v_xor_b32 v44, 24, v44
    v_min_u32 v44, 1, v44
    v_lshlrev_b32 v44, 5, v44
    v_add_u32 v44, 1024, v44
    v_cndmask_b32 v241, v43, v241, vcc
    v_cndmask_b32 v242, v44, v242, s[58:59]
    s_sub_u32 s34, 8, s91
    s_cmp_eq_u32 s51, 0
    s_cselect_b32 s31, s34, 0
    s_cselect_b32 s34, 15, s34
    s_add_u32 s58, s41, 15
    s_lshl_b32 s58, s58, 7
    s_add_u32 s58, s58, 11108352
    s_lshl_b32 s59, s41, 7
    s_add_u32 s59, s59, 11010048
    s_bitcmp1_b32 s51, 0
    s_cselect_b32 s58, s59, s58
    s_cmp_eq_u32 s34, 8
    s_cselect_b32 s30, s58, 0
    s_lshl_b32 s58, s41, 11
    s_add_u32 s58, s58, 11173888
    s_cmp_eq_u32 s40, 4
    s_cselect_b32 s30, s58, s30
    s_lshl_b32 s58, s46, 12
    s_add_u32 s58, s58, 11206656
    s_cmp_eq_u32 s40, 5
    s_cselect_b32 s30, s58, s30
    s_cmp_lt_u32 s42, 30
    s_cselect_b32 s53, s40, 0
    s_lshl_b32 s58, s44, 1
    s_add_u32 s58, s58, s43
    s_lshl_b32 s58, s58, 2
    s_add_u32 s58, s58, s45
    s_lshl_b32 s58, s58, 2
    s_and_b32 s59, s40, 3
    s_add_u32 s58, s58, s59
    s_lshl_b32 s58, s58, 4
    v_and_b32 v40, 15, v0
    v_add_u32 v246, s58, v40
    v_lshlrev_b32 v248, 2, v246
    v_add_u32 v248, 10485760, v248
    s_add_u32 s86, s8, 163840
    s_lshr_b32 s58, s91, 2
    s_mul_i32 s58, s58, 486400
    s_mul_i32 s59, s91, 1280
    s_add_u32 s58, s58, s59
    s_add_u32 s87, s58, s11
    s_lshl_b32 s58, s91, 10
    s_add_u32 m0, s58, 126976
    s_mul_i32 s99, s46, 160
    s_lshr_b32 s62, s40, 2
    s_xor_b32 s62, s62, s43
    s_and_b32 s63, s40, 3
    v_lshrrev_b32 v11, 4, v0
    v_lshrrev_b32 v1, 5, v0
    v_bfe_u32 v13, v0, 2, 2
    v_and_b32 v14, 1, v11
    v_lshl_add_u32 v12, v14, 2, v13
    v_mad_u32_u24 v12, v1, 20, v12
    v_mul_u32_u24 v12, 160, v12
    v_and_b32 v15, 3, v0
    v_lshlrev_b32 v15, 3, v15
    s_mul_i32 s59, s62, 51200
    s_add_u32 s59, s59, 16384
    v_add3_u32 v7, v12, v15, s59
    v_mad_u32_u24 v12, v11, 40, v13
    v_mul_u32_u24 v12, 160, v12
    v_add3_u32 v12, v12, v15, s59
    v_mul_u32_u24 v15, 3200, v14
    v_add_u32 v8, v12, v15
    v_sub_u32 v9, v12, v15
    v_add_u32 v9, 3200, v9
    s_mul_i32 s60, s63, 5440
    s_add_u32 s60, s60, 118784
    v_and_b32 v15, 48, v0
    v_add3_u32 v6, s60, v243, v15
    v_mul_u32_u24 v12, 26, v0
    v_lshrrev_b32 v12, 8, v12
    v_mul_u32_u24 v12, 1120, v12
    v_and_b32 v13, -16, v246
    v_mul_u32_u24 v13, 1280, v13
    v_add3_u32 v5, v12, v13, v243
    v_and_b32 v13, 127, v246
    s_lshl_b32 s60, s44, 1
    s_add_u32 s60, s60, s43
    s_lshl_b32 s60, s60, 1
    s_lshr_b32 s61, s45, 1
    s_add_u32 s60, s60, s61
    v_lshlrev_b32 v12, 4, v13
    v_lshl_add_u32 v2, v11, 11, v12
    v_lshlrev_b32 v12, 3, v13
    v_lshl_add_u32 v12, v11, 11, v12
    v_lshl_add_u32 v3, v14, 10, v12
    v_xor_b32 v4, 0x400, v3
    s_lshl_b32 s60, s60, 1
    s_add_u32 s60, s60, s62
    s_lshl_b32 s89, s60, 14
    s_add_u32 s89, s89, 9961472
    s_lshl_b32 s88, s60, 16
    s_add_u32 s88, s88, 7864320
    s_mul_i32 s96, s43, 12
    s_add_u32 s96, s96, s44
    s_lshl_b32 s96, s96, 7
    s_add_u32 s96, s96, 11075584
    s_lshl_b32 s59, s63, 3
    s_lshr_b32 s59, 1429489207, s59
    s_and_b32 s59, s59, 255
    s_lshl_b32 s59, s59, 10
    s_add_u32 s93, s59, 16384
    s_mul_i32 s97, s46, 102400
    s_add_u32 s97, s97, s59
    s_add_u32 s97, s97, 11796480
    v_mov_b32 v37, 0
    v_lshrrev_b32 v124, 4, v0
    v_bfe_u32 v12, v0, 2, 2
    v_lshl_add_u32 v124, v124, 3, v12
    v_and_b32 v12, 3, v0
    v_lshlrev_b32 v12, 3, v12
    v_lshl_add_u32 v124, v124, 7, v12
    v_add_u32 v124, 135168, v124
    v_and_b32 v1, 31, v0
    v_lshlrev_b32 v245, 7, v1
    s_cmp_eq_u32 s40, 4
    s_cbranch_scc1 L_top2
    s_cmp_eq_u32 s40, 6
    s_cbranch_scc1 L_rare_43
L_rare_43_b:
    v_min_u32 v11, 17, v0
    v_mul_u32_u24 v11, 640, v11
    v_min_u32 v1, 8, v0
    v_lshlrev_b32 v1, 9, v1
    v_mov_b32 v12, 0x3f803f80
    v_mov_b32 v13, 0x3f803f80
    v_mov_b32 v14, 0x3f803f80
    v_mov_b32 v15, 0x3f803f80
    s_cmp_eq_u32 s40, 5
    s_cbranch_scc1 L_rare_44
L_rare_44_b:
    v_mov_b32 v16, 0
    v_mov_b32 v17, 0
    v_mov_b32 v18, 0
    v_mov_b32 v19, 0
    s_barrier
    ds_write_b128 v11, v[12:15] offset:1024
    ds_write_b128 v1, v[12:15] offset:1040
    ds_write_b128 v11, v[16:19] offset:1056
L_ba:
    s_add_u32 s61, s9, s10
    s_add_u32 s60, s9, 163840
    s_lshl_b32 s58, s91, 9
    s_add_u32 s58, s58, 139264
    s_mul_i32 s59, s91, 1280
    s_add_u32 s59, s59, 153600
    s_waitcnt lgkmcnt(0)
    s_cmp_lt_u32 s40, 4
    s_cbranch_scc1 L_yp_45
    s_setprio 1
L_yp_45:
    s_barrier
L_ba2:
    buffer_load_dwordx4 v244, s[12:15], s86 offen sc1 lds
    buffer_load_dwordx4 v[32:35], v244, s[12:15], s8 offen sc1
    s_mov_b32 m0, s58
    s_mov_b32 exec_hi, 0
    buffer_load_dwordx4 v244, s[12:15], s60 offen sc1 lds
    buffer_load_dwordx2 v[22:23], v244, s[12:15], s61 offen sc1
    s_mov_b32 m0, s59
    s_mov_b64 exec, -1
    v_mov_b32 v13, 0
    ds_read_b128 v[120:123], v13 offset:512
    buffer_load_dwordx4 v243, s[12:15], s87 offen sc1 lds
    s_mov_b64 exec, 0xffff
    buffer_load_dwordx4 v243, s[12:15], s87 offen offset:1024 sc1 lds
    s_mov_b64 exec, -1
    s_cmp_eq_u32 s34, 8
    s_cbranch_scc1 L_rare_46
L_rare_46_b:
    s_mov_b32 s92, 0
    s_mov_b32 s86, s8
    s_mov_b32 s87, s61
    v_mov_b32 v249, v244
    s_and_b32 s59, s42, 1
    s_cmp_lg_u32 s59, s43
    s_cbranch_scc1 L_rare_47
L_rare_47_b:
    s_cmp_eq_u32 s40, 1
    s_cbranch_scc1 L_rare_48
L_rare_48_b:
    s_mov_b32 s35, 1
    s_waitcnt lgkmcnt(0)
    v_readfirstlane_b32 s54, v120
    v_readfirstlane_b32 s55, v121
    v_readfirstlane_b32 s50, v123
    v_readfirstlane_b32 s98, v246
    s_not_b32 s100, s54
    s_and_b32 s100, s100, 2047
    s_sub_u32 s100, s100, s98
    s_not_b32 s101, s55
    s_and_b32 s101, s101, 2047
    s_sub_u32 s101, s101, s98
    s_min_u32 s3, s100, s101
    s_cmp_lt_u32 s40, 4
    s_cselect_b32 s3, s3, 99
    s_and_b32 s59, s42, 1
    s_cmp_eq_u32 s59, s43
    s_cselect_b32 s91, s50, 0
    s_cmp_eq_u32 s53, 4
    s_cbranch_scc1 L_stage_a
    s_cmp_eq_u32 s34, 8
    s_cbranch_scc1 L_low_try
    s_waitcnt vmcnt(2)
L_u4:
    ds_read_b128 v[16:19], v240 offset:8192
    ds_read_b64 v[20:21], v241 offset:4096
    s_waitcnt lgkmcnt(0)
    v_mfma_f32_32x32x16_bf16 v[80:95], v[16:19], v[32:35], v[208:223]
    v_mfma_f32_32x32x8_bf16 v[80:95], v[20:21], v[22:23], v[80:95]
    v_mfma_f32_32x32x16_bf16 v[64:79], v[16:19], v[32:35], v[208:223]
    s_nop 10
    v_max3_f32 v11, v80, v81, v82
    v_max3_f32 v11, v83, v84, v11
    v_max3_f32 v11, v85, v86, v11
    v_max3_f32 v11, v87, v88, v11
    v_max3_f32 v11, v89, v90, v11
    v_max3_f32 v11, v91, v92, v11
    v_max3_f32 v11, v93, v94, v11
    v_max_f32 v11, v95, v11
    v_mov_b32 v12, v11
    s_nop 1
    v_permlane32_swap_b32 v11, v12
    v_max_f32 v11, v11, v12
    s_mov_b32 exec_lo, 0
    v_cvt_pk_bf16_f32 v22, -v11, 0
    s_mov_b64 exec, -1
    s_nop 0
    v_mfma_f32_32x32x8_bf16 v[64:79], v[20:21], v[22:23], v[64:79]
    s_cmp_eq_u32 s34, 8
    s_cbranch_scc1 L_bb2
    s_waitcnt vmcnt(8)
    s_cmp_eq_u32 s53, 4
    s_cbranch_scc1 L_bb2
    s_waitcnt vmcnt(0)
L_bb2:
    s_cmp_lt_u32 s40, 4
    s_cbranch_scc1 L_att_o
    s_cmp_eq_u32 s53, 6
    s_cbranch_scc1 L_att_b
L_att_y:
    ds_read_b128 v[24:27], v242 offset:10240
    ds_read_b128 v[28:31], v242 offset:10880
    s_nop 6
    v_exp_f32 v64, v64
    v_exp_f32 v65, v65
    v_exp_f32 v66, v66
    v_exp_f32 v67, v67
    v_exp_f32 v68, v68
    v_exp_f32 v69, v69
    v_exp_f32 v70, v70
    v_exp_f32 v71, v71
    v_cvt_pk_bf16_f32 v96, v64, v65
    v_cvt_pk_bf16_f32 v97, v66, v67
    v_cvt_pk_bf16_f32 v98, v68, v69
    v_cvt_pk_bf16_f32 v99, v70, v71
    s_cmp_eq_u32 s35, 0
    s_cbranch_scc1 L_bb_49
    s_barrier
    s_mov_b32 s35, 0
    s_setprio 1
L_bb_49:
    v_exp_f32 v72, v72
    ds_read_b128 v[16:19], v240 offset:7168
    v_exp_f32 v73, v73
    ds_read_b64 v[20:21], v241 offset:3584
    s_waitcnt lgkmcnt(2)
    v_mfma_f32_32x32x16_bf16 v[104:119], v[24:27], v[96:99], 0
    v_exp_f32 v74, v74
    v_exp_f32 v75, v75
    v_exp_f32 v76, v76
    v_exp_f32 v77, v77
    s_waitcnt lgkmcnt(0)
    v_mfma_f32_32x32x16_bf16 v[80:95], v[16:19], v[32:35], 0
    v_exp_f32 v78, v78
    v_exp_f32 v79, v79
    v_cvt_pk_bf16_f32 v100, v72, v73
    v_cvt_pk_bf16_f32 v101, v74, v75
    v_mfma_f32_32x32x8_bf16 v[80:95], v[20:21], v[22:23], v[80:95]
    v_cvt_pk_bf16_f32 v102, v76, v77
    v_cvt_pk_bf16_f32 v103, v78, v79
    ds_read_b128 v[16:19], v240 offset:6144
    ds_read_b64 v[20:21], v241 offset:3072
    v_mfma_f32_32x32x16_bf16 v[104:119], v[28:31], v[100:103], v[104:119]
    s_cmp_eq_u32 s31, 8
    s_cbranch_scc1 L_rem_y8
    s_cmp_eq_u32 s53, 4
    s_cbranch_scc1 L_rare_50
L_rare_50_b:
    s_nop 2
    v_exp_f32 v80, v80
    ds_read_b128 v[24:27], v242 offset:8960
    v_exp_f32 v81, v81
    v_exp_f32 v82, v82
    ds_read_b128 v[28:31], v242 offset:9600
    v_exp_f32 v83, v83
    s_add_u32 s60, s97, 0
    v_exp_f32 v84, v84
    s_waitcnt lgkmcnt(2)
    v_mfma_f32_32x32x16_bf16 v[64:79], v[16:19], v[32:35], 0
    v_exp_f32 v85, v85
    s_add_u32 m0, s93, 0
    v_exp_f32 v86, v86
    buffer_load_dwordx4 v243, s[12:15], s60 offen offset:0 sc1 lds
    v_exp_f32 v87, v87
    v_mfma_f32_32x32x8_bf16 v[64:79], v[20:21], v[22:23], v[64:79]
    v_cvt_pk_bf16_f32 v96, v80, v81
    v_cvt_pk_bf16_f32 v97, v82, v83
    v_cvt_pk_bf16_f32 v98, v84, v85
    v_cvt_pk_bf16_f32 v99, v86, v87
    v_exp_f32 v88, v88
    ds_read_b128 v[16:19], v240 offset:5120
    v_exp_f32 v89, v89
    ds_read_b64 v[20:21], v241 offset:2560
    s_waitcnt lgkmcnt(2)
    v_mfma_f32_32x32x16_bf16 v[104:119], v[24:27], v[96:99], v[104:119]
    v_exp_f32 v90, v90
    buffer_load_dwordx4 v243, s[12:15], s60 offen offset:1024 sc1 lds
    v_exp_f32 v91, v91
    buffer_load_dwordx4 v243, s[12:15], s60 offen offset:2048 sc1 lds
    v_exp_f32 v92, v92
    buffer_load_dword v10, v248, s[12:15], 0 offen sc1
    v_exp_f32 v93, v93
    v_exp_f32 v94, v94
    v_exp_f32 v95, v95
    v_cvt_pk_bf16_f32 v100, v88, v89
    v_cvt_pk_bf16_f32 v101, v90, v91
    v_cvt_pk_bf16_f32 v102, v92, v93
    v_cvt_pk_bf16_f32 v103, v94, v95
    s_cmp_eq_u32 s31, 7
    s_cbranch_scc1 L_rem_y7
    v_exp_f32 v64, v64
    ds_read_b128 v[24:27], v242 offset:7680
    v_exp_f32 v65, v65
    v_mfma_f32_32x32x16_bf16 v[104:119], v[28:31], v[100:103], v[104:119]
    v_exp_f32 v66, v66
    ds_read_b128 v[28:31], v242 offset:8320
    v_exp_f32 v67, v67
    buffer_load_dwordx4 v243, s[12:15], s60 offen offset:3072 sc1 lds
    v_exp_f32 v68, v68
    s_waitcnt lgkmcnt(2)
    v_mfma_f32_32x32x16_bf16 v[80:95], v[16:19], v[32:35], 0
    v_exp_f32 v69, v69
    s_add_u32 s60, s97, 4096
    v_exp_f32 v70, v70
    s_add_u32 m0, s93, 4096
    v_exp_f32 v71, v71
    v_mfma_f32_32x32x8_bf16 v[80:95], v[20:21], v[22:23], v[80:95]
    v_cvt_pk_bf16_f32 v96, v64, v65
    v_cvt_pk_bf16_f32 v97, v66, v67
    v_cvt_pk_bf16_f32 v98, v68, v69
    v_cvt_pk_bf16_f32 v99, v70, v71
    v_exp_f32 v72, v72
    ds_read_b128 v[16:19], v240 offset:4096
    v_exp_f32 v73, v73
    ds_read_b64 v[20:21], v241 offset:2048
    s_waitcnt lgkmcnt(2)
    v_mfma_f32_32x32x16_bf16 v[104:119], v[24:27], v[96:99], v[104:119]
    v_exp_f32 v74, v74
    buffer_load_dwordx4 v243, s[12:15], s60 offen offset:0 sc1 lds
    v_exp_f32 v75, v75
    v_exp_f32 v76, v76
    v_exp_f32 v77, v77
    v_exp_f32 v78, v78
    v_exp_f32 v79, v79
    v_cvt_pk_bf16_f32 v100, v72, v73
    v_cvt_pk_bf16_f32 v101, v74, v75
    v_cvt_pk_bf16_f32 v102, v76, v77
    v_cvt_pk_bf16_f32 v103, v78, v79
    s_cmp_eq_u32 s31, 6
    s_cbranch_scc1 L_rem_y6
    v_exp_f32 v80, v80
    ds_read_b128 v[24:27], v242 offset:6400
    v_exp_f32 v81, v81
    v_mfma_f32_32x32x16_bf16 v[104:119], v[28:31], v[100:103], v[104:119]
    v_exp_f32 v82, v82
    ds_read_b128 v[28:31], v242 offset:7040
    v_exp_f32 v83, v83
    buffer_load_dwordx4 v243, s[12:15], s60 offen offset:1024 sc1 lds
    v_exp_f32 v84, v84
    s_waitcnt lgkmcnt(2)
    v_mfma_f32_32x32x16_bf16 v[64:79], v[16:19], v[32:35], 0
    v_exp_f32 v85, v85
    buffer_load_dwordx4 v243, s[12:15], s60 offen offset:2048 sc1 lds
    v_exp_f32 v86, v86
    v_exp_f32 v87, v87
    v_mfma_f32_32x32x8_bf16 v[64:79], v[20:21], v[22:23], v[64:79]
    v_cvt_pk_bf16_f32 v96, v80, v81
    v_cvt_pk_bf16_f32 v97, v82, v83
    v_cvt_pk_bf16_f32 v98, v84, v85
    v_cvt_pk_bf16_f32 v99, v86, v87
    s_cmp_eq_u32 s34, 4
    s_cbranch_scc1 L_rare_51
L_rare_51_b:
    v_exp_f32 v88, v88
    ds_read_b128 v[16:19], v240 offset:3072
    v_exp_f32 v89, v89
    ds_read_b64 v[20:21], v241 offset:1536
    s_waitcnt lgkmcnt(2)
    v_mfma_f32_32x32x16_bf16 v[104:119], v[24:27], v[96:99], v[104:119]
    v_exp_f32 v90, v90
    v_exp_f32 v91, v91
    v_exp_f32 v92, v92
    v_exp_f32 v93, v93
    v_exp_f32 v94, v94
    v_exp_f32 v95, v95
    v_cvt_pk_bf16_f32 v100, v88, v89
    v_cvt_pk_bf16_f32 v101, v90, v91
    v_cvt_pk_bf16_f32 v102, v92, v93
    v_cvt_pk_bf16_f32 v103, v94, v95
    s_cmp_eq_u32 s31, 5
    s_cbranch_scc1 L_rem_y5
    v_exp_f32 v64, v64
    ds_read_b128 v[24:27], v242 offset:5120
    v_exp_f32 v65, v65
    v_mfma_f32_32x32x16_bf16 v[104:119], v[28:31], v[100:103], v[104:119]
    v_exp_f32 v66, v66
    ds_read_b128 v[28:31], v242 offset:5760
    v_exp_f32 v67, v67
    buffer_load_dwordx4 v243, s[12:15], s60 offen offset:3072 sc1 lds
    v_exp_f32 v68, v68
    s_waitcnt lgkmcnt(2)
    v_mfma_f32_32x32x16_bf16 v[80:95], v[16:19], v[32:35], 0
    v_exp_f32 v69, v69
    s_add_u32 s60, s97, 8192
    v_exp_f32 v70, v70
    s_add_u32 m0, s93, 8192
    v_exp_f32 v71, v71
    v_mfma_f32_32x32x8_bf16 v[80:95], v[20:21], v[22:23], v[80:95]
    v_cvt_pk_bf16_f32 v96, v64, v65
    v_cvt_pk_bf16_f32 v97, v66, v67
    v_cvt_pk_bf16_f32 v98, v68, v69
    v_cvt_pk_bf16_f32 v99, v70, v71
    s_cmp_eq_u32 s34, 3
    s_cbranch_scc1 L_rare_52
L_rare_52_b:
    v_exp_f32 v72, v72
    ds_read_b128 v[16:19], v240 offset:2048
    v_exp_f32 v73, v73
    ds_read_b64 v[20:21], v241 offset:1024
    s_waitcnt lgkmcnt(2)
    v_mfma_f32_32x32x16_bf16 v[104:119], v[24:27], v[96:99], v[104:119]
    v_exp_f32 v74, v74
    buffer_load_dwordx4 v243, s[12:15], s60 offen offset:0 sc1 lds
    v_exp_f32 v75, v75
    v_exp_f32 v76, v76
    v_exp_f32 v77, v77
    v_exp_f32 v78, v78
    v_exp_f32 v79, v79
    v_cvt_pk_bf16_f32 v100, v72, v73
    v_cvt_pk_bf16_f32 v101, v74, v75
    v_cvt_pk_bf16_f32 v102, v76, v77
    v_cvt_pk_bf16_f32 v103, v78, v79
    s_cmp_eq_u32 s31, 4
    s_cbranch_scc1 L_rem_y4
    v_exp_f32 v80, v80
    ds_read_b128 v[24:27], v242 offset:3840
    v_exp_f32 v81, v81
    v_mfma_f32_32x32x16_bf16 v[104:119], v[28:31], v[100:103], v[104:119]
    v_exp_f32 v82, v82
    ds_read_b128 v[28:31], v242 offset:4480
    v_exp_f32 v83, v83
    buffer_load_dwordx4 v243, s[12:15], s60 offen offset:1024 sc1 lds
    v_exp_f32 v84, v84
    s_waitcnt lgkmcnt(2)
    v_mfma_f32_32x32x16_bf16 v[64:79], v[16:19], v[32:35], 0
    v_exp_f32 v85, v85
    buffer_load_dwordx4 v243, s[12:15], s60 offen offset:2048 sc1 lds
    v_exp_f32 v86, v86
    v_exp_f32 v87, v87
    v_mfma_f32_32x32x8_bf16 v[64:79], v[20:21], v[22:23], v[64:79]
    v_cvt_pk_bf16_f32 v96, v80, v81
    v_cvt_pk_bf16_f32 v97, v82, v83
    v_cvt_pk_bf16_f32 v98, v84, v85
    v_cvt_pk_bf16_f32 v99, v86, v87
    s_cmp_eq_u32 s34, 2
    s_cbranch_scc1 L_rare_53
L_rare_53_b:
    v_exp_f32 v88, v88
    ds_read_b128 v[16:19], v240 offset:1024
    v_exp_f32 v89, v89
    ds_read_b64 v[20:21], v241 offset:512
    s_waitcnt lgkmcnt(2)
    v_mfma_f32_32x32x16_bf16 v[104:119], v[24:27], v[96:99], v[104:119]
    v_exp_f32 v90, v90
    v_exp_f32 v91, v91
    v_exp_f32 v92, v92
    v_exp_f32 v93, v93
    v_exp_f32 v94, v94
    v_exp_f32 v95, v95
    v_cvt_pk_bf16_f32 v100, v88, v89
    v_cvt_pk_bf16_f32 v101, v90, v91
    v_cvt_pk_bf16_f32 v102, v92, v93
    v_cvt_pk_bf16_f32 v103, v94, v95
    s_cmp_eq_u32 s31, 3
    s_cbranch_scc1 L_rem_y3
    s_setprio 0
    v_exp_f32 v64, v64
    ds_read_b128 v[24:27], v242 offset:2560
    v_exp_f32 v65, v65
    v_mfma_f32_32x32x16_bf16 v[104:119], v[28:31], v[100:103], v[104:119]
    v_exp_f32 v66, v66
    ds_read_b128 v[28:31], v242 offset:3200
    v_exp_f32 v67, v67
    buffer_load_dwordx4 v243, s[12:15], s60 offen offset:3072 sc1 lds
    v_exp_f32 v68, v68
    s_waitcnt lgkmcnt(2)
    v_mfma_f32_32x32x16_bf16 v[80:95], v[16:19], v[32:35], 0
    v_exp_f32 v69, v69
    s_add_u32 s60, s97, 12288
    v_exp_f32 v70, v70
    s_add_u32 m0, s93, 12288
    v_exp_f32 v71, v71
    v_mfma_f32_32x32x8_bf16 v[80:95], v[20:21], v[22:23], v[80:95]
    v_cvt_pk_bf16_f32 v96, v64, v65
    v_cvt_pk_bf16_f32 v97, v66, v67
    v_cvt_pk_bf16_f32 v98, v68, v69
    v_cvt_pk_bf16_f32 v99, v70, v71
    s_cmp_eq_u32 s34, 1
    s_cbranch_scc1 L_rare_54
L_rare_54_b:
    v_exp_f32 v72, v72
    ds_read_b128 v[16:19], v240 offset:0
    v_exp_f32 v73, v73
    ds_read_b64 v[20:21], v241 offset:0
    s_waitcnt lgkmcnt(2)
    v_mfma_f32_32x32x16_bf16 v[104:119], v[24:27], v[96:99], v[104:119]
    v_exp_f32 v74, v74
    buffer_load_dwordx4 v243, s[12:15], s60 offen offset:0 sc1 lds
    v_exp_f32 v75, v75
    v_exp_f32 v76, v76
    v_exp_f32 v77, v77
    v_exp_f32 v78, v78
    v_exp_f32 v79, v79
    v_cvt_pk_bf16_f32 v100, v72, v73
    v_cvt_pk_bf16_f32 v101, v74, v75
    v_cvt_pk_bf16_f32 v102, v76, v77
    v_cvt_pk_bf16_f32 v103, v78, v79
    s_cmp_eq_u32 s31, 2
    s_cbranch_scc1 L_rem_y2
    v_exp_f32 v80, v80
    ds_read_b128 v[24:27], v242 offset:1280
    v_exp_f32 v81, v81
    v_mfma_f32_32x32x16_bf16 v[104:119], v[28:31], v[100:103], v[104:119]
    v_exp_f32 v82, v82
    ds_read_b128 v[28:31], v242 offset:1920
    v_exp_f32 v83, v83
    buffer_load_dwordx4 v243, s[12:15], s60 offen offset:1024 sc1 lds
    v_exp_f32 v84, v84
    s_waitcnt lgkmcnt(2)
    v_mfma_f32_32x32x16_bf16 v[64:79], v[16:19], v[32:35], v[224:239]
    v_exp_f32 v85, v85
    buffer_load_dwordx4 v243, s[12:15], s60 offen offset:2048 sc1 lds
    v_exp_f32 v86, v86
    v_exp_f32 v87, v87
    v_mfma_f32_32x32x8_bf16 v[64:79], v[20:21], v[22:23], v[64:79]
    v_cvt_pk_bf16_f32 v96, v80, v81
    v_cvt_pk_bf16_f32 v97, v82, v83
    v_cvt_pk_bf16_f32 v98, v84, v85
    v_cvt_pk_bf16_f32 v99, v86, v87
    v_exp_f32 v88, v88
    v_exp_f32 v89, v89
    s_waitcnt lgkmcnt(0)
    v_mfma_f32_32x32x16_bf16 v[104:119], v[24:27], v[96:99], v[104:119]
    v_exp_f32 v90, v90
    v_exp_f32 v91, v91
    v_exp_f32 v92, v92
    v_exp_f32 v93, v93
    v_exp_f32 v94, v94
    v_exp_f32 v95, v95
    v_cvt_pk_bf16_f32 v100, v88, v89
    v_cvt_pk_bf16_f32 v101, v90, v91
    v_cvt_pk_bf16_f32 v102, v92, v93
    v_cvt_pk_bf16_f32 v103, v94, v95
    s_cmp_eq_u32 s31, 1
    s_cbranch_scc1 L_rem_y1
    v_exp_f32 v64, v64
    ds_read_b128 v[24:27], v242 offset:0
    v_exp_f32 v65, v65
    v_mfma_f32_32x32x16_bf16 v[104:119], v[28:31], v[100:103], v[104:119]
    v_exp_f32 v66, v66
    ds_read_b128 v[28:31], v242 offset:640
    v_exp_f32 v67, v67
    v_exp_f32 v68, v68
    v_exp_f32 v69, v69
    v_exp_f32 v70, v70
    v_exp_f32 v71, v71
    v_cvt_pk_bf16_f32 v96, v64, v65
    v_cvt_pk_bf16_f32 v97, v66, v67
    v_cvt_pk_bf16_f32 v98, v68, v69
    v_cvt_pk_bf16_f32 v99, v70, v71
    v_exp_f32 v72, v72
    v_exp_f32 v73, v73
    s_waitcnt lgkmcnt(0)
    v_mfma_f32_32x32x16_bf16 v[104:119], v[24:27], v[96:99], v[104:119]
    v_exp_f32 v74, v74
    v_exp_f32 v75, v75
    v_exp_f32 v76, v76
    v_exp_f32 v77, v77
    v_exp_f32 v78, v78
    v_exp_f32 v79, v79
    v_cvt_pk_bf16_f32 v100, v72, v73
    v_cvt_pk_bf16_f32 v101, v74, v75
    v_cvt_pk_bf16_f32 v102, v76, v77
    v_cvt_pk_bf16_f32 v103, v78, v79
    s_nop 1
    v_mfma_f32_32x32x16_bf16 v[104:119], v[28:31], v[100:103], v[104:119]
L_att_done:
    v_mov_b32 v12, 1736441856
    s_cmp_lg_u32 s92, 0
    s_cbranch_scc1 L_att_out
    s_nop 8
    v_cmp_nle_f32 s[58:59], v116, v12
    v_cmp_gt_f32 vcc, 394264576, v116
    s_or_b64 vcc, vcc, s[58:59]
    s_cbranch_vccnz L_att_fb
L_att_out:
    s_setprio 0
    s_nop 7
    v_rcp_f32 v12, v116
    s_nop 0
    v_mul_f32 v104, v12, v104
    v_mul_f32 v105, v12, v105
    v_mul_f32 v106, v12, v106
    v_mul_f32 v107, v12, v107
    v_mul_f32 v108, v12, v108
    v_mul_f32 v109, v12, v109
    v_mul_f32 v110, v12, v110
    v_mul_f32 v111, v12, v111
    v_mul_f32 v112, v12, v112
    v_mul_f32 v113, v12, v113
    v_mul_f32 v114, v12, v114
    v_mul_f32 v115, v12, v115
    v_cvt_pk_bf16_f32 v40, v104, v105
    v_cvt_pk_bf16_f32 v41, v106, v107
    v_cvt_pk_bf16_f32 v42, v108, v109
    v_cvt_pk_bf16_f32 v43, v110, v111
    v_cvt_pk_bf16_f32 v44, v112, v113
    v_cvt_pk_bf16_f32 v45, v114, v115
    s_cmp_eq_u32 s91, 0
    s_cbranch_scc1 L_wt_55
    buffer_store_dwordx4 v[40:43], v244, s[12:15], s86 offen
    s_mov_b32 exec_hi, 0
    buffer_store_dwordx2 v[44:45], v249, s[12:15], s87 offen
    s_mov_b64 exec, -1
    s_branch L_wtd_56
L_wt_55:
    buffer_store_dwordx4 v[40:43], v244, s[12:15], s86 offen sc1
    s_mov_b32 exec_hi, 0
    buffer_store_dwordx2 v[44:45], v249, s[12:15], s87 offen sc1
    s_mov_b64 exec, -1
L_wtd_56:
    s_cmp_ge_u32 s40, 4
    s_cbranch_scc1 L_o_late
    v_and_b32 v4, 48, v0
    v_sub_u32 v1, v6, v4
    v_lshrrev_b32 v4, 1, v4
    v_add_u32 v4, v4, v1
    v_sub_u32 v4, v4, v243
    v_and_b32 v12, 15, v0
    v_mul_u32_u24 v12, 160, v12
    v_add_u32 v4, v4, v12
    s_waitcnt vmcnt(0)
    s_barrier
    ds_write_b128 v1, v[48:51] offset:0
    ds_write_b128 v1, v[52:55] offset:960
    ds_write_b128 v1, v[56:59] offset:1920
    ds_read_b64 v[22:23], v4 offset:0
    ds_read_b64 v[24:25], v4 offset:32
    ds_read_b64 v[26:27], v4 offset:64
    ds_read_b64 v[28:29], v4 offset:96
    ds_read_b64 v[30:31], v4 offset:128
    s_cmp_lt_u32 s3, 16
    s_cbranch_scc1 L_y_get
L_y_back0:
    ds_read_b64_tr_b16 v[96:97], v7 offset:0
    ds_read_b64_tr_b16 v[98:99], v7 offset:1280
    ds_read_b64_tr_b16 v[100:101], v7 offset:32
    ds_read_b64_tr_b16 v[102:103], v7 offset:1312
    ds_read_b64_tr_b16 v[104:105], v7 offset:64
    ds_read_b64_tr_b16 v[106:107], v7 offset:1344
    ds_read_b64_tr_b16 v[108:109], v7 offset:96
    ds_read_b64_tr_b16 v[110:111], v7 offset:1376
    ds_read_b64_tr_b16 v[112:113], v7 offset:128
    ds_read_b64_tr_b16 v[114:115], v7 offset:1408
    s_waitcnt lgkmcnt(10)
    v_sub_f32 v33, 1.0, v10
    v_lshlrev_b32 v12, 16, v22
    v_and_b32 v13, 0xffff0000, v22
    v_mul_f32 v12, v33, v12
    v_mul_f32 v13, v33, v13
    v_lshlrev_b32 v14, 16, v23
    v_and_b32 v15, 0xffff0000, v23
    v_mul_f32 v14, v33, v14
    v_mul_f32 v15, v33, v15
    v_lshlrev_b32 v16, 16, v24
    v_and_b32 v17, 0xffff0000, v24
    v_mul_f32 v16, v33, v16
    v_mul_f32 v17, v33, v17
    v_lshlrev_b32 v18, 16, v25
    v_and_b32 v19, 0xffff0000, v25
    v_mul_f32 v18, v33, v18
    v_mul_f32 v19, v33, v19
    v_lshlrev_b32 v20, 16, v26
    v_and_b32 v21, 0xffff0000, v26
    v_mul_f32 v20, v33, v20
    v_mul_f32 v21, v33, v21
    v_lshlrev_b32 v22, 16, v27
    v_and_b32 v23, 0xffff0000, v27
    v_mul_f32 v22, v33, v22
    v_mul_f32 v23, v33, v23
    v_lshlrev_b32 v24, 16, v28
    v_and_b32 v25, 0xffff0000, v28
    v_mul_f32 v24, v33, v24
    v_mul_f32 v25, v33, v25
    v_lshlrev_b32 v26, 16, v29
    v_and_b32 v27, 0xffff0000, v29
    v_mul_f32 v26, v33, v26
    v_mul_f32 v27, v33, v27
    v_lshlrev_b32 v28, 16, v30
    v_and_b32 v29, 0xffff0000, v30
    v_mul_f32 v28, v33, v28
    v_mul_f32 v29, v33, v29
    v_lshlrev_b32 v30, 16, v31
    v_and_b32 v31, 0xffff0000, v31
    v_mul_f32 v30, v33, v30
    v_mul_f32 v31, v33, v31
    ds_read_b64_tr_b16 v[116:117], v7 offset:6400
    ds_read_b64_tr_b16 v[118:119], v7 offset:7680
    ds_read_b64_tr_b16 v[120:121], v7 offset:6432
    ds_read_b64_tr_b16 v[122:123], v7 offset:7712
    ds_read_b64_tr_b16 v[124:125], v7 offset:6464
    ds_read_b64_tr_b16 v[126:127], v7 offset:7744
    ds_read_b64_tr_b16 v[128:129], v7 offset:6496
    ds_read_b64_tr_b16 v[130:131], v7 offset:7776
    ds_read_b64_tr_b16 v[132:133], v7 offset:6528
    ds_read_b64_tr_b16 v[134:135], v7 offset:7808
    ds_read_b64_tr_b16 v[136:137], v7 offset:12800
    ds_read_b64_tr_b16 v[138:139], v7 offset:14080
    ds_read_b64_tr_b16 v[140:141], v7 offset:12832
    ds_read_b64_tr_b16 v[142:143], v7 offset:14112
    ds_read_b64_tr_b16 v[144:145], v7 offset:12864
    ds_read_b64_tr_b16 v[146:147], v7 offset:14144
    ds_read_b64_tr_b16 v[148:149], v7 offset:12896
    ds_read_b64_tr_b16 v[150:151], v7 offset:14176
    ds_read_b64_tr_b16 v[152:153], v7 offset:12928
    ds_read_b64_tr_b16 v[154:155], v7 offset:14208
    s_barrier
    buffer_load_dwordx4 v[36:39], v2, s[12:15], s88 offen sc1
    s_add_u32 s88, s88, 10240
    buffer_load_dwordx4 v[40:43], v2, s[12:15], s88 offen sc1
    s_add_u32 s88, s88, 10240
    buffer_load_dwordx4 v[44:47], v2, s[12:15], s88 offen sc1
    s_add_u32 s88, s88, 10240
    buffer_load_dwordx4 v[48:51], v2, s[12:15], s88 offen sc1
    s_add_u32 s88, s88, 10240
    buffer_load_dwordx4 v[52:55], v2, s[12:15], s88 offen sc1
    s_add_u32 s88, s88, 10240
    buffer_load_dwordx4 v[56:59], v2, s[12:15], s88 offen sc1
    s_add_u32 s88, s88, 10240
    ds_read_b64_tr_b16 v[156:157], v7 offset:19200
    ds_read_b64_tr_b16 v[158:159], v7 offset:20480
    ds_read_b64_tr_b16 v[160:161], v7 offset:19232
    ds_read_b64_tr_b16 v[162:163], v7 offset:20512
    ds_read_b64_tr_b16 v[164:165], v7 offset:19264
    ds_read_b64_tr_b16 v[166:167], v7 offset:20544
    ds_read_b64_tr_b16 v[168:169], v7 offset:19296
    ds_read_b64_tr_b16 v[170:171], v7 offset:20576
    ds_read_b64_tr_b16 v[172:173], v7 offset:19328
    ds_read_b64_tr_b16 v[174:175], v7 offset:20608
    s_cmp_lt_u32 s3, 16
    s_cbranch_scc1 L_y_sum
L_y_back1:
    s_waitcnt vmcnt(5) lgkmcnt(0)
    v_mfma_f32_16x16x32_bf16 v[76:79], v[96:99], v[36:39], 0
    buffer_load_dwordx4 v[60:63], v2, s[12:15], s88 offen sc1
    s_add_u32 s88, s88, 10240
    ds_read_b64_tr_b16 v[176:177], v7 offset:25600
    ds_read_b64_tr_b16 v[178:179], v7 offset:26880
    v_mfma_f32_16x16x32_bf16 v[80:83], v[100:103], v[36:39], 0
    ds_read_b64_tr_b16 v[180:181], v7 offset:25632
    ds_read_b64_tr_b16 v[182:183], v7 offset:26912
    v_mfma_f32_16x16x32_bf16 v[84:87], v[104:107], v[36:39], 0
    ds_read_b64_tr_b16 v[184:185], v7 offset:25664
    ds_read_b64_tr_b16 v[186:187], v7 offset:26944
    v_mfma_f32_16x16x32_bf16 v[88:91], v[108:111], v[36:39], 0
    ds_read_b64_tr_b16 v[188:189], v7 offset:25696
    ds_read_b64_tr_b16 v[190:191], v7 offset:26976
    v_mfma_f32_16x16x32_bf16 v[92:95], v[112:115], v[36:39], 0
    ds_read_b64_tr_b16 v[192:193], v7 offset:25728
    ds_read_b64_tr_b16 v[194:195], v7 offset:27008
    s_waitcnt vmcnt(5) lgkmcnt(10)
    v_mfma_f32_16x16x32_bf16 v[76:79], v[116:119], v[40:43], v[76:79]
    buffer_load_dwordx4 v[64:67], v2, s[12:15], s88 offen sc1
    s_add_u32 s88, s88, 10240
    ds_read_b64_tr_b16 v[196:197], v7 offset:32000
    ds_read_b64_tr_b16 v[198:199], v7 offset:33280
    v_mfma_f32_16x16x32_bf16 v[80:83], v[120:123], v[40:43], v[80:83]
    ds_read_b64_tr_b16 v[200:201], v7 offset:32032
    ds_read_b64_tr_b16 v[202:203], v7 offset:33312
    v_mfma_f32_16x16x32_bf16 v[84:87], v[124:127], v[40:43], v[84:87]
    ds_read_b64_tr_b16 v[204:205], v7 offset:32064
    ds_read_b64_tr_b16 v[206:207], v7 offset:33344
    v_mfma_f32_16x16x32_bf16 v[88:91], v[128:131], v[40:43], v[88:91]
    ds_read_b64_tr_b16 v[208:209], v7 offset:32096
    ds_read_b64_tr_b16 v[210:211], v7 offset:33376
    v_mfma_f32_16x16x32_bf16 v[92:95], v[132:135], v[40:43], v[92:95]
    ds_read_b64_tr_b16 v[212:213], v7 offset:32128
    ds_read_b64_tr_b16 v[214:215], v7 offset:33408
    s_waitcnt vmcnt(5) lgkmcnt(10)
    v_mfma_f32_16x16x32_bf16 v[76:79], v[136:139], v[44:47], v[76:79]
    buffer_load_dwordx4 v[68:71], v3, s[12:15], s89 offen sc1
    s_add_u32 s89, s89, 40960
    ds_read_b64_tr_b16 v[216:217], v7 offset:38400
    ds_read_b64_tr_b16 v[218:219], v7 offset:39680
    v_mfma_f32_16x16x32_bf16 v[80:83], v[140:143], v[44:47], v[80:83]
    ds_read_b64_tr_b16 v[220:221], v7 offset:38432
    ds_read_b64_tr_b16 v[222:223], v7 offset:39712
    v_mfma_f32_16x16x32_bf16 v[84:87], v[144:147], v[44:47], v[84:87]
    ds_read_b64_tr_b16 v[224:225], v7 offset:38464
    ds_read_b64_tr_b16 v[226:227], v7 offset:39744
    v_mfma_f32_16x16x32_bf16 v[88:91], v[148:151], v[44:47], v[88:91]
    ds_read_b64_tr_b16 v[228:229], v7 offset:38496
    ds_read_b64_tr_b16 v[230:231], v7 offset:39776
    v_mfma_f32_16x16x32_bf16 v[92:95], v[152:155], v[44:47], v[92:95]
    ds_read_b64_tr_b16 v[232:233], v7 offset:38528
    ds_read_b64_tr_b16 v[234:235], v7 offset:39808
    s_waitcnt vmcnt(5) lgkmcnt(10)
    v_mfma_f32_16x16x32_bf16 v[76:79], v[156:159], v[48:51], v[76:79]
    buffer_load_dwordx4 v[72:75], v3, s[12:15], s89 offen sc1
    s_add_u32 s89, s89, 40960
    ds_read_b64_tr_b16 v[236:237], v7 offset:44800
    ds_read_b64_tr_b16 v[238:239], v7 offset:46080
    v_mfma_f32_16x16x32_bf16 v[80:83], v[160:163], v[48:51], v[80:83]
    ds_read_b64_tr_b16 v[240:241], v7 offset:44832
    ds_read_b64_tr_b16 v[242:243], v7 offset:46112
    v_mfma_f32_16x16x32_bf16 v[84:87], v[164:167], v[48:51], v[84:87]
    ds_read_b64_tr_b16 v[244:245], v7 offset:44864
    ds_read_b64_tr_b16 v[246:247], v7 offset:46144
    v_mfma_f32_16x16x32_bf16 v[88:91], v[168:171], v[48:51], v[88:91]
    ds_read_b64_tr_b16 v[248:249], v7 offset:44896
    ds_read_b64_tr_b16 v[250:251], v7 offset:46176
    v_mfma_f32_16x16x32_bf16 v[92:95], v[172:175], v[48:51], v[92:95]
    ds_read_b64_tr_b16 v[252:253], v7 offset:44928
    ds_read_b64_tr_b16 v[254:255], v7 offset:46208
    s_waitcnt vmcnt(5) lgkmcnt(10)
    v_mfma_f32_16x16x32_bf16 v[76:79], v[176:179], v[52:55], v[76:79]
    ds_read_b64_tr_b16 v[96:97], v8 offset:2560
    ds_read_b64_tr_b16 v[98:99], v9 offset:2560
    v_mfma_f32_16x16x32_bf16 v[80:83], v[180:183], v[52:55], v[80:83]
    ds_read_b64_tr_b16 v[100:101], v8 offset:2592
    ds_read_b64_tr_b16 v[102:103], v9 offset:2592
    v_mfma_f32_16x16x32_bf16 v[84:87], v[184:187], v[52:55], v[84:87]
    ds_read_b64_tr_b16 v[104:105], v8 offset:2624
    ds_read_b64_tr_b16 v[106:107], v9 offset:2624
    v_mfma_f32_16x16x32_bf16 v[88:91], v[188:191], v[52:55], v[88:91]
    ds_read_b64_tr_b16 v[108:109], v8 offset:2656
    ds_read_b64_tr_b16 v[110:111], v9 offset:2656
    v_mfma_f32_16x16x32_bf16 v[92:95], v[192:195], v[52:55], v[92:95]
    ds_read_b64_tr_b16 v[112:113], v8 offset:2688
    ds_read_b64_tr_b16 v[114:115], v9 offset:2688
    s_waitcnt vmcnt(4) lgkmcnt(10)
    v_mfma_f32_16x16x32_bf16 v[76:79], v[196:199], v[56:59], v[76:79]
    ds_read_b64_tr_b16 v[116:117], v8 offset:28160
    ds_read_b64_tr_b16 v[118:119], v9 offset:28160
    v_mfma_f32_16x16x32_bf16 v[80:83], v[200:203], v[56:59], v[80:83]
    ds_read_b64_tr_b16 v[120:121], v8 offset:28192
    ds_read_b64_tr_b16 v[122:123], v9 offset:28192
    v_mfma_f32_16x16x32_bf16 v[84:87], v[204:207], v[56:59], v[84:87]
    ds_read_b64_tr_b16 v[124:125], v8 offset:28224
    ds_read_b64_tr_b16 v[126:127], v9 offset:28224
    v_mfma_f32_16x16x32_bf16 v[88:91], v[208:211], v[56:59], v[88:91]
    ds_read_b64_tr_b16 v[128:129], v8 offset:28256
    ds_read_b64_tr_b16 v[130:131], v9 offset:28256
    v_mfma_f32_16x16x32_bf16 v[92:95], v[212:215], v[56:59], v[92:95]
    ds_read_b64_tr_b16 v[132:133], v8 offset:28288
    ds_read_b64_tr_b16 v[134:135], v9 offset:28288
    s_waitcnt vmcnt(3)
    v_mfma_f32_16x16x32_bf16 v[76:79], v[216:219], v[60:63], v[76:79]
    v_mfma_f32_16x16x32_bf16 v[80:83], v[220:223], v[60:63], v[80:83]
    v_mfma_f32_16x16x32_bf16 v[84:87], v[224:227], v[60:63], v[84:87]
    v_mfma_f32_16x16x32_bf16 v[88:91], v[228:231], v[60:63], v[88:91]
    v_mfma_f32_16x16x32_bf16 v[92:95], v[232:235], v[60:63], v[92:95]
    s_waitcnt vmcnt(2) lgkmcnt(0)
    v_mfma_f32_16x16x32_bf16 v[76:79], v[236:239], v[64:67], v[76:79]
    v_mfma_f32_16x16x32_bf16 v[80:83], v[240:243], v[64:67], v[80:83]
    v_mfma_f32_16x16x32_bf16 v[84:87], v[244:247], v[64:67], v[84:87]
    v_mfma_f32_16x16x32_bf16 v[88:91], v[248:251], v[64:67], v[88:91]
    v_mfma_f32_16x16x32_bf16 v[92:95], v[252:255], v[64:67], v[92:95]
    s_waitcnt vmcnt(1) lgkmcnt(0)
    v_mfma_f32_16x16x32_bf16 v[76:79], v[96:99], v[68:71], v[76:79]
    v_mfma_f32_16x16x32_bf16 v[80:83], v[100:103], v[68:71], v[80:83]
    v_mfma_f32_16x16x32_bf16 v[84:87], v[104:107], v[68:71], v[84:87]
    v_mfma_f32_16x16x32_bf16 v[88:91], v[108:111], v[68:71], v[88:91]
    v_mfma_f32_16x16x32_bf16 v[92:95], v[112:115], v[68:71], v[92:95]
    s_waitcnt vmcnt(0) lgkmcnt(0)
    v_mfma_f32_16x16x32_bf16 v[76:79], v[116:119], v[72:75], v[76:79]
    v_mfma_f32_16x16x32_bf16 v[80:83], v[120:123], v[72:75], v[80:83]
    v_mfma_f32_16x16x32_bf16 v[84:87], v[124:127], v[72:75], v[84:87]
    v_mfma_f32_16x16x32_bf16 v[88:91], v[128:131], v[72:75], v[88:91]
    v_mfma_f32_16x16x32_bf16 v[92:95], v[132:135], v[72:75], v[92:95]
    s_nop 3
    v_fma_f32 v76, v10, v76, v12
    v_fma_f32 v77, v10, v77, v13
    v_fma_f32 v78, v10, v78, v14
    v_fma_f32 v79, v10, v79, v15
    ds_write_b128 v6, v[76:79] offset:0
    v_fma_f32 v80, v10, v80, v16
    v_fma_f32 v81, v10, v81, v17
    v_fma_f32 v82, v10, v82, v18
    v_fma_f32 v83, v10, v83, v19
    ds_write_b128 v6, v[80:83] offset:1088
    v_fma_f32 v84, v10, v84, v20
    v_fma_f32 v85, v10, v85, v21
    v_fma_f32 v86, v10, v86, v22
    v_fma_f32 v87, v10, v87, v23
    ds_write_b128 v6, v[84:87] offset:2176
    v_fma_f32 v88, v10, v88, v24
    v_fma_f32 v89, v10, v89, v25
    v_fma_f32 v90, v10, v90, v26
    v_fma_f32 v91, v10, v91, v27
    ds_write_b128 v6, v[88:91] offset:3264
    v_fma_f32 v92, v10, v92, v28
    v_fma_f32 v93, v10, v93, v29
    v_fma_f32 v94, v10, v94, v30
    v_fma_f32 v95, v10, v95, v31
    ds_write_b128 v6, v[92:95] offset:4352
    s_waitcnt lgkmcnt(0)
    s_barrier
    s_branch L_fin
L_o_late:
    v_and_b32 v11, 15, v0
    v_lshlrev_b32 v11, 11, v11
    s_lshl_b32 s62, s2, 7
    s_add_u32 s62, s62, 11075584
    v_mov_b32 v22, 0
    v_mov_b32 v23, 1
    v_and_b32 v33, 48, v0
    v_sub_u32 v32, v6, v33
    v_lshrrev_b32 v33, 1, v33
    v_add_u32 v33, v33, v32
    v_sub_u32 v33, v33, v243
    v_and_b32 v12, 15, v0
    v_mul_u32_u24 v12, 160, v12
    v_add_u32 v33, v33, v12
    s_cmp_eq_u32 s40, 7
    s_cbranch_scc1 L_o_l7
    s_cmp_lg_u32 s40, 4
    s_cbranch_scc1 L_o_l0
    s_mov_b64 exec, 1
    s_cmp_eq_u32 s91, 0
    s_cbranch_scc1 L_wt_57
    s_waitcnt vmcnt(0)
    s_barrier
    buffer_store_dword v23, v22, s[12:15], s62 offen
    s_branch L_wtd_58
L_wt_57:
    s_waitcnt vmcnt(0)
    s_barrier
    buffer_store_dword v23, v22, s[12:15], s62 offen sc1
L_wtd_58:
    s_mov_b64 exec, -1
    s_branch L_o_l1
L_o_l0:
    s_waitcnt vmcnt(0)
    s_barrier
L_o_l1:
    ds_read_b64_tr_b16 v[96:97], v7 offset:0
    ds_read_b64_tr_b16 v[98:99], v7 offset:1280
    ds_read_b64_tr_b16 v[100:101], v7 offset:32
    ds_read_b64_tr_b16 v[102:103], v7 offset:1312
    ds_read_b64_tr_b16 v[104:105], v7 offset:64
    ds_read_b64_tr_b16 v[106:107], v7 offset:1344
    ds_read_b64_tr_b16 v[108:109], v7 offset:96
    ds_read_b64_tr_b16 v[110:111], v7 offset:1376
    ds_read_b64_tr_b16 v[112:113], v7 offset:128
    ds_read_b64_tr_b16 v[114:115], v7 offset:1408
    ds_read_b64_tr_b16 v[116:117], v7 offset:6400
    ds_read_b64_tr_b16 v[118:119], v7 offset:7680
    ds_read_b64_tr_b16 v[120:121], v7 offset:6432
    ds_read_b64_tr_b16 v[122:123], v7 offset:7712
    ds_read_b64_tr_b16 v[124:125], v7 offset:6464
    ds_read_b64_tr_b16 v[126:127], v7 offset:7744
    ds_read_b64_tr_b16 v[128:129], v7 offset:6496
    ds_read_b64_tr_b16 v[130:131], v7 offset:7776
    ds_read_b64_tr_b16 v[132:133], v7 offset:6528
    ds_read_b64_tr_b16 v[134:135], v7 offset:7808
    ds_read_b64_tr_b16 v[136:137], v7 offset:12800
    ds_read_b64_tr_b16 v[138:139], v7 offset:14080
    ds_read_b64_tr_b16 v[140:141], v7 offset:12832
    ds_read_b64_tr_b16 v[142:143], v7 offset:14112
    ds_read_b64_tr_b16 v[144:145], v7 offset:12864
    ds_read_b64_tr_b16 v[146:147], v7 offset:14144
    ds_read_b64_tr_b16 v[148:149], v7 offset:12896
    ds_read_b64_tr_b16 v[150:151], v7 offset:14176
    ds_read_b64_tr_b16 v[152:153], v7 offset:12928
    ds_read_b64_tr_b16 v[154:155], v7 offset:14208
    s_barrier
L_o_l3:
    ds_read_b64_tr_b16 v[156:157], v7 offset:19200
    ds_read_b64_tr_b16 v[158:159], v7 offset:20480
    ds_read_b64_tr_b16 v[160:161], v7 offset:19232
    ds_read_b64_tr_b16 v[162:163], v7 offset:20512
    ds_read_b64_tr_b16 v[164:165], v7 offset:19264
    ds_read_b64_tr_b16 v[166:167], v7 offset:20544
    ds_read_b64_tr_b16 v[168:169], v7 offset:19296
    ds_read_b64_tr_b16 v[170:171], v7 offset:20576
    ds_read_b64_tr_b16 v[172:173], v7 offset:19328
    ds_read_b64_tr_b16 v[174:175], v7 offset:20608
    ds_read_b64_tr_b16 v[176:177], v7 offset:25600
    ds_read_b64_tr_b16 v[178:179], v7 offset:26880
    ds_read_b64_tr_b16 v[180:181], v7 offset:25632
    ds_read_b64_tr_b16 v[182:183], v7 offset:26912
    ds_read_b64_tr_b16 v[184:185], v7 offset:25664
    ds_read_b64_tr_b16 v[186:187], v7 offset:26944
    ds_read_b64_tr_b16 v[188:189], v7 offset:25696
    ds_read_b64_tr_b16 v[190:191], v7 offset:26976
    ds_read_b64_tr_b16 v[192:193], v7 offset:25728
    ds_read_b64_tr_b16 v[194:195], v7 offset:27008
    ds_read_b64_tr_b16 v[196:197], v7 offset:32000
    ds_read_b64_tr_b16 v[198:199], v7 offset:33280
    ds_read_b64_tr_b16 v[200:201], v7 offset:32032
    ds_read_b64_tr_b16 v[202:203], v7 offset:33312
    ds_read_b64_tr_b16 v[204:205], v7 offset:32064
    ds_read_b64_tr_b16 v[206:207], v7 offset:33344
    ds_read_b64_tr_b16 v[208:209], v7 offset:32096
    ds_read_b64_tr_b16 v[210:211], v7 offset:33376
    ds_read_b64_tr_b16 v[212:213], v7 offset:32128
    ds_read_b64_tr_b16 v[214:215], v7 offset:33408
    ds_read_b64_tr_b16 v[216:217], v7 offset:38400
    ds_read_b64_tr_b16 v[218:219], v7 offset:39680
    ds_read_b64_tr_b16 v[220:221], v7 offset:38432
    ds_read_b64_tr_b16 v[222:223], v7 offset:39712
    ds_read_b64_tr_b16 v[224:225], v7 offset:38464
    ds_read_b64_tr_b16 v[226:227], v7 offset:39744
    ds_read_b64_tr_b16 v[228:229], v7 offset:38496
    ds_read_b64_tr_b16 v[230:231], v7 offset:39776
    ds_read_b64_tr_b16 v[232:233], v7 offset:38528
    ds_read_b64_tr_b16 v[234:235], v7 offset:39808
    ds_read_b64_tr_b16 v[236:237], v7 offset:44800
    ds_read_b64_tr_b16 v[238:239], v7 offset:46080
    ds_read_b64_tr_b16 v[240:241], v7 offset:44832
    ds_read_b64_tr_b16 v[242:243], v7 offset:46112
    ds_read_b64_tr_b16 v[244:245], v7 offset:44864
    ds_read_b64_tr_b16 v[246:247], v7 offset:46144
    ds_read_b64_tr_b16 v[248:249], v7 offset:44896
    ds_read_b64_tr_b16 v[250:251], v7 offset:46176
    ds_read_b64_tr_b16 v[252:253], v7 offset:44928
    ds_read_b64_tr_b16 v[254:255], v7 offset:46208
    s_mov_b32 s90, 0
L_lp_59:
    ds_read_b32 v24, v22 offset:528
    s_add_u32 s90, s90, 1
    s_cmp_gt_u32 s90, 1000000
    s_waitcnt lgkmcnt(0)
    s_cbranch_scc1 L_lpd_60
    v_cmp_gt_u32 vcc, 1, v24
    s_cbranch_vccnz L_lp_59
L_lpd_60:
L_o_l4:
    buffer_load_dwordx4 v[36:39], v2, s[12:15], s88 offen sc1
    s_add_u32 s88, s88, 8192
    buffer_load_dwordx4 v[40:43], v2, s[12:15], s88 offen sc1
    s_add_u32 s88, s88, 8192
    buffer_load_dwordx4 v[44:47], v2, s[12:15], s88 offen sc1
    s_add_u32 s88, s88, 8192
    buffer_load_dwordx4 v[48:51], v2, s[12:15], s88 offen sc1
    s_add_u32 s88, s88, 8192
    buffer_load_dwordx4 v[52:55], v2, s[12:15], s88 offen sc1
    s_add_u32 s88, s88, 8192
    buffer_load_dwordx4 v[56:59], v2, s[12:15], s88 offen sc1
    s_add_u32 s88, s88, 8192
    buffer_load_dwordx4 v[60:63], v2, s[12:15], s88 offen sc1
    s_add_u32 s88, s88, 8192
    buffer_load_dwordx4 v[64:67], v2, s[12:15], s88 offen sc1
    s_add_u32 s88, s88, 8192
L_o_l5:
    s_waitcnt vmcnt(7) lgkmcnt(0)
    v_mfma_f32_16x16x32_bf16 v[76:79], v[96:99], v[36:39], 0
    buffer_load_dwordx2 v[68:69], v3, s[12:15], s89 offen sc1
    buffer_load_dwordx2 v[70:71], v4, s[12:15], s89 offen sc1
    s_add_u32 s89, s89, 8192
    v_mfma_f32_16x16x32_bf16 v[80:83], v[100:103], v[36:39], 0
    v_mfma_f32_16x16x32_bf16 v[84:87], v[104:107], v[36:39], 0
    v_mfma_f32_16x16x32_bf16 v[88:91], v[108:111], v[36:39], 0
    v_mfma_f32_16x16x32_bf16 v[92:95], v[112:115], v[36:39], 0
    s_waitcnt vmcnt(8) lgkmcnt(10)
    v_mfma_f32_16x16x32_bf16 v[76:79], v[116:119], v[40:43], v[76:79]
    buffer_load_dwordx2 v[72:73], v3, s[12:15], s89 offen sc1
    buffer_load_dwordx2 v[74:75], v4, s[12:15], s89 offen sc1
    s_add_u32 s89, s89, 8192
    ds_read_b64_tr_b16 v[96:97], v8 offset:2560
    ds_read_b64_tr_b16 v[98:99], v9 offset:2560
    v_mfma_f32_16x16x32_bf16 v[80:83], v[120:123], v[40:43], v[80:83]
    ds_read_b64_tr_b16 v[100:101], v8 offset:2592
    ds_read_b64_tr_b16 v[102:103], v9 offset:2592
    v_mfma_f32_16x16x32_bf16 v[84:87], v[124:127], v[40:43], v[84:87]
    ds_read_b64_tr_b16 v[104:105], v8 offset:2624
    ds_read_b64_tr_b16 v[106:107], v9 offset:2624
    v_mfma_f32_16x16x32_bf16 v[88:91], v[128:131], v[40:43], v[88:91]
    ds_read_b64_tr_b16 v[108:109], v8 offset:2656
    ds_read_b64_tr_b16 v[110:111], v9 offset:2656
    v_mfma_f32_16x16x32_bf16 v[92:95], v[132:135], v[40:43], v[92:95]
    ds_read_b64_tr_b16 v[112:113], v8 offset:2688
    ds_read_b64_tr_b16 v[114:115], v9 offset:2688
    s_waitcnt vmcnt(9) lgkmcnt(10)
    v_mfma_f32_16x16x32_bf16 v[76:79], v[136:139], v[44:47], v[76:79]
    ds_read_b64_tr_b16 v[116:117], v8 offset:28160
    ds_read_b64_tr_b16 v[118:119], v9 offset:28160
    v_mfma_f32_16x16x32_bf16 v[80:83], v[140:143], v[44:47], v[80:83]
    ds_read_b64_tr_b16 v[120:121], v8 offset:28192
    ds_read_b64_tr_b16 v[122:123], v9 offset:28192
    v_mfma_f32_16x16x32_bf16 v[84:87], v[144:147], v[44:47], v[84:87]
    ds_read_b64_tr_b16 v[124:125], v8 offset:28224
    ds_read_b64_tr_b16 v[126:127], v9 offset:28224
    v_mfma_f32_16x16x32_bf16 v[88:91], v[148:151], v[44:47], v[88:91]
    ds_read_b64_tr_b16 v[128:129], v8 offset:28256
    ds_read_b64_tr_b16 v[130:131], v9 offset:28256
    v_mfma_f32_16x16x32_bf16 v[92:95], v[152:155], v[44:47], v[92:95]
    ds_read_b64_tr_b16 v[132:133], v8 offset:28288
    ds_read_b64_tr_b16 v[134:135], v9 offset:28288
    s_waitcnt vmcnt(8)
    v_mfma_f32_16x16x32_bf16 v[76:79], v[156:159], v[48:51], v[76:79]
    v_mfma_f32_16x16x32_bf16 v[80:83], v[160:163], v[48:51], v[80:83]
    v_mfma_f32_16x16x32_bf16 v[84:87], v[164:167], v[48:51], v[84:87]
    v_mfma_f32_16x16x32_bf16 v[88:91], v[168:171], v[48:51], v[88:91]
    v_mfma_f32_16x16x32_bf16 v[92:95], v[172:175], v[48:51], v[92:95]
    s_waitcnt vmcnt(7)
    v_mfma_f32_16x16x32_bf16 v[76:79], v[176:179], v[52:55], v[76:79]
    v_mfma_f32_16x16x32_bf16 v[80:83], v[180:183], v[52:55], v[80:83]
    v_mfma_f32_16x16x32_bf16 v[84:87], v[184:187], v[52:55], v[84:87]
    v_mfma_f32_16x16x32_bf16 v[88:91], v[188:191], v[52:55], v[88:91]
    v_mfma_f32_16x16x32_bf16 v[92:95], v[192:195], v[52:55], v[92:95]
    s_waitcnt vmcnt(6)
    v_mfma_f32_16x16x32_bf16 v[76:79], v[196:199], v[56:59], v[76:79]
    v_mfma_f32_16x16x32_bf16 v[80:83], v[200:203], v[56:59], v[80:83]
    v_mfma_f32_16x16x32_bf16 v[84:87], v[204:207], v[56:59], v[84:87]
    v_mfma_f32_16x16x32_bf16 v[88:91], v[208:211], v[56:59], v[88:91]
    v_mfma_f32_16x16x32_bf16 v[92:95], v[212:215], v[56:59], v[92:95]
    s_waitcnt vmcnt(5)
    v_mfma_f32_16x16x32_bf16 v[76:79], v[216:219], v[60:63], v[76:79]
    v_mfma_f32_16x16x32_bf16 v[80:83], v[220:223], v[60:63], v[80:83]
    v_mfma_f32_16x16x32_bf16 v[84:87], v[224:227], v[60:63], v[84:87]
    v_mfma_f32_16x16x32_bf16 v[88:91], v[228:231], v[60:63], v[88:91]
    v_mfma_f32_16x16x32_bf16 v[92:95], v[232:235], v[60:63], v[92:95]
    s_barrier
    ds_read_b128 v[36:39], v6 offset:0
    ds_read_b128 v[40:43], v6 offset:1088
    ds_read_b128 v[44:47], v6 offset:2176
    ds_read_b128 v[48:51], v6 offset:3264
    ds_read_b128 v[52:55], v6 offset:4352
    s_waitcnt vmcnt(0) lgkmcnt(5)
    v_mfma_f32_16x16x32_bf16 v[76:79], v[236:239], v[64:67], v[76:79]
    v_mfma_f32_16x16x32_bf16 v[76:79], v[96:99], v[68:71], v[76:79]
    v_mfma_f32_16x16x32_bf16 v[76:79], v[116:119], v[72:75], v[76:79]
    v_mfma_f32_16x16x32_bf16 v[80:83], v[240:243], v[64:67], v[80:83]
    v_mfma_f32_16x16x32_bf16 v[80:83], v[100:103], v[68:71], v[80:83]
    v_mfma_f32_16x16x32_bf16 v[80:83], v[120:123], v[72:75], v[80:83]
    v_mfma_f32_16x16x32_bf16 v[84:87], v[244:247], v[64:67], v[84:87]
    v_mfma_f32_16x16x32_bf16 v[84:87], v[104:107], v[68:71], v[84:87]
    v_mfma_f32_16x16x32_bf16 v[84:87], v[124:127], v[72:75], v[84:87]
    v_mfma_f32_16x16x32_bf16 v[88:91], v[248:251], v[64:67], v[88:91]
    s_waitcnt lgkmcnt(0)
    v_fma_f32 v76, v10, v76, v36
    v_fma_f32 v77, v10, v77, v37
    v_fma_f32 v78, v10, v78, v38
    v_mfma_f32_16x16x32_bf16 v[88:91], v[108:111], v[68:71], v[88:91]
    v_fma_f32 v79, v10, v79, v39
    v_cvt_pk_bf16_f32 v12, v76, v77
    v_cvt_pk_bf16_f32 v13, v78, v79
    v_mfma_f32_16x16x32_bf16 v[88:91], v[128:131], v[72:75], v[88:91]
    ds_write_b64 v33, v[12:13] offset:0
    v_fma_f32 v80, v10, v80, v40
    v_fma_f32 v81, v10, v81, v41
    v_mfma_f32_16x16x32_bf16 v[92:95], v[252:255], v[64:67], v[92:95]
    v_fma_f32 v82, v10, v82, v42
    v_fma_f32 v83, v10, v83, v43
    v_cvt_pk_bf16_f32 v14, v80, v81
    v_mfma_f32_16x16x32_bf16 v[92:95], v[112:115], v[68:71], v[92:95]
    v_cvt_pk_bf16_f32 v15, v82, v83
    ds_write_b64 v33, v[14:15] offset:32
    v_fma_f32 v84, v10, v84, v44
    v_mfma_f32_16x16x32_bf16 v[92:95], v[132:135], v[72:75], v[92:95]
    v_fma_f32 v85, v10, v85, v45
    v_fma_f32 v86, v10, v86, v46
    v_fma_f32 v87, v10, v87, v47
    v_cvt_pk_bf16_f32 v16, v84, v85
    v_cvt_pk_bf16_f32 v17, v86, v87
    ds_write_b64 v33, v[16:17] offset:64
    v_fma_f32 v88, v10, v88, v48
    v_fma_f32 v89, v10, v89, v49
    v_fma_f32 v90, v10, v90, v50
    v_fma_f32 v91, v10, v91, v51
    v_cvt_pk_bf16_f32 v18, v88, v89
    v_cvt_pk_bf16_f32 v19, v90, v91
    ds_write_b64 v33, v[18:19] offset:96
    v_fma_f32 v92, v10, v92, v52
    v_fma_f32 v93, v10, v93, v53
    v_fma_f32 v94, v10, v94, v54
    v_fma_f32 v95, v10, v95, v55
    v_cvt_pk_bf16_f32 v20, v92, v93
    v_cvt_pk_bf16_f32 v21, v94, v95
    ds_write_b64 v33, v[20:21] offset:128
    ds_read_b128 v[140:143], v32 offset:0
    ds_read_b128 v[144:147], v32 offset:960
    ds_read_b128 v[148:151], v32 offset:1920
    s_add_u32 s58, s99, 7680
    s_add_u32 s59, s99, 15360
    s_mov_b32 exec_hi, 0x0fffffff
    s_waitcnt lgkmcnt(2)
    buffer_store_dwordx4 v[140:143], v5, s[20:23], s99 offen
    s_waitcnt lgkmcnt(1)
    buffer_store_dwordx4 v[144:147], v5, s[20:23], s58 offen
    s_mov_b32 exec_hi, 0xff
    s_waitcnt lgkmcnt(0)
    buffer_store_dwordx4 v[148:151], v5, s[20:23], s59 offen
L_fin:
L_end:
    s_endpgm
L_low_try:
    s_waitcnt vmcnt(0)
    v_cmp_eq_u32 vcc, 0, v126
    s_cbranch_vccnz L_u4
    s_add_u32 s58, s8, 4294641152
    s_mov_b32 m0, 125952
    s_nop 0
    buffer_load_dwordx4 v244, s[12:15], s58 offen sc1  lds
    s_add_u32 s58, s8, 4294640640
    s_mov_b32 m0, 124928
    s_nop 0
    buffer_load_dwordx4 v244, s[12:15], s58 offen sc1  lds
    s_add_u32 s58, s8, 4294640128
    s_mov_b32 m0, 123904
    s_nop 0
    buffer_load_dwordx4 v244, s[12:15], s58 offen sc1  lds
    s_add_u32 s58, s8, 4294639616
    s_mov_b32 m0, 122880
    s_nop 0
    buffer_load_dwordx4 v244, s[12:15], s58 offen sc1  lds
    s_add_u32 s58, s9, 4294639616
    s_mov_b32 m0, 137216
    s_nop 0
    buffer_load_dwordx4 v243, s[12:15], s58 offen offset:0 sc1 lds
    buffer_load_dwordx4 v243, s[12:15], s58 offen offset:1024 sc1 lds
    s_add_u32 s58, s8, 4294149632
    s_mov_b32 m0, 121856
    s_nop 0
    buffer_load_dwordx4 v244, s[12:15], s58 offen sc1  lds
    s_add_u32 s58, s8, 4294149120
    s_mov_b32 m0, 120832
    s_nop 0
    buffer_load_dwordx4 v244, s[12:15], s58 offen sc1  lds
    s_add_u32 s58, s8, 4294148608
    s_mov_b32 m0, 119808
    s_nop 0
    buffer_load_dwordx4 v244, s[12:15], s58 offen sc1  lds
    s_add_u32 s58, s8, 4294148096
    s_mov_b32 m0, 118784
    s_nop 0
    buffer_load_dwordx4 v244, s[12:15], s58 offen sc1  lds
    s_add_u32 s58, s9, 4294148096
    s_mov_b32 m0, 135168
    s_nop 0
    buffer_load_dwordx4 v243, s[12:15], s58 offen offset:0 sc1 lds
    buffer_load_dwordx4 v243, s[12:15], s58 offen offset:1024 sc1 lds
    s_sub_u32 s58, s11, 491520
    s_mov_b32 m0, 148480
    s_nop 0
    buffer_load_dwordx4 v243, s[12:15], s58 offen offset:0 sc1 lds
    buffer_load_dwordx4 v243, s[12:15], s58 offen offset:1024 sc1 lds
    buffer_load_dwordx4 v243, s[12:15], s58 offen offset:2048 sc1 lds
    buffer_load_dwordx4 v243, s[12:15], s58 offen offset:3072 sc1 lds
    s_add_u32 s58, s58, 4096
    s_mov_b32 m0, 152576
    s_nop 0
    buffer_load_dwordx4 v243, s[12:15], s58 offen sc1 lds
    s_sub_u32 s58, s11, 983040
    s_mov_b32 m0, 143360
    s_nop 0
    buffer_load_dwordx4 v243, s[12:15], s58 offen offset:0 sc1 lds
    buffer_load_dwordx4 v243, s[12:15], s58 offen offset:1024 sc1 lds
    buffer_load_dwordx4 v243, s[12:15], s58 offen offset:2048 sc1 lds
    buffer_load_dwordx4 v243, s[12:15], s58 offen offset:3072 sc1 lds
    s_add_u32 s58, s58, 4096
    s_mov_b32 m0, 147456
    s_nop 0
    buffer_load_dwordx4 v243, s[12:15], s58 offen sc1 lds
    s_mov_b32 s30, 0
    s_barrier
    s_mov_b32 s35, 0
    s_branch L_u4
L_low_wait:
    s_cmp_eq_u32 s30, 0
    s_cbranch_scc1 L_low_w2
    s_mov_b32 s90, 0
L_poll_61:
    buffer_load_dwordx2 v[126:127], v245, s[12:15], s30 offen sc1
    s_add_u32 s90, s90, 1
    s_cmp_gt_u32 s90, 200000
    s_waitcnt vmcnt(0)
    s_cbranch_scc1 L_polld_62
    v_cmp_eq_u32 vcc, 0, v126
    s_cbranch_vccnz L_poll_61
L_polld_62:
    s_add_u32 s58, s8, 4294641152
    s_mov_b32 m0, 125952
    s_nop 0
    buffer_load_dwordx4 v244, s[12:15], s58 offen sc1  lds
    s_add_u32 s58, s8, 4294640640
    s_mov_b32 m0, 124928
    s_nop 0
    buffer_load_dwordx4 v244, s[12:15], s58 offen sc1  lds
    s_add_u32 s58, s8, 4294640128
    s_mov_b32 m0, 123904
    s_nop 0
    buffer_load_dwordx4 v244, s[12:15], s58 offen sc1  lds
    s_add_u32 s58, s8, 4294639616
    s_mov_b32 m0, 122880
    s_nop 0
    buffer_load_dwordx4 v244, s[12:15], s58 offen sc1  lds
    s_add_u32 s58, s9, 4294639616
    s_mov_b32 m0, 137216
    s_nop 0
    buffer_load_dwordx4 v243, s[12:15], s58 offen offset:0 sc1 lds
    buffer_load_dwordx4 v243, s[12:15], s58 offen offset:1024 sc1 lds
    s_add_u32 s58, s8, 4294149632
    s_mov_b32 m0, 121856
    s_nop 0
    buffer_load_dwordx4 v244, s[12:15], s58 offen sc1  lds
    s_add_u32 s58, s8, 4294149120
    s_mov_b32 m0, 120832
    s_nop 0
    buffer_load_dwordx4 v244, s[12:15], s58 offen sc1  lds
    s_add_u32 s58, s8, 4294148608
    s_mov_b32 m0, 119808
    s_nop 0
    buffer_load_dwordx4 v244, s[12:15], s58 offen sc1  lds
    s_add_u32 s58, s8, 4294148096
    s_mov_b32 m0, 118784
    s_nop 0
    buffer_load_dwordx4 v244, s[12:15], s58 offen sc1  lds
    s_add_u32 s58, s9, 4294148096
    s_mov_b32 m0, 135168
    s_nop 0
    buffer_load_dwordx4 v243, s[12:15], s58 offen offset:0 sc1 lds
    buffer_load_dwordx4 v243, s[12:15], s58 offen offset:1024 sc1 lds
    s_sub_u32 s58, s11, 491520
    s_mov_b32 m0, 148480
    s_nop 0
    buffer_load_dwordx4 v243, s[12:15], s58 offen offset:0 sc1 lds
    buffer_load_dwordx4 v243, s[12:15], s58 offen offset:1024 sc1 lds
    buffer_load_dwordx4 v243, s[12:15], s58 offen offset:2048 sc1 lds
    buffer_load_dwordx4 v243, s[12:15], s58 offen offset:3072 sc1 lds
    s_add_u32 s58, s58, 4096
    s_mov_b32 m0, 152576
    s_nop 0
    buffer_load_dwordx4 v243, s[12:15], s58 offen sc1 lds
    s_sub_u32 s58, s11, 983040
    s_mov_b32 m0, 143360
    s_nop 0
    buffer_load_dwordx4 v243, s[12:15], s58 offen offset:0 sc1 lds
    buffer_load_dwordx4 v243, s[12:15], s58 offen offset:1024 sc1 lds
    buffer_load_dwordx4 v243, s[12:15], s58 offen offset:2048 sc1 lds
    buffer_load_dwordx4 v243, s[12:15], s58 offen offset:3072 sc1 lds
    s_add_u32 s58, s58, 4096
    s_mov_b32 m0, 147456
    s_nop 0
    buffer_load_dwordx4 v243, s[12:15], s58 offen sc1 lds
    s_mov_b32 s30, 0
L_low_w2:
    v_mov_b32 v14, 0
    v_mov_b32 v15, 1
    s_waitcnt vmcnt(0)
    ds_write_b32 v14, v15 offset:520
    s_mov_b32 s34, 15
    s_branch L_low_done
L_top2:
    ds_read_b64_tr_b16 v[128:129], v124 offset:0
    ds_read_b64_tr_b16 v[130:131], v124 offset:512
    ds_read_b64_tr_b16 v[132:133], v124 offset:4096
    ds_read_b64_tr_b16 v[134:135], v124 offset:4608
    ds_read_b64_tr_b16 v[136:137], v124 offset:32
    ds_read_b64_tr_b16 v[138:139], v124 offset:544
    ds_read_b64_tr_b16 v[140:141], v124 offset:4128
    ds_read_b64_tr_b16 v[142:143], v124 offset:4640
    s_waitcnt lgkmcnt(4)
    ds_read_b64_tr_b16 v[144:145], v124 offset:64
    ds_read_b64_tr_b16 v[146:147], v124 offset:576
    ds_read_b64_tr_b16 v[148:149], v124 offset:4160
    ds_read_b64_tr_b16 v[150:151], v124 offset:4672
    ds_read_b64_tr_b16 v[152:153], v124 offset:96
    ds_read_b64_tr_b16 v[154:155], v124 offset:608
    ds_read_b64_tr_b16 v[156:157], v124 offset:4192
    ds_read_b64_tr_b16 v[158:159], v124 offset:4704
    s_waitcnt lgkmcnt(4)
    ds_read_b64_tr_b16 v[160:161], v124 offset:8192
    ds_read_b64_tr_b16 v[162:163], v124 offset:8704
    ds_read_b64_tr_b16 v[164:165], v124 offset:12288
    ds_read_b64_tr_b16 v[166:167], v124 offset:12800
    ds_read_b64_tr_b16 v[168:169], v124 offset:8224
    ds_read_b64_tr_b16 v[170:171], v124 offset:8736
    ds_read_b64_tr_b16 v[172:173], v124 offset:12320
    ds_read_b64_tr_b16 v[174:175], v124 offset:12832
    s_waitcnt lgkmcnt(4)
    ds_read_b64_tr_b16 v[176:177], v124 offset:8256
    ds_read_b64_tr_b16 v[178:179], v124 offset:8768
    ds_read_b64_tr_b16 v[180:181], v124 offset:12352
    ds_read_b64_tr_b16 v[182:183], v124 offset:12864
    ds_read_b64_tr_b16 v[184:185], v124 offset:8288
    ds_read_b64_tr_b16 v[186:187], v124 offset:8800
    ds_read_b64_tr_b16 v[188:189], v124 offset:12384
    ds_read_b64_tr_b16 v[190:191], v124 offset:12896
    s_waitcnt lgkmcnt(4)
    s_waitcnt lgkmcnt(0)
    v_lshrrev_b32 v1, 2, v0
    v_and_b32 v14, 3, v0
    v_lshlrev_b32 v14, 3, v14
    v_lshl_add_u32 v245, v1, 7, v14
    s_barrier
    buffer_load_dwordx2 v[126:127], v245, s[12:15], s30 offen sc1
    s_mov_b32 s90, 0
    s_branch L_polle_66
L_poll_64:
    buffer_load_dwordx2 v[126:127], v245, s[12:15], s30 offen sc1
L_polle_66:
    s_add_u32 s90, s90, 1
    s_cmp_gt_u32 s90, 200000
    s_waitcnt vmcnt(0)
    s_cbranch_scc1 L_polld_65
    v_cmp_eq_u32 vcc, 0, v126
    s_cbranch_vccnz L_poll_64
L_polld_65:
    v_max_u32_dpp v14, v126, v126 row_ror:8 row_mask:0xf bank_mask:0xf
    s_nop 1
    v_max_u32_dpp v14, v14, v14 row_ror:4 row_mask:0xf bank_mask:0xf
    s_nop 1
    v_max_u32_dpp v14, v14, v14 row_ror:2 row_mask:0xf bank_mask:0xf
    s_nop 1
    v_max_u32_dpp v14, v14, v14 row_ror:1 row_mask:0xf bank_mask:0xf
    s_nop 0
    v_readlane_b32 s54, v14, 0
    v_readlane_b32 s63, v14, 16
    s_max_u32 s54, s54, s63
    v_readlane_b32 s63, v14, 32
    s_max_u32 s54, s54, s63
    v_readlane_b32 s63, v14, 48
    s_max_u32 s54, s54, s63
    v_cmp_eq_u32 vcc, s54, v126
    s_nop 1
    v_cndmask_b32 v126, v126, v127, vcc
    s_nop 1
    v_max_u32_dpp v14, v126, v126 row_ror:8 row_mask:0xf bank_mask:0xf
    s_nop 1
    v_max_u32_dpp v14, v14, v14 row_ror:4 row_mask:0xf bank_mask:0xf
    s_nop 1
    v_max_u32_dpp v14, v14, v14 row_ror:2 row_mask:0xf bank_mask:0xf
    s_nop 1
    v_max_u32_dpp v14, v14, v14 row_ror:1 row_mask:0xf bank_mask:0xf
    s_nop 0
    v_readlane_b32 s55, v14, 0
    v_readlane_b32 s63, v14, 16
    s_max_u32 s55, s55, s63
    v_readlane_b32 s63, v14, 32
    s_max_u32 s55, s55, s63
    v_readlane_b32 s63, v14, 48
    s_max_u32 s55, s55, s63
    v_and_b32 v12, 1, v0
    v_cmp_eq_u32 vcc, 1, v12
    v_mov_b32 v14, s54
    v_mov_b32 v15, s55
    v_and_b32 v13, 48, v0
    v_cndmask_b32 v14, v14, v15, vcc
    v_not_b32 v14, v14
    v_and_b32 v14, 2047, v14
    v_mul_u32_u24 v14, 1280, v14
    v_add_u32 v14, v14, v13
    s_lshl_b32 s58, s57, 7
    buffer_load_dwordx4 v[192:195], v14, s[4:7], s58 offen
    buffer_load_dwordx4 v[196:199], v14, s[4:7], s58 offen offset:64
    v_mov_b32 v12, 0
    v_mov_b32 v14, s54
    ds_write_b64 v12, v[14:15] offset:512
    s_branch L_ba
L_stage_a:
    v_and_b32 v12, 1, v0
    v_and_b32 v13, 48, v0
    v_lshl_add_u32 v14, v12, 8, v13
    s_mul_i32 s58, s56, 10
    s_add_u32 s58, s58, s57
    s_lshl_b32 s58, s58, 10
    s_add_u32 s58, s58, 10551296
    s_waitcnt vmcnt(6)
    v_mfma_f32_16x16x32_bf16 v[64:67], v[128:131], v[192:195], 0
    v_mfma_f32_16x16x32_bf16 v[68:71], v[136:139], v[192:195], 0
    v_mfma_f32_16x16x32_bf16 v[72:75], v[144:147], v[192:195], 0
    v_mfma_f32_16x16x32_bf16 v[76:79], v[152:155], v[192:195], 0
    v_mfma_f32_16x16x32_bf16 v[80:83], v[160:163], v[192:195], 0
    v_mfma_f32_16x16x32_bf16 v[84:87], v[168:171], v[192:195], 0
    v_mfma_f32_16x16x32_bf16 v[88:91], v[176:179], v[192:195], 0
    v_mfma_f32_16x16x32_bf16 v[92:95], v[184:187], v[192:195], 0
    v_mfma_f32_16x16x32_bf16 v[64:67], v[132:135], v[196:199], v[64:67]
    v_mfma_f32_16x16x32_bf16 v[68:71], v[140:143], v[196:199], v[68:71]
    v_mfma_f32_16x16x32_bf16 v[72:75], v[148:151], v[196:199], v[72:75]
    v_mfma_f32_16x16x32_bf16 v[76:79], v[156:159], v[196:199], v[76:79]
    v_mfma_f32_16x16x32_bf16 v[80:83], v[164:167], v[196:199], v[80:83]
    v_mfma_f32_16x16x32_bf16 v[84:87], v[172:175], v[196:199], v[84:87]
    v_mfma_f32_16x16x32_bf16 v[88:91], v[180:183], v[196:199], v[88:91]
    v_mfma_f32_16x16x32_bf16 v[92:95], v[188:191], v[196:199], v[92:95]
    s_mov_b32 exec_lo, 0x00030003
    s_mov_b32 exec_hi, 0x00030003
    buffer_store_dwordx4 v[64:67], v14, s[12:15], s58 offen offset:0 sc1
    buffer_store_dwordx4 v[68:71], v14, s[12:15], s58 offen offset:64 sc1
    buffer_store_dwordx4 v[72:75], v14, s[12:15], s58 offen offset:128 sc1
    buffer_store_dwordx4 v[76:79], v14, s[12:15], s58 offen offset:192 sc1
    buffer_store_dwordx4 v[80:83], v14, s[12:15], s58 offen offset:512 sc1
    buffer_store_dwordx4 v[84:87], v14, s[12:15], s58 offen offset:576 sc1
    buffer_store_dwordx4 v[88:91], v14, s[12:15], s58 offen offset:640 sc1
    buffer_store_dwordx4 v[92:95], v14, s[12:15], s58 offen offset:704 sc1
    s_mov_b64 exec, -1
    s_waitcnt vmcnt(10)
    s_branch L_u4
L_att_o:
    ds_read_b128 v[24:27], v242 offset:10240
    ds_read_b128 v[28:31], v242 offset:10880
    s_nop 7
    v_exp_f32 v64, v64
    v_exp_f32 v65, v65
    v_exp_f32 v66, v66
    v_exp_f32 v67, v67
    v_exp_f32 v68, v68
    v_exp_f32 v69, v69
    v_exp_f32 v70, v70
    v_exp_f32 v71, v71
    v_cvt_pk_bf16_f32 v96, v64, v65
    v_cvt_pk_bf16_f32 v97, v66, v67
    v_cvt_pk_bf16_f32 v98, v68, v69
    v_cvt_pk_bf16_f32 v99, v70, v71
    s_cmp_eq_u32 s35, 0
    s_cbranch_scc1 L_bb_67
    s_barrier
    s_mov_b32 s35, 0
L_bb_67:
    s_cmp_eq_u32 s34, 8
    s_cbranch_scc1 L_low_wait
L_low_done:
    v_exp_f32 v72, v72
    ds_read_b128 v[16:19], v240 offset:7168
    v_exp_f32 v73, v73
    ds_read_b64 v[20:21], v241 offset:3584
    s_waitcnt lgkmcnt(2)
    v_mfma_f32_32x32x16_bf16 v[104:119], v[24:27], v[96:99], 0
    v_exp_f32 v74, v74
    v_exp_f32 v75, v75
    v_exp_f32 v76, v76
    v_exp_f32 v77, v77
    s_waitcnt lgkmcnt(0)
    v_mfma_f32_32x32x16_bf16 v[80:95], v[16:19], v[32:35], 0
    v_exp_f32 v78, v78
    v_exp_f32 v79, v79
    v_cvt_pk_bf16_f32 v100, v72, v73
    v_cvt_pk_bf16_f32 v101, v74, v75
    v_mfma_f32_32x32x8_bf16 v[80:95], v[20:21], v[22:23], v[80:95]
    v_cvt_pk_bf16_f32 v102, v76, v77
    v_cvt_pk_bf16_f32 v103, v78, v79
    s_cmp_eq_u32 s34, 7
    s_cbranch_scc1 L_rare_68
L_rare_68_b:
    ds_read_b128 v[16:19], v240 offset:6144
    ds_read_b64 v[20:21], v241 offset:3072
    v_mfma_f32_32x32x16_bf16 v[104:119], v[28:31], v[100:103], v[104:119]
    s_cmp_eq_u32 s31, 8
    s_cbranch_scc1 L_rem_o8
    s_nop 2
    v_exp_f32 v80, v80
    ds_read_b128 v[24:27], v242 offset:8960
    v_exp_f32 v81, v81
    v_exp_f32 v82, v82
    ds_read_b128 v[28:31], v242 offset:9600
    v_exp_f32 v83, v83
    s_add_u32 s60, s97, 0
    v_exp_f32 v84, v84
    s_waitcnt lgkmcnt(2)
    v_mfma_f32_32x32x16_bf16 v[64:79], v[16:19], v[32:35], 0
    v_exp_f32 v85, v85
    s_add_u32 m0, s93, 0
    v_exp_f32 v86, v86
    buffer_load_dwordx4 v243, s[12:15], s60 offen offset:0 sc1 lds
    v_exp_f32 v87, v87
    v_mfma_f32_32x32x8_bf16 v[64:79], v[20:21], v[22:23], v[64:79]
    v_cvt_pk_bf16_f32 v96, v80, v81
    v_cvt_pk_bf16_f32 v97, v82, v83
    v_cvt_pk_bf16_f32 v98, v84, v85
    v_cvt_pk_bf16_f32 v99, v86, v87
    s_cmp_eq_u32 s34, 6
    s_cbranch_scc1 L_rare_69
L_rare_69_b:
    v_exp_f32 v88, v88
    ds_read_b128 v[16:19], v240 offset:5120
    v_exp_f32 v89, v89
    ds_read_b64 v[20:21], v241 offset:2560
    s_waitcnt lgkmcnt(2)
    v_mfma_f32_32x32x16_bf16 v[104:119], v[24:27], v[96:99], v[104:119]
    v_exp_f32 v90, v90
    buffer_load_dwordx4 v243, s[12:15], s60 offen offset:1024 sc1 lds
    v_exp_f32 v91, v91
    buffer_load_dword v10, v248, s[12:15], 0 offen sc1
    v_exp_f32 v92, v92
    v_exp_f32 v93, v93
    v_exp_f32 v94, v94
    v_exp_f32 v95, v95
    v_cvt_pk_bf16_f32 v100, v88, v89
    v_cvt_pk_bf16_f32 v101, v90, v91
    v_cvt_pk_bf16_f32 v102, v92, v93
    v_cvt_pk_bf16_f32 v103, v94, v95
    s_cmp_eq_u32 s31, 7
    s_cbranch_scc1 L_rem_o7
    v_exp_f32 v64, v64
    ds_read_b128 v[24:27], v242 offset:7680
    v_exp_f32 v65, v65
    v_mfma_f32_32x32x16_bf16 v[104:119], v[28:31], v[100:103], v[104:119]
    v_exp_f32 v66, v66
    ds_read_b128 v[28:31], v242 offset:8320
    v_exp_f32 v67, v67
    buffer_load_dwordx4 v243, s[12:15], s60 offen offset:2048 sc1 lds
    v_exp_f32 v68, v68
    s_waitcnt lgkmcnt(2)
    v_mfma_f32_32x32x16_bf16 v[80:95], v[16:19], v[32:35], 0
    v_exp_f32 v69, v69
    buffer_load_dwordx4 v243, s[12:15], s60 offen offset:3072 sc1 lds
    v_exp_f32 v70, v70
    v_exp_f32 v71, v71
    v_mfma_f32_32x32x8_bf16 v[80:95], v[20:21], v[22:23], v[80:95]
    v_cvt_pk_bf16_f32 v96, v64, v65
    v_cvt_pk_bf16_f32 v97, v66, v67
    v_cvt_pk_bf16_f32 v98, v68, v69
    v_cvt_pk_bf16_f32 v99, v70, v71
    s_cmp_eq_u32 s34, 5
    s_cbranch_scc1 L_rare_70
L_rare_70_b:
    v_exp_f32 v72, v72
    ds_read_b128 v[16:19], v240 offset:4096
    v_exp_f32 v73, v73
    ds_read_b64 v[20:21], v241 offset:2048
    s_waitcnt lgkmcnt(2)
    v_mfma_f32_32x32x16_bf16 v[104:119], v[24:27], v[96:99], v[104:119]
    v_exp_f32 v74, v74
    v_exp_f32 v75, v75
    v_exp_f32 v76, v76
    v_exp_f32 v77, v77
    v_exp_f32 v78, v78
    v_exp_f32 v79, v79
    v_cvt_pk_bf16_f32 v100, v72, v73
    v_cvt_pk_bf16_f32 v101, v74, v75
    v_cvt_pk_bf16_f32 v102, v76, v77
    v_cvt_pk_bf16_f32 v103, v78, v79
    s_cmp_eq_u32 s31, 6
    s_cbranch_scc1 L_rem_o6
    s_cmp_lt_u32 s3, 16
    s_cbranch_scc1 L_rare_71
L_rare_71_b:
    v_exp_f32 v80, v80
    ds_read_b128 v[24:27], v242 offset:6400
    v_exp_f32 v81, v81
    v_mfma_f32_32x32x16_bf16 v[104:119], v[28:31], v[100:103], v[104:119]
    v_exp_f32 v82, v82
    ds_read_b128 v[28:31], v242 offset:7040
    v_exp_f32 v83, v83
    s_add_u32 s60, s97, 4096
    v_exp_f32 v84, v84
    s_waitcnt lgkmcnt(2)
    v_mfma_f32_32x32x16_bf16 v[64:79], v[16:19], v[32:35], 0
    v_exp_f32 v85, v85
    s_add_u32 m0, s93, 4096
    v_exp_f32 v86, v86
    buffer_load_dwordx4 v243, s[12:15], s60 offen offset:0 sc1 lds
    v_exp_f32 v87, v87
    v_mfma_f32_32x32x8_bf16 v[64:79], v[20:21], v[22:23], v[64:79]
    v_cvt_pk_bf16_f32 v96, v80, v81
    v_cvt_pk_bf16_f32 v97, v82, v83
    v_cvt_pk_bf16_f32 v98, v84, v85
    v_cvt_pk_bf16_f32 v99, v86, v87
    v_exp_f32 v88, v88
    ds_read_b128 v[16:19], v240 offset:3072
    v_exp_f32 v89, v89
    ds_read_b64 v[20:21], v241 offset:1536
    s_waitcnt lgkmcnt(2)
    v_mfma_f32_32x32x16_bf16 v[104:119], v[24:27], v[96:99], v[104:119]
    v_exp_f32 v90, v90
    buffer_load_dwordx4 v243, s[12:15], s60 offen offset:1024 sc1 lds
    v_exp_f32 v91, v91
    v_exp_f32 v92, v92
    v_exp_f32 v93, v93
    v_exp_f32 v94, v94
    v_exp_f32 v95, v95
    v_cvt_pk_bf16_f32 v100, v88, v89
    v_cvt_pk_bf16_f32 v101, v90, v91
    v_cvt_pk_bf16_f32 v102, v92, v93
    v_cvt_pk_bf16_f32 v103, v94, v95
    s_cmp_eq_u32 s31, 5
    s_cbranch_scc1 L_rem_o5
    v_exp_f32 v64, v64
    ds_read_b128 v[24:27], v242 offset:5120
    v_exp_f32 v65, v65
    v_mfma_f32_32x32x16_bf16 v[104:119], v[28:31], v[100:103], v[104:119]
    v_exp_f32 v66, v66
    ds_read_b128 v[28:31], v242 offset:5760
    v_exp_f32 v67, v67
    buffer_load_dwordx4 v243, s[12:15], s60 offen offset:2048 sc1 lds
    v_exp_f32 v68, v68
    s_waitcnt lgkmcnt(2)
    v_mfma_f32_32x32x16_bf16 v[80:95], v[16:19], v[32:35], 0
    v_exp_f32 v69, v69
    buffer_load_dwordx4 v243, s[12:15], s60 offen offset:3072 sc1 lds
    v_exp_f32 v70, v70
    s_add_u32 s59, s99, 0
    v_exp_f32 v71, v71
    v_mfma_f32_32x32x8_bf16 v[80:95], v[20:21], v[22:23], v[80:95]
    v_cvt_pk_bf16_f32 v96, v64, v65
    v_cvt_pk_bf16_f32 v97, v66, v67
    v_cvt_pk_bf16_f32 v98, v68, v69
    v_cvt_pk_bf16_f32 v99, v70, v71
    v_exp_f32 v72, v72
    ds_read_b128 v[16:19], v240 offset:2048
    v_exp_f32 v73, v73
    ds_read_b64 v[20:21], v241 offset:1024
    s_waitcnt lgkmcnt(2)
    v_mfma_f32_32x32x16_bf16 v[104:119], v[24:27], v[96:99], v[104:119]
    v_exp_f32 v74, v74
    buffer_load_dwordx4 v[48:51], v5, s[4:7], s59 offen
    v_exp_f32 v75, v75
    v_exp_f32 v76, v76
    v_exp_f32 v77, v77
    v_exp_f32 v78, v78
    v_exp_f32 v79, v79
    v_cvt_pk_bf16_f32 v100, v72, v73
    v_cvt_pk_bf16_f32 v101, v74, v75
    v_cvt_pk_bf16_f32 v102, v76, v77
    v_cvt_pk_bf16_f32 v103, v78, v79
    s_cmp_eq_u32 s31, 4
    s_cbranch_scc1 L_rem_o4
    v_exp_f32 v80, v80
    ds_read_b128 v[24:27], v242 offset:3840
    v_exp_f32 v81, v81
    v_mfma_f32_32x32x16_bf16 v[104:119], v[28:31], v[100:103], v[104:119]
    v_exp_f32 v82, v82
    ds_read_b128 v[28:31], v242 offset:4480
    v_exp_f32 v83, v83
    s_add_u32 s60, s97, 8192
    v_exp_f32 v84, v84
    s_waitcnt lgkmcnt(2)
    v_mfma_f32_32x32x16_bf16 v[64:79], v[16:19], v[32:35], 0
    v_exp_f32 v85, v85
    s_add_u32 m0, s93, 8192
    v_exp_f32 v86, v86
    buffer_load_dwordx4 v243, s[12:15], s60 offen offset:0 sc1 lds
    v_exp_f32 v87, v87
    v_mfma_f32_32x32x8_bf16 v[64:79], v[20:21], v[22:23], v[64:79]
    v_cvt_pk_bf16_f32 v96, v80, v81
    v_cvt_pk_bf16_f32 v97, v82, v83
    v_cvt_pk_bf16_f32 v98, v84, v85
    v_cvt_pk_bf16_f32 v99, v86, v87
    v_exp_f32 v88, v88
    ds_read_b128 v[16:19], v240 offset:1024
    v_exp_f32 v89, v89
    ds_read_b64 v[20:21], v241 offset:512
    s_waitcnt lgkmcnt(2)
    v_mfma_f32_32x32x16_bf16 v[104:119], v[24:27], v[96:99], v[104:119]
    v_exp_f32 v90, v90
    buffer_load_dwordx4 v243, s[12:15], s60 offen offset:1024 sc1 lds
    v_exp_f32 v91, v91
    s_add_u32 s59, s99, 7680
    v_exp_f32 v92, v92
    buffer_load_dwordx4 v[52:55], v5, s[4:7], s59 offen
    v_exp_f32 v93, v93
    v_exp_f32 v94, v94
    v_exp_f32 v95, v95
    v_cvt_pk_bf16_f32 v100, v88, v89
    v_cvt_pk_bf16_f32 v101, v90, v91
    v_cvt_pk_bf16_f32 v102, v92, v93
    v_cvt_pk_bf16_f32 v103, v94, v95
    s_cmp_eq_u32 s31, 3
    s_cbranch_scc1 L_rem_o3
    v_exp_f32 v64, v64
    ds_read_b128 v[24:27], v242 offset:2560
    v_exp_f32 v65, v65
    v_mfma_f32_32x32x16_bf16 v[104:119], v[28:31], v[100:103], v[104:119]
    v_exp_f32 v66, v66
    ds_read_b128 v[28:31], v242 offset:3200
    v_exp_f32 v67, v67
    buffer_load_dwordx4 v243, s[12:15], s60 offen offset:2048 sc1 lds
    v_exp_f32 v68, v68
    s_waitcnt lgkmcnt(2)
    v_mfma_f32_32x32x16_bf16 v[80:95], v[16:19], v[32:35], 0
    v_exp_f32 v69, v69
    buffer_load_dwordx4 v243, s[12:15], s60 offen offset:3072 sc1 lds
    v_exp_f32 v70, v70
    s_add_u32 s59, s99, 15360
    v_exp_f32 v71, v71
    v_mfma_f32_32x32x8_bf16 v[80:95], v[20:21], v[22:23], v[80:95]
    v_cvt_pk_bf16_f32 v96, v64, v65
    v_cvt_pk_bf16_f32 v97, v66, v67
    v_cvt_pk_bf16_f32 v98, v68, v69
    v_cvt_pk_bf16_f32 v99, v70, v71
    v_exp_f32 v72, v72
    ds_read_b128 v[16:19], v240 offset:0
    v_exp_f32 v73, v73
    ds_read_b64 v[20:21], v241 offset:0
    s_waitcnt lgkmcnt(2)
    v_mfma_f32_32x32x16_bf16 v[104:119], v[24:27], v[96:99], v[104:119]
    v_exp_f32 v74, v74
    buffer_load_dwordx4 v[56:59], v5, s[4:7], s59 offen
    v_exp_f32 v75, v75
    v_exp_f32 v76, v76
    v_exp_f32 v77, v77
    v_exp_f32 v78, v78
    v_exp_f32 v79, v79
    v_cvt_pk_bf16_f32 v100, v72, v73
    v_cvt_pk_bf16_f32 v101, v74, v75
    v_cvt_pk_bf16_f32 v102, v76, v77
    v_cvt_pk_bf16_f32 v103, v78, v79
    s_cmp_eq_u32 s31, 2
    s_cbranch_scc1 L_rem_o2
    v_exp_f32 v80, v80
    ds_read_b128 v[24:27], v242 offset:1280
    v_exp_f32 v81, v81
    v_mfma_f32_32x32x16_bf16 v[104:119], v[28:31], v[100:103], v[104:119]
    v_exp_f32 v82, v82
    ds_read_b128 v[28:31], v242 offset:1920
    v_exp_f32 v83, v83
    s_add_u32 s60, s97, 12288
    v_exp_f32 v84, v84
    s_waitcnt lgkmcnt(2)
    v_mfma_f32_32x32x16_bf16 v[64:79], v[16:19], v[32:35], v[224:239]
    v_exp_f32 v85, v85
    s_add_u32 m0, s93, 12288
    v_exp_f32 v86, v86
    buffer_load_dwordx4 v243, s[12:15], s60 offen offset:0 sc1 lds
    v_exp_f32 v87, v87
    v_mfma_f32_32x32x8_bf16 v[64:79], v[20:21], v[22:23], v[64:79]
    v_cvt_pk_bf16_f32 v96, v80, v81
    v_cvt_pk_bf16_f32 v97, v82, v83
    v_cvt_pk_bf16_f32 v98, v84, v85
    v_cvt_pk_bf16_f32 v99, v86, v87
    v_exp_f32 v88, v88
    v_exp_f32 v89, v89
    s_waitcnt lgkmcnt(0)
    v_mfma_f32_32x32x16_bf16 v[104:119], v[24:27], v[96:99], v[104:119]
    v_exp_f32 v90, v90
    v_exp_f32 v91, v91
    v_exp_f32 v92, v92
    v_exp_f32 v93, v93
    v_exp_f32 v94, v94
    v_exp_f32 v95, v95
    v_cvt_pk_bf16_f32 v100, v88, v89
    v_cvt_pk_bf16_f32 v101, v90, v91
    v_cvt_pk_bf16_f32 v102, v92, v93
    v_cvt_pk_bf16_f32 v103, v94, v95
    s_cmp_eq_u32 s31, 1
    s_cbranch_scc1 L_rem_o1
    v_exp_f32 v64, v64
    ds_read_b128 v[24:27], v242 offset:0
    v_exp_f32 v65, v65
    v_mfma_f32_32x32x16_bf16 v[104:119], v[28:31], v[100:103], v[104:119]
    v_exp_f32 v66, v66
    ds_read_b128 v[28:31], v242 offset:640
    v_exp_f32 v67, v67
    v_exp_f32 v68, v68
    v_exp_f32 v69, v69
    v_exp_f32 v70, v70
    v_exp_f32 v71, v71
    v_cvt_pk_bf16_f32 v96, v64, v65
    v_cvt_pk_bf16_f32 v97, v66, v67
    v_cvt_pk_bf16_f32 v98, v68, v69
    v_cvt_pk_bf16_f32 v99, v70, v71
    v_exp_f32 v72, v72
    v_exp_f32 v73, v73
    s_waitcnt lgkmcnt(0)
    v_mfma_f32_32x32x16_bf16 v[104:119], v[24:27], v[96:99], v[104:119]
    v_exp_f32 v74, v74
    v_exp_f32 v75, v75
    v_exp_f32 v76, v76
    v_exp_f32 v77, v77
    v_exp_f32 v78, v78
    v_exp_f32 v79, v79
    v_cvt_pk_bf16_f32 v100, v72, v73
    v_cvt_pk_bf16_f32 v101, v74, v75
    v_cvt_pk_bf16_f32 v102, v76, v77
    v_cvt_pk_bf16_f32 v103, v78, v79
    s_nop 1
    v_mfma_f32_32x32x16_bf16 v[104:119], v[28:31], v[100:103], v[104:119]
    s_branch L_att_done
L_att_b:
    ds_read_b128 v[24:27], v242 offset:10240
    ds_read_b128 v[28:31], v242 offset:10880
    s_nop 3
    v_exp_f32 v64, v64
    v_exp_f32 v65, v65
    v_exp_f32 v66, v66
    v_exp_f32 v67, v67
    v_exp_f32 v68, v68
    v_exp_f32 v69, v69
    v_exp_f32 v70, v70
    v_exp_f32 v71, v71
    v_cvt_pk_bf16_f32 v96, v64, v65
    v_cvt_pk_bf16_f32 v97, v66, v67
    v_cvt_pk_bf16_f32 v98, v68, v69
    v_cvt_pk_bf16_f32 v99, v70, v71
    s_cmp_eq_u32 s35, 0
    s_cbranch_scc1 L_bb_72
    s_barrier
    s_mov_b32 s35, 0
    s_setprio 1
L_bb_72:
    v_exp_f32 v72, v72
    ds_read_b128 v[16:19], v240 offset:7168
    v_exp_f32 v73, v73
    ds_read_b64 v[20:21], v241 offset:3584
    s_waitcnt lgkmcnt(2)
    v_mfma_f32_32x32x16_bf16 v[104:119], v[24:27], v[96:99], 0
    v_exp_f32 v74, v74
    v_exp_f32 v75, v75
    v_exp_f32 v76, v76
    v_exp_f32 v77, v77
    s_waitcnt lgkmcnt(0)
    v_mfma_f32_32x32x16_bf16 v[80:95], v[16:19], v[32:35], 0
    v_exp_f32 v78, v78
    v_exp_f32 v79, v79
    v_cvt_pk_bf16_f32 v100, v72, v73
    v_cvt_pk_bf16_f32 v101, v74, v75
    v_mfma_f32_32x32x8_bf16 v[80:95], v[20:21], v[22:23], v[80:95]
    v_cvt_pk_bf16_f32 v102, v76, v77
    v_cvt_pk_bf16_f32 v103, v78, v79
    ds_read_b128 v[16:19], v240 offset:6144
    ds_read_b64 v[20:21], v241 offset:3072
    v_mfma_f32_32x32x16_bf16 v[104:119], v[28:31], v[100:103], v[104:119]
    s_cmp_eq_u32 s31, 8
    s_cbranch_scc1 L_rem_b8
    s_nop 4
    v_exp_f32 v80, v80
    ds_read_b128 v[24:27], v242 offset:8960
    v_exp_f32 v81, v81
    v_exp_f32 v82, v82
    ds_read_b128 v[28:31], v242 offset:9600
    v_exp_f32 v83, v83
    s_add_u32 s60, s97, 0
    v_exp_f32 v84, v84
    s_waitcnt lgkmcnt(2)
    v_mfma_f32_32x32x16_bf16 v[64:79], v[16:19], v[32:35], 0
    v_exp_f32 v85, v85
    s_add_u32 m0, s93, 0
    v_exp_f32 v86, v86
    buffer_load_dwordx4 v243, s[12:15], s60 offen offset:0 sc1 lds
    v_exp_f32 v87, v87
    v_mfma_f32_32x32x8_bf16 v[64:79], v[20:21], v[22:23], v[64:79]
    v_cvt_pk_bf16_f32 v96, v80, v81
    v_cvt_pk_bf16_f32 v97, v82, v83
    v_cvt_pk_bf16_f32 v98, v84, v85
    v_cvt_pk_bf16_f32 v99, v86, v87
    v_exp_f32 v88, v88
    ds_read_b128 v[16:19], v240 offset:5120
    v_exp_f32 v89, v89
    ds_read_b64 v[20:21], v241 offset:2560
    s_waitcnt lgkmcnt(2)
    v_mfma_f32_32x32x16_bf16 v[104:119], v[24:27], v[96:99], v[104:119]
    v_exp_f32 v90, v90
    buffer_load_dwordx4 v243, s[12:15], s60 offen offset:1024 sc1 lds
    v_exp_f32 v91, v91
    buffer_load_dword v10, v248, s[12:15], 0 offen sc1
    v_exp_f32 v92, v92
    v_exp_f32 v93, v93
    v_exp_f32 v94, v94
    v_exp_f32 v95, v95
    v_cvt_pk_bf16_f32 v100, v88, v89
    v_cvt_pk_bf16_f32 v101, v90, v91
    v_cvt_pk_bf16_f32 v102, v92, v93
    v_cvt_pk_bf16_f32 v103, v94, v95
    s_cmp_eq_u32 s31, 7
    s_cbranch_scc1 L_rem_b7
    buffer_load_dwordx2 v[126:127], v245, s[12:15], s30 offen sc1
    v_exp_f32 v64, v64
    ds_read_b128 v[24:27], v242 offset:7680
    v_exp_f32 v65, v65
    v_mfma_f32_32x32x16_bf16 v[104:119], v[28:31], v[100:103], v[104:119]
    v_exp_f32 v66, v66
    ds_read_b128 v[28:31], v242 offset:8320
    v_exp_f32 v67, v67
    buffer_load_dwordx4 v243, s[12:15], s60 offen offset:2048 sc1 lds
    v_exp_f32 v68, v68
    s_waitcnt lgkmcnt(2)
    v_mfma_f32_32x32x16_bf16 v[80:95], v[16:19], v[32:35], 0
    v_exp_f32 v69, v69
    v_exp_f32 v70, v70
    v_exp_f32 v71, v71
    v_mfma_f32_32x32x8_bf16 v[80:95], v[20:21], v[22:23], v[80:95]
    v_cvt_pk_bf16_f32 v96, v64, v65
    v_cvt_pk_bf16_f32 v97, v66, v67
    v_cvt_pk_bf16_f32 v98, v68, v69
    v_cvt_pk_bf16_f32 v99, v70, v71
    v_exp_f32 v72, v72
    ds_read_b128 v[16:19], v240 offset:4096
    v_exp_f32 v73, v73
    ds_read_b64 v[20:21], v241 offset:2048
    s_waitcnt lgkmcnt(2)
    v_mfma_f32_32x32x16_bf16 v[104:119], v[24:27], v[96:99], v[104:119]
    v_exp_f32 v74, v74
    v_exp_f32 v75, v75
    v_exp_f32 v76, v76
    v_exp_f32 v77, v77
    v_exp_f32 v78, v78
    v_exp_f32 v79, v79
    v_cvt_pk_bf16_f32 v100, v72, v73
    v_cvt_pk_bf16_f32 v101, v74, v75
    v_cvt_pk_bf16_f32 v102, v76, v77
    v_cvt_pk_bf16_f32 v103, v78, v79
    s_cmp_eq_u32 s31, 6
    s_cbranch_scc1 L_rem_b6
    v_exp_f32 v80, v80
    ds_read_b128 v[24:27], v242 offset:6400
    v_exp_f32 v81, v81
    v_mfma_f32_32x32x16_bf16 v[104:119], v[28:31], v[100:103], v[104:119]
    v_exp_f32 v82, v82
    ds_read_b128 v[28:31], v242 offset:7040
    v_exp_f32 v83, v83
    v_exp_f32 v84, v84
    s_waitcnt lgkmcnt(2)
    v_mfma_f32_32x32x16_bf16 v[64:79], v[16:19], v[32:35], 0
    v_exp_f32 v85, v85
    v_exp_f32 v86, v86
    v_exp_f32 v87, v87
    v_mfma_f32_32x32x8_bf16 v[64:79], v[20:21], v[22:23], v[64:79]
    v_cvt_pk_bf16_f32 v96, v80, v81
    v_cvt_pk_bf16_f32 v97, v82, v83
    v_cvt_pk_bf16_f32 v98, v84, v85
    v_cvt_pk_bf16_f32 v99, v86, v87
    v_exp_f32 v88, v88
    ds_read_b128 v[16:19], v240 offset:3072
    v_exp_f32 v89, v89
    ds_read_b64 v[20:21], v241 offset:1536
    s_waitcnt lgkmcnt(2)
    v_mfma_f32_32x32x16_bf16 v[104:119], v[24:27], v[96:99], v[104:119]
    v_exp_f32 v90, v90
    v_exp_f32 v91, v91
    v_exp_f32 v92, v92
    v_exp_f32 v93, v93
    v_exp_f32 v94, v94
    v_exp_f32 v95, v95
    v_cvt_pk_bf16_f32 v100, v88, v89
    v_cvt_pk_bf16_f32 v101, v90, v91
    v_cvt_pk_bf16_f32 v102, v92, v93
    v_cvt_pk_bf16_f32 v103, v94, v95
    s_cmp_eq_u32 s31, 5
    s_cbranch_scc1 L_rem_b5
    s_waitcnt vmcnt(1)
    v_cmp_ne_u32 vcc, 1, v126
    s_cbranch_vccz L_fa_73
    s_mov_b32 s90, 0
L_poll_74:
    buffer_load_dwordx2 v[126:127], v245, s[12:15], s30 offen sc1
    s_add_u32 s90, s90, 1
    s_cmp_gt_u32 s90, 200000
    s_waitcnt vmcnt(0)
    s_cbranch_scc1 L_polld_75
    v_cmp_ne_u32 vcc, 1, v126
    s_cbranch_vccnz L_poll_74
L_polld_75:
L_fa_73:
    s_mul_i32 s58, s56, 10240
    s_add_u32 s58, s58, 10551296
    buffer_load_dwordx4 v[128:131], v243, s[12:15], s58 offen offset:0 sc1
    buffer_load_dwordx4 v[132:135], v243, s[12:15], s58 offen offset:1024 sc1
    buffer_load_dwordx4 v[136:139], v243, s[12:15], s58 offen offset:2048 sc1
    buffer_load_dwordx4 v[140:143], v243, s[12:15], s58 offen offset:3072 sc1
    s_add_u32 s58, s58, 4096
    buffer_load_dwordx4 v[144:147], v243, s[12:15], s58 offen offset:0 sc1
    buffer_load_dwordx4 v[148:151], v243, s[12:15], s58 offen offset:1024 sc1
    buffer_load_dwordx4 v[152:155], v243, s[12:15], s58 offen offset:2048 sc1
    buffer_load_dwordx4 v[156:159], v243, s[12:15], s58 offen offset:3072 sc1
    s_add_u32 s58, s58, 4096
    buffer_load_dwordx4 v[160:163], v243, s[12:15], s58 offen offset:0 sc1
    buffer_load_dwordx4 v[164:167], v243, s[12:15], s58 offen offset:1024 sc1
    v_exp_f32 v64, v64
    ds_read_b128 v[24:27], v242 offset:5120
    v_exp_f32 v65, v65
    v_mfma_f32_32x32x16_bf16 v[104:119], v[28:31], v[100:103], v[104:119]
    v_exp_f32 v66, v66
    ds_read_b128 v[28:31], v242 offset:5760
    v_exp_f32 v67, v67
    v_exp_f32 v68, v68
    s_waitcnt lgkmcnt(2)
    v_mfma_f32_32x32x16_bf16 v[80:95], v[16:19], v[32:35], 0
    v_exp_f32 v69, v69
    v_exp_f32 v70, v70
    v_exp_f32 v71, v71
    v_mfma_f32_32x32x8_bf16 v[80:95], v[20:21], v[22:23], v[80:95]
    v_cvt_pk_bf16_f32 v96, v64, v65
    v_cvt_pk_bf16_f32 v97, v66, v67
    v_cvt_pk_bf16_f32 v98, v68, v69
    v_cvt_pk_bf16_f32 v99, v70, v71
    s_cmp_eq_u32 s34, 3
    s_cbranch_scc1 L_rare_77
L_rare_77_b:
    v_exp_f32 v72, v72
    ds_read_b128 v[16:19], v240 offset:2048
    v_exp_f32 v73, v73
    ds_read_b64 v[20:21], v241 offset:1024
    s_waitcnt lgkmcnt(2)
    v_mfma_f32_32x32x16_bf16 v[104:119], v[24:27], v[96:99], v[104:119]
    v_exp_f32 v74, v74
    v_exp_f32 v75, v75
    v_exp_f32 v76, v76
    v_exp_f32 v77, v77
    v_exp_f32 v78, v78
    v_exp_f32 v79, v79
    v_cvt_pk_bf16_f32 v100, v72, v73
    v_cvt_pk_bf16_f32 v101, v74, v75
    v_cvt_pk_bf16_f32 v102, v76, v77
    v_cvt_pk_bf16_f32 v103, v78, v79
    s_cmp_eq_u32 s31, 4
    s_cbranch_scc1 L_rem_b4
    v_exp_f32 v80, v80
    ds_read_b128 v[24:27], v242 offset:3840
    v_exp_f32 v81, v81
    v_mfma_f32_32x32x16_bf16 v[104:119], v[28:31], v[100:103], v[104:119]
    v_exp_f32 v82, v82
    ds_read_b128 v[28:31], v242 offset:4480
    v_exp_f32 v83, v83
    v_exp_f32 v84, v84
    s_waitcnt lgkmcnt(2)
    v_mfma_f32_32x32x16_bf16 v[64:79], v[16:19], v[32:35], 0
    v_exp_f32 v85, v85
    v_exp_f32 v86, v86
    v_exp_f32 v87, v87
    v_mfma_f32_32x32x8_bf16 v[64:79], v[20:21], v[22:23], v[64:79]
    v_cvt_pk_bf16_f32 v96, v80, v81
    v_cvt_pk_bf16_f32 v97, v82, v83
    v_cvt_pk_bf16_f32 v98, v84, v85
    v_cvt_pk_bf16_f32 v99, v86, v87
    v_exp_f32 v88, v88
    ds_read_b128 v[16:19], v240 offset:1024
    v_exp_f32 v89, v89
    ds_read_b64 v[20:21], v241 offset:512
    s_waitcnt lgkmcnt(2)
    v_mfma_f32_32x32x16_bf16 v[104:119], v[24:27], v[96:99], v[104:119]
    v_exp_f32 v90, v90
    v_exp_f32 v91, v91
    v_exp_f32 v92, v92
    v_exp_f32 v93, v93
    v_exp_f32 v94, v94
    v_exp_f32 v95, v95
    v_cvt_pk_bf16_f32 v100, v88, v89
    v_cvt_pk_bf16_f32 v101, v90, v91
    v_cvt_pk_bf16_f32 v102, v92, v93
    v_cvt_pk_bf16_f32 v103, v94, v95
    s_cmp_eq_u32 s31, 3
    s_cbranch_scc1 L_rem_b3
    s_waitcnt vmcnt(0)
    s_mul_i32 s58, s56, 2560
    s_lshl_b32 s59, s57, 8
    s_add_u32 s58, s58, s59
    s_add_u32 s58, s58, 10878976
    v_pk_add_f32 v[128:129], v[128:129], v[132:133]
    v_pk_add_f32 v[130:131], v[130:131], v[134:135]
    v_pk_add_f32 v[128:129], v[128:129], v[136:137]
    v_pk_add_f32 v[130:131], v[130:131], v[138:139]
    v_pk_add_f32 v[128:129], v[128:129], v[140:141]
    v_pk_add_f32 v[130:131], v[130:131], v[142:143]
    v_pk_add_f32 v[128:129], v[128:129], v[144:145]
    v_pk_add_f32 v[130:131], v[130:131], v[146:147]
    v_pk_add_f32 v[128:129], v[128:129], v[148:149]
    v_pk_add_f32 v[130:131], v[130:131], v[150:151]
    v_pk_add_f32 v[128:129], v[128:129], v[152:153]
    v_pk_add_f32 v[130:131], v[130:131], v[154:155]
    v_pk_add_f32 v[128:129], v[128:129], v[156:157]
    v_pk_add_f32 v[130:131], v[130:131], v[158:159]
    v_pk_add_f32 v[128:129], v[128:129], v[160:161]
    v_pk_add_f32 v[130:131], v[130:131], v[162:163]
    v_pk_add_f32 v[128:129], v[128:129], v[164:165]
    v_pk_add_f32 v[130:131], v[130:131], v[166:167]
    v_cvt_pk_bf16_f32 v128, 0, v128
    v_cvt_pk_bf16_f32 v129, 0, v129
    v_cvt_pk_bf16_f32 v130, 0, v130
    v_cvt_pk_bf16_f32 v131, 0, v131
    s_nop 0
    v_permlane32_swap_b32 v128, v130
    v_permlane32_swap_b32 v129, v131
    v_mul_f32 v132, 3216550459, v128
    v_mul_f32 v133, 3216550459, v129
    v_exp_f32 v132, v132
    v_exp_f32 v133, v133
    v_add_f32 v132, 1.0, v132
    v_add_f32 v133, 1.0, v133
    v_rcp_f32 v132, v132
    v_rcp_f32 v133, v133
    v_mul_f32 v128, v128, v132
    v_mul_f32 v129, v129, v133
    v_cvt_pk_bf16_f32 v128, 0, v128
    v_cvt_pk_bf16_f32 v129, 0, v129
    v_mul_f32 v128, v128, v130
    v_mul_f32 v129, v129, v131
    v_cvt_pk_bf16_f32 v128, v128, v129
    ds_write_b32 v36, v128 offset:0
    ds_read_b128 v[132:135], v39 offset:0
    ds_read_b128 v[136:139], v39 offset:64
    s_waitcnt lgkmcnt(0)
    v_mfma_f32_16x16x32_bf16 v[140:143], v[168:171], v[132:135], 0
    v_mfma_f32_16x16x32_bf16 v[144:147], v[176:179], v[132:135], 0
    v_mfma_f32_16x16x32_bf16 v[148:151], v[184:187], v[132:135], 0
    v_mfma_f32_16x16x32_bf16 v[152:155], v[192:195], v[132:135], 0
    v_mfma_f32_16x16x32_bf16 v[140:143], v[172:175], v[136:139], v[140:143]
    v_mfma_f32_16x16x32_bf16 v[144:147], v[180:183], v[136:139], v[144:147]
    v_mfma_f32_16x16x32_bf16 v[148:151], v[188:191], v[136:139], v[148:151]
    v_mfma_f32_16x16x32_bf16 v[152:155], v[196:199], v[136:139], v[152:155]
    s_mov_b32 exec_lo, 0x00030003
    s_mov_b32 exec_hi, 0x00030003
    s_nop 2
    buffer_store_dwordx4 v[140:143], v37, s[12:15], s58 offen offset:0 sc1
    buffer_store_dwordx4 v[144:147], v37, s[12:15], s58 offen offset:64 sc1
    buffer_store_dwordx4 v[148:151], v37, s[12:15], s58 offen offset:128 sc1
    buffer_store_dwordx4 v[152:155], v37, s[12:15], s58 offen offset:192 sc1
    s_mov_b64 exec, -1
    v_exp_f32 v64, v64
    ds_read_b128 v[24:27], v242 offset:2560
    v_exp_f32 v65, v65
    v_mfma_f32_32x32x16_bf16 v[104:119], v[28:31], v[100:103], v[104:119]
    v_exp_f32 v66, v66
    ds_read_b128 v[28:31], v242 offset:3200
    v_exp_f32 v67, v67
    v_exp_f32 v68, v68
    s_waitcnt lgkmcnt(2)
    v_mfma_f32_32x32x16_bf16 v[80:95], v[16:19], v[32:35], 0
    v_exp_f32 v69, v69
    v_exp_f32 v70, v70
    v_exp_f32 v71, v71
    v_mfma_f32_32x32x8_bf16 v[80:95], v[20:21], v[22:23], v[80:95]
    v_cvt_pk_bf16_f32 v96, v64, v65
    v_cvt_pk_bf16_f32 v97, v66, v67
    v_cvt_pk_bf16_f32 v98, v68, v69
    v_cvt_pk_bf16_f32 v99, v70, v71
    v_exp_f32 v72, v72
    ds_read_b128 v[16:19], v240 offset:0
    v_exp_f32 v73, v73
    ds_read_b64 v[20:21], v241 offset:0
    s_waitcnt lgkmcnt(2)
    v_mfma_f32_32x32x16_bf16 v[104:119], v[24:27], v[96:99], v[104:119]
    v_exp_f32 v74, v74
    v_exp_f32 v75, v75
    v_exp_f32 v76, v76
    v_exp_f32 v77, v77
    v_exp_f32 v78, v78
    v_exp_f32 v79, v79
    v_cvt_pk_bf16_f32 v100, v72, v73
    v_cvt_pk_bf16_f32 v101, v74, v75
    v_cvt_pk_bf16_f32 v102, v76, v77
    v_cvt_pk_bf16_f32 v103, v78, v79
    s_cmp_eq_u32 s31, 2
    s_cbranch_scc1 L_rem_b2
    s_setprio 0
    v_exp_f32 v80, v80
    ds_read_b128 v[24:27], v242 offset:1280
    v_exp_f32 v81, v81
    v_mfma_f32_32x32x16_bf16 v[104:119], v[28:31], v[100:103], v[104:119]
    v_exp_f32 v82, v82
    ds_read_b128 v[28:31], v242 offset:1920
    v_exp_f32 v83, v83
    v_exp_f32 v84, v84
    s_waitcnt lgkmcnt(2)
    v_mfma_f32_32x32x16_bf16 v[64:79], v[16:19], v[32:35], v[224:239]
    v_exp_f32 v85, v85
    v_exp_f32 v86, v86
    v_exp_f32 v87, v87
    v_mfma_f32_32x32x8_bf16 v[64:79], v[20:21], v[22:23], v[64:79]
    v_cvt_pk_bf16_f32 v96, v80, v81
    v_cvt_pk_bf16_f32 v97, v82, v83
    v_cvt_pk_bf16_f32 v98, v84, v85
    v_cvt_pk_bf16_f32 v99, v86, v87
    v_exp_f32 v88, v88
    v_exp_f32 v89, v89
    s_waitcnt lgkmcnt(0)
    v_mfma_f32_32x32x16_bf16 v[104:119], v[24:27], v[96:99], v[104:119]
    v_exp_f32 v90, v90
    v_exp_f32 v91, v91
    v_exp_f32 v92, v92
    v_exp_f32 v93, v93
    v_exp_f32 v94, v94
    v_exp_f32 v95, v95
    v_cvt_pk_bf16_f32 v100, v88, v89
    v_cvt_pk_bf16_f32 v101, v90, v91
    v_cvt_pk_bf16_f32 v102, v92, v93
    v_cvt_pk_bf16_f32 v103, v94, v95
    s_cmp_eq_u32 s31, 1
    s_cbranch_scc1 L_rem_b1
    v_exp_f32 v64, v64
    ds_read_b128 v[24:27], v242 offset:0
    v_exp_f32 v65, v65
    v_mfma_f32_32x32x16_bf16 v[104:119], v[28:31], v[100:103], v[104:119]
    v_exp_f32 v66, v66
    ds_read_b128 v[28:31], v242 offset:640
    v_exp_f32 v67, v67
    v_exp_f32 v68, v68
    v_exp_f32 v69, v69
    v_exp_f32 v70, v70
    v_exp_f32 v71, v71
    v_cvt_pk_bf16_f32 v96, v64, v65
    v_cvt_pk_bf16_f32 v97, v66, v67
    v_cvt_pk_bf16_f32 v98, v68, v69
    v_cvt_pk_bf16_f32 v99, v70, v71
    v_exp_f32 v72, v72
    v_exp_f32 v73, v73
    s_waitcnt lgkmcnt(0)
    v_mfma_f32_32x32x16_bf16 v[104:119], v[24:27], v[96:99], v[104:119]
    v_exp_f32 v74, v74
    v_exp_f32 v75, v75
    v_exp_f32 v76, v76
    v_exp_f32 v77, v77
    v_exp_f32 v78, v78
    v_exp_f32 v79, v79
    v_cvt_pk_bf16_f32 v100, v72, v73
    v_cvt_pk_bf16_f32 v101, v74, v75
    v_cvt_pk_bf16_f32 v102, v76, v77
    v_cvt_pk_bf16_f32 v103, v78, v79
    s_nop 1
    v_mfma_f32_32x32x16_bf16 v[104:119], v[28:31], v[100:103], v[104:119]
    s_branch L_att_done
L_rem_o7:
    v_mfma_f32_32x32x16_bf16 v[104:119], v[28:31], v[100:103], v[104:119]
    s_branch L_remx_o7
L_rem_o6:
    v_mfma_f32_32x32x16_bf16 v[104:119], v[28:31], v[100:103], v[104:119]
    s_branch L_remx_o6
L_rem_o5:
    v_mfma_f32_32x32x16_bf16 v[104:119], v[28:31], v[100:103], v[104:119]
    s_branch L_remx_o5
L_rem_o4:
    v_mfma_f32_32x32x16_bf16 v[104:119], v[28:31], v[100:103], v[104:119]
    s_branch L_remx_o4
L_rem_o3:
    v_mfma_f32_32x32x16_bf16 v[104:119], v[28:31], v[100:103], v[104:119]
    s_branch L_remx_o3
L_rem_o2:
    v_mfma_f32_32x32x16_bf16 v[104:119], v[28:31], v[100:103], v[104:119]
    s_branch L_remx_o2
L_rem_o1:
    v_mfma_f32_32x32x16_bf16 v[104:119], v[28:31], v[100:103], v[104:119]
    s_branch L_remx_o1
L_rem_o8:
L_remx_o8:
    s_add_u32 s60, s97, 0
    s_add_u32 m0, s93, 0
    s_nop 0
    buffer_load_dwordx4 v243, s[12:15], s60 offen offset:0 sc1 lds
    buffer_load_dwordx4 v243, s[12:15], s60 offen offset:1024 sc1 lds
    buffer_load_dword v10, v248, s[12:15], 0 offen sc1
L_remx_o7:
    s_add_u32 s60, s97, 0
    s_add_u32 m0, s93, 0
    s_nop 0
    buffer_load_dwordx4 v243, s[12:15], s60 offen offset:2048 sc1 lds
    buffer_load_dwordx4 v243, s[12:15], s60 offen offset:3072 sc1 lds
L_remx_o6:
    s_cmp_lt_u32 s3, 16
    s_cbranch_scc1 L_rare_78
L_rare_78_b:
    s_add_u32 s60, s97, 4096
    s_add_u32 m0, s93, 4096
    s_nop 0
    buffer_load_dwordx4 v243, s[12:15], s60 offen offset:0 sc1 lds
    buffer_load_dwordx4 v243, s[12:15], s60 offen offset:1024 sc1 lds
L_remx_o5:
    s_add_u32 s60, s97, 4096
    s_add_u32 m0, s93, 4096
    s_nop 0
    buffer_load_dwordx4 v243, s[12:15], s60 offen offset:2048 sc1 lds
    buffer_load_dwordx4 v243, s[12:15], s60 offen offset:3072 sc1 lds
    s_add_u32 s59, s99, 0
    buffer_load_dwordx4 v[48:51], v5, s[4:7], s59 offen
L_remx_o4:
    s_add_u32 s60, s97, 8192
    s_add_u32 m0, s93, 8192
    s_nop 0
    buffer_load_dwordx4 v243, s[12:15], s60 offen offset:0 sc1 lds
    buffer_load_dwordx4 v243, s[12:15], s60 offen offset:1024 sc1 lds
    s_add_u32 s59, s99, 7680
    buffer_load_dwordx4 v[52:55], v5, s[4:7], s59 offen
L_remx_o3:
    s_add_u32 s60, s97, 8192
    s_add_u32 m0, s93, 8192
    s_nop 0
    buffer_load_dwordx4 v243, s[12:15], s60 offen offset:2048 sc1 lds
    buffer_load_dwordx4 v243, s[12:15], s60 offen offset:3072 sc1 lds
    s_add_u32 s59, s99, 15360
    buffer_load_dwordx4 v[56:59], v5, s[4:7], s59 offen
L_remx_o2:
    s_add_u32 s60, s97, 12288
    s_add_u32 m0, s93, 12288
    s_nop 0
    buffer_load_dwordx4 v243, s[12:15], s60 offen offset:0 sc1 lds
L_remx_o1:
    s_waitcnt lgkmcnt(0)
    s_branch L_att_done
L_rem_y7:
    v_mfma_f32_32x32x16_bf16 v[104:119], v[28:31], v[100:103], v[104:119]
    s_branch L_remx_y7
L_rem_y6:
    v_mfma_f32_32x32x16_bf16 v[104:119], v[28:31], v[100:103], v[104:119]
    s_branch L_remx_y6
L_rem_y5:
    v_mfma_f32_32x32x16_bf16 v[104:119], v[28:31], v[100:103], v[104:119]
    s_branch L_remx_y5
L_rem_y4:
    v_mfma_f32_32x32x16_bf16 v[104:119], v[28:31], v[100:103], v[104:119]
    s_branch L_remx_y4
L_rem_y3:
    v_mfma_f32_32x32x16_bf16 v[104:119], v[28:31], v[100:103], v[104:119]
    s_branch L_remx_y3
L_rem_y2:
    v_mfma_f32_32x32x16_bf16 v[104:119], v[28:31], v[100:103], v[104:119]
    s_branch L_remx_y2
L_rem_y1:
    v_mfma_f32_32x32x16_bf16 v[104:119], v[28:31], v[100:103], v[104:119]
    s_branch L_remx_y1
L_rem_y8:
L_remx_y8:
    s_cmp_eq_u32 s53, 4
    s_cbranch_scc1 L_rare_79
L_rare_79_b:
    s_add_u32 s60, s97, 0
    s_add_u32 m0, s93, 0
    s_nop 0
    buffer_load_dwordx4 v243, s[12:15], s60 offen offset:0 sc1 lds
    buffer_load_dwordx4 v243, s[12:15], s60 offen offset:1024 sc1 lds
    buffer_load_dwordx4 v243, s[12:15], s60 offen offset:2048 sc1 lds
    buffer_load_dword v10, v248, s[12:15], 0 offen sc1
L_remx_y7:
    s_add_u32 s60, s97, 0
    s_add_u32 m0, s93, 0
    s_nop 0
    buffer_load_dwordx4 v243, s[12:15], s60 offen offset:3072 sc1 lds
    s_add_u32 s60, s97, 4096
    s_add_u32 m0, s93, 4096
    s_nop 0
    buffer_load_dwordx4 v243, s[12:15], s60 offen offset:0 sc1 lds
L_remx_y6:
    s_add_u32 s60, s97, 4096
    s_add_u32 m0, s93, 4096
    s_nop 0
    buffer_load_dwordx4 v243, s[12:15], s60 offen offset:1024 sc1 lds
    buffer_load_dwordx4 v243, s[12:15], s60 offen offset:2048 sc1 lds
L_remx_y5:
    s_add_u32 s60, s97, 4096
    s_add_u32 m0, s93, 4096
    s_nop 0
    buffer_load_dwordx4 v243, s[12:15], s60 offen offset:3072 sc1 lds
    s_add_u32 s60, s97, 8192
    s_add_u32 m0, s93, 8192
    s_nop 0
    buffer_load_dwordx4 v243, s[12:15], s60 offen offset:0 sc1 lds
L_remx_y4:
    s_add_u32 s60, s97, 8192
    s_add_u32 m0, s93, 8192
    s_nop 0
    buffer_load_dwordx4 v243, s[12:15], s60 offen offset:1024 sc1 lds
    buffer_load_dwordx4 v243, s[12:15], s60 offen offset:2048 sc1 lds
L_remx_y3:
    s_add_u32 s60, s97, 8192
    s_add_u32 m0, s93, 8192
    s_nop 0
    buffer_load_dwordx4 v243, s[12:15], s60 offen offset:3072 sc1 lds
    s_add_u32 s60, s97, 12288
    s_add_u32 m0, s93, 12288
    s_nop 0
    buffer_load_dwordx4 v243, s[12:15], s60 offen offset:0 sc1 lds
L_remx_y2:
    s_add_u32 s60, s97, 12288
    s_add_u32 m0, s93, 12288
    s_nop 0
    buffer_load_dwordx4 v243, s[12:15], s60 offen offset:1024 sc1 lds
    buffer_load_dwordx4 v243, s[12:15], s60 offen offset:2048 sc1 lds
L_remx_y1:
    s_waitcnt lgkmcnt(0)
    s_branch L_att_done
L_rem_b7:
    v_mfma_f32_32x32x16_bf16 v[104:119], v[28:31], v[100:103], v[104:119]
    s_branch L_remx_b7
L_rem_b6:
    v_mfma_f32_32x32x16_bf16 v[104:119], v[28:31], v[100:103], v[104:119]
    s_branch L_remx_b6
L_rem_b5:
    v_mfma_f32_32x32x16_bf16 v[104:119], v[28:31], v[100:103], v[104:119]
    s_branch L_remx_b5
L_rem_b4:
    v_mfma_f32_32x32x16_bf16 v[104:119], v[28:31], v[100:103], v[104:119]
    s_branch L_remx_b4
L_rem_b3:
    v_mfma_f32_32x32x16_bf16 v[104:119], v[28:31], v[100:103], v[104:119]
    s_branch L_remx_b3
L_rem_b2:
    v_mfma_f32_32x32x16_bf16 v[104:119], v[28:31], v[100:103], v[104:119]
    s_branch L_remx_b2
L_rem_b1:
    v_mfma_f32_32x32x16_bf16 v[104:119], v[28:31], v[100:103], v[104:119]
    s_branch L_remx_b1
L_rem_b8:
L_remx_b8:
    s_add_u32 s60, s97, 0
    s_add_u32 m0, s93, 0
    s_nop 0
    buffer_load_dwordx4 v243, s[12:15], s60 offen offset:0 sc1 lds
    buffer_load_dwordx4 v243, s[12:15], s60 offen offset:1024 sc1 lds
    buffer_load_dword v10, v248, s[12:15], 0 offen sc1
L_remx_b7:
    buffer_load_dwordx2 v[126:127], v245, s[12:15], s30 offen sc1
    s_add_u32 s60, s97, 0
    s_add_u32 m0, s93, 0
    s_nop 0
    buffer_load_dwordx4 v243, s[12:15], s60 offen offset:2048 sc1 lds
L_remx_b6:
L_remx_b5:
    s_waitcnt vmcnt(1)
    v_cmp_ne_u32 vcc, 1, v126
    s_cbranch_vccz L_fa_80
    s_mov_b32 s90, 0
L_poll_81:
    buffer_load_dwordx2 v[126:127], v245, s[12:15], s30 offen sc1
    s_add_u32 s90, s90, 1
    s_cmp_gt_u32 s90, 200000
    s_waitcnt vmcnt(0)
    s_cbranch_scc1 L_polld_82
    v_cmp_ne_u32 vcc, 1, v126
    s_cbranch_vccnz L_poll_81
L_polld_82:
L_fa_80:
    s_mul_i32 s58, s56, 10240
    s_add_u32 s58, s58, 10551296
    buffer_load_dwordx4 v[128:131], v243, s[12:15], s58 offen offset:0 sc1
    buffer_load_dwordx4 v[132:135], v243, s[12:15], s58 offen offset:1024 sc1
    buffer_load_dwordx4 v[136:139], v243, s[12:15], s58 offen offset:2048 sc1
    buffer_load_dwordx4 v[140:143], v243, s[12:15], s58 offen offset:3072 sc1
    s_add_u32 s58, s58, 4096
    buffer_load_dwordx4 v[144:147], v243, s[12:15], s58 offen offset:0 sc1
    buffer_load_dwordx4 v[148:151], v243, s[12:15], s58 offen offset:1024 sc1
    buffer_load_dwordx4 v[152:155], v243, s[12:15], s58 offen offset:2048 sc1
    buffer_load_dwordx4 v[156:159], v243, s[12:15], s58 offen offset:3072 sc1
    s_add_u32 s58, s58, 4096
    buffer_load_dwordx4 v[160:163], v243, s[12:15], s58 offen offset:0 sc1
    buffer_load_dwordx4 v[164:167], v243, s[12:15], s58 offen offset:1024 sc1
L_remx_b4:
L_remx_b3:
    s_waitcnt vmcnt(0)
    s_mul_i32 s58, s56, 2560
    s_lshl_b32 s59, s57, 8
    s_add_u32 s58, s58, s59
    s_add_u32 s58, s58, 10878976
    v_pk_add_f32 v[128:129], v[128:129], v[132:133]
    v_pk_add_f32 v[130:131], v[130:131], v[134:135]
    v_pk_add_f32 v[128:129], v[128:129], v[136:137]
    v_pk_add_f32 v[130:131], v[130:131], v[138:139]
    v_pk_add_f32 v[128:129], v[128:129], v[140:141]
    v_pk_add_f32 v[130:131], v[130:131], v[142:143]
    v_pk_add_f32 v[128:129], v[128:129], v[144:145]
    v_pk_add_f32 v[130:131], v[130:131], v[146:147]
    v_pk_add_f32 v[128:129], v[128:129], v[148:149]
    v_pk_add_f32 v[130:131], v[130:131], v[150:151]
    v_pk_add_f32 v[128:129], v[128:129], v[152:153]
    v_pk_add_f32 v[130:131], v[130:131], v[154:155]
    v_pk_add_f32 v[128:129], v[128:129], v[156:157]
    v_pk_add_f32 v[130:131], v[130:131], v[158:159]
    v_pk_add_f32 v[128:129], v[128:129], v[160:161]
    v_pk_add_f32 v[130:131], v[130:131], v[162:163]
    v_pk_add_f32 v[128:129], v[128:129], v[164:165]
    v_pk_add_f32 v[130:131], v[130:131], v[166:167]
    v_cvt_pk_bf16_f32 v128, 0, v128
    v_cvt_pk_bf16_f32 v129, 0, v129
    v_cvt_pk_bf16_f32 v130, 0, v130
    v_cvt_pk_bf16_f32 v131, 0, v131
    s_nop 0
    v_permlane32_swap_b32 v128, v130
    v_permlane32_swap_b32 v129, v131
    v_mul_f32 v132, 3216550459, v128
    v_mul_f32 v133, 3216550459, v129
    v_exp_f32 v132, v132
    v_exp_f32 v133, v133
    v_add_f32 v132, 1.0, v132
    v_add_f32 v133, 1.0, v133
    v_rcp_f32 v132, v132
    v_rcp_f32 v133, v133
    v_mul_f32 v128, v128, v132
    v_mul_f32 v129, v129, v133
    v_cvt_pk_bf16_f32 v128, 0, v128
    v_cvt_pk_bf16_f32 v129, 0, v129
    v_mul_f32 v128, v128, v130
    v_mul_f32 v129, v129, v131
    v_cvt_pk_bf16_f32 v128, v128, v129
    ds_write_b32 v36, v128 offset:0
    ds_read_b128 v[132:135], v39 offset:0
    ds_read_b128 v[136:139], v39 offset:64
    s_waitcnt lgkmcnt(0)
    v_mfma_f32_16x16x32_bf16 v[140:143], v[168:171], v[132:135], 0
    v_mfma_f32_16x16x32_bf16 v[144:147], v[176:179], v[132:135], 0
    v_mfma_f32_16x16x32_bf16 v[148:151], v[184:187], v[132:135], 0
    v_mfma_f32_16x16x32_bf16 v[152:155], v[192:195], v[132:135], 0
    v_mfma_f32_16x16x32_bf16 v[140:143], v[172:175], v[136:139], v[140:143]
    v_mfma_f32_16x16x32_bf16 v[144:147], v[180:183], v[136:139], v[144:147]
    v_mfma_f32_16x16x32_bf16 v[148:151], v[188:191], v[136:139], v[148:151]
    v_mfma_f32_16x16x32_bf16 v[152:155], v[196:199], v[136:139], v[152:155]
    s_mov_b32 exec_lo, 0x00030003
    s_mov_b32 exec_hi, 0x00030003
    s_nop 2
    buffer_store_dwordx4 v[140:143], v37, s[12:15], s58 offen offset:0 sc1
    buffer_store_dwordx4 v[144:147], v37, s[12:15], s58 offen offset:64 sc1
    buffer_store_dwordx4 v[148:151], v37, s[12:15], s58 offen offset:128 sc1
    buffer_store_dwordx4 v[152:155], v37, s[12:15], s58 offen offset:192 sc1
    s_mov_b64 exec, -1
L_remx_b2:
L_remx_b1:
    s_waitcnt lgkmcnt(0)
    s_branch L_att_done
L_rare_9:
    buffer_load_dword v48, v49, s[12:15], s100 offen sc1
    s_waitcnt vmcnt(0)
    v_cmp_ne_u32 vcc, s60, v48
    s_branch L_rare_9_b
L_rare_20:
    buffer_load_dword v48, v49, s[12:15], s100 offen sc1
    s_waitcnt vmcnt(0)
    v_cmp_ne_u32 vcc, s60, v48
    s_branch L_rare_20_b
L_rare_32:
    buffer_load_dword v48, v49, s[12:15], s100 offen sc1
    s_waitcnt vmcnt(0)
    v_cmp_ne_u32 vcc, s60, v48
    s_branch L_rare_32_b
L_rare_37:
    v_mov_b32 v15, s50
    ds_write_b64 v14, v[14:15] offset:520
    ds_write_b32 v14, v14 offset:528
    s_branch L_rare_37_b
L_rare_43:
    ds_read_b64_tr_b16 v[168:169], v124 offset:16384
    ds_read_b64_tr_b16 v[170:171], v124 offset:16896
    ds_read_b64_tr_b16 v[172:173], v124 offset:20480
    ds_read_b64_tr_b16 v[174:175], v124 offset:20992
    ds_read_b64_tr_b16 v[176:177], v124 offset:16416
    ds_read_b64_tr_b16 v[178:179], v124 offset:16928
    ds_read_b64_tr_b16 v[180:181], v124 offset:20512
    ds_read_b64_tr_b16 v[182:183], v124 offset:21024
    s_waitcnt lgkmcnt(4)
    ds_read_b64_tr_b16 v[184:185], v124 offset:16448
    ds_read_b64_tr_b16 v[186:187], v124 offset:16960
    ds_read_b64_tr_b16 v[188:189], v124 offset:20544
    ds_read_b64_tr_b16 v[190:191], v124 offset:21056
    ds_read_b64_tr_b16 v[192:193], v124 offset:16480
    ds_read_b64_tr_b16 v[194:195], v124 offset:16992
    ds_read_b64_tr_b16 v[196:197], v124 offset:20576
    ds_read_b64_tr_b16 v[198:199], v124 offset:21088
    s_waitcnt lgkmcnt(4)
    s_waitcnt lgkmcnt(0)
    v_and_b32 v36, 31, v0
    v_lshlrev_b32 v36, 3, v36
    v_lshrrev_b32 v37, 5, v0
    v_lshl_add_u32 v36, v37, 2, v36
    v_and_b32 v37, 1, v0
    v_lshlrev_b32 v37, 7, v37
    v_and_b32 v38, 48, v0
    v_add_u32 v39, v37, v38
    v_mul_u32_u24 v37, 480, v37
    v_add_u32 v37, v37, v38
    s_sub_u32 s59, s42, s57
    s_lshl_b32 s59, s59, 3
    s_add_u32 s59, s59, s41
    s_lshl_b32 s59, s59, 7
    s_add_u32 s30, s59, 11042816
    v_min_u32 v245, 9, v0
    v_lshlrev_b32 v245, 10, v245
    s_branch L_rare_43_b
L_rare_44:
    s_waitcnt vmcnt(0)
    s_mov_b32 exec_hi, 0
    v_cmp_eq_u32 vcc, 0, v126
    s_mov_b64 exec, -1
    s_cbranch_vccz L_w_84
    s_mov_b32 s90, 0
L_poll_85:
    buffer_load_dwordx2 v[126:127], v245, s[12:15], s30 offen sc1
    s_add_u32 s90, s90, 1
    s_cmp_gt_u32 s90, 200000
    s_waitcnt vmcnt(0)
    s_cbranch_scc1 L_polld_86
    v_cmp_eq_u32 vcc, 0, v126
    s_cbranch_vccnz L_poll_85
L_polld_86:
L_w_84:
    s_branch L_rare_44_b
L_rare_46:
    v_max_u32 v245, 0x2000, v245
    buffer_load_dwordx2 v[126:127], v245, s[12:15], s30 offen sc1
    s_branch L_rare_46_b
L_rare_47:
    s_lshr_b32 s60, s91, 2
    s_mul_i32 s61, s60, 491520
    v_subrev_u32 v244, s61, v244
    v_lshrrev_b32 v249, 1, v244
    s_lshl_b32 s61, s51, 1
    s_add_u32 s60, s60, s61
    s_lshl_b32 s60, s60, 5
    s_add_u32 s60, s60, s52
    s_lshl_b32 s86, s60, 12
    s_add_u32 s86, s86, 7864320
    s_lshl_b32 s87, s60, 10
    s_add_u32 s87, s87, 9961472
    s_branch L_rare_47_b
L_rare_48:
    s_mul_i32 s99, s46, 160
    s_lshr_b32 s62, s40, 2
    s_xor_b32 s62, s62, s43
    s_and_b32 s63, s40, 3
    v_lshrrev_b32 v11, 4, v0
    v_lshrrev_b32 v1, 5, v0
    v_bfe_u32 v13, v0, 2, 2
    v_and_b32 v14, 1, v11
    v_lshl_add_u32 v12, v14, 2, v13
    v_mad_u32_u24 v12, v1, 20, v12
    v_mul_u32_u24 v12, 160, v12
    v_and_b32 v15, 3, v0
    v_lshlrev_b32 v15, 3, v15
    s_mul_i32 s59, s62, 51200
    s_add_u32 s59, s59, 16384
    v_add3_u32 v7, v12, v15, s59
    v_mad_u32_u24 v12, v11, 40, v13
    v_mul_u32_u24 v12, 160, v12
    v_add3_u32 v12, v12, v15, s59
    v_mul_u32_u24 v15, 3200, v14
    v_add_u32 v8, v12, v15
    v_sub_u32 v9, v12, v15
    v_add_u32 v9, 3200, v9
    s_mul_i32 s60, s63, 5440
    s_add_u32 s60, s60, 118784
    v_and_b32 v15, 48, v0
    v_add3_u32 v6, s60, v243, v15
    v_mul_u32_u24 v12, 26, v0
    v_lshrrev_b32 v12, 8, v12
    v_mul_u32_u24 v12, 1120, v12
    v_and_b32 v13, -16, v246
    v_mul_u32_u24 v13, 1280, v13
    v_add3_u32 v5, v12, v13, v243
    v_and_b32 v13, 127, v246
    s_lshl_b32 s60, s44, 1
    s_add_u32 s60, s60, s43
    s_lshl_b32 s60, s60, 1
    s_lshr_b32 s61, s45, 1
    s_add_u32 s60, s60, s61
    v_add_u32 v12, v11, v1
    v_lshlrev_b32 v13, 4, v13
    v_lshl_add_u32 v2, v12, 11, v13
    v_mul_u32_u24 v12, 10240, v11
    v_add_u32 v3, v12, v13
    s_mul_i32 s88, s60, 491520
    s_mul_i32 s60, s62, 81920
    s_add_u32 s88, s88, s60
    s_add_u32 s89, s88, 4096
    v_mov_b32 v4, 0
    s_lshl_b32 s59, s63, 3
    s_lshr_b32 s59, 656018688, s59
    s_and_b32 s59, s59, 255
    s_lshl_b32 s59, s59, 10
    s_add_u32 s93, s59, 16384
    s_mul_i32 s97, s46, 102400
    s_add_u32 s97, s97, s59
    s_add_u32 s97, s97, 11796480
    s_branch L_rare_48_b
L_rare_50:
    s_lshl_b32 s58, s2, 7
    s_add_u32 s58, s58, 11042816
    v_mov_b32 v14, 0
    v_mov_b32 v15, 1
    s_mov_b64 exec, 1
    s_waitcnt vmcnt(0)
    s_cmp_eq_u32 s50, 0
    s_cbranch_scc1 L_wt_88
    buffer_store_dword v15, v14, s[12:15], s58 offen
    s_branch L_wtd_89
L_wt_88:
    buffer_store_dword v15, v14, s[12:15], s58 offen sc1
L_wtd_89:
    s_mov_b64 exec, -1
    s_branch L_rare_50_b
L_rare_51:
    v_mov_b32 v14, 0
    s_mov_b32 s90, 0
L_lp_90:
    ds_read_b32 v12, v14 offset:520
    s_add_u32 s90, s90, 1
    s_cmp_gt_u32 s90, 1000000
    s_waitcnt lgkmcnt(0)
    s_cbranch_scc1 L_lpd_91
    v_cmp_gt_u32 vcc, 1, v12
    s_cbranch_vccnz L_lp_90
L_lpd_91:
    s_branch L_rare_51_b
L_rare_52:
    v_mov_b32 v14, 0
    s_mov_b32 s90, 0
L_lp_92:
    ds_read_b32 v12, v14 offset:520
    s_add_u32 s90, s90, 1
    s_cmp_gt_u32 s90, 1000000
    s_waitcnt lgkmcnt(0)
    s_cbranch_scc1 L_lpd_93
    v_cmp_gt_u32 vcc, 1, v12
    s_cbranch_vccnz L_lp_92
L_lpd_93:
    s_branch L_rare_52_b
L_rare_53:
    v_mov_b32 v14, 0
    s_mov_b32 s90, 0
L_lp_94:
    ds_read_b32 v12, v14 offset:520
    s_add_u32 s90, s90, 1
    s_cmp_gt_u32 s90, 1000000
    s_waitcnt lgkmcnt(0)
    s_cbranch_scc1 L_lpd_95
    v_cmp_gt_u32 vcc, 1, v12
    s_cbranch_vccnz L_lp_94
L_lpd_95:
    s_branch L_rare_53_b
L_rare_54:
    v_mov_b32 v14, 0
    s_mov_b32 s90, 0
L_lp_96:
    ds_read_b32 v12, v14 offset:520
    s_add_u32 s90, s90, 1
    s_cmp_gt_u32 s90, 1000000
    s_waitcnt lgkmcnt(0)
    s_cbranch_scc1 L_lpd_97
    v_cmp_gt_u32 vcc, 1, v12
    s_cbranch_vccnz L_lp_96
L_lpd_97:
    s_branch L_rare_54_b
L_rare_68:
    v_mov_b32 v14, 0
    s_mov_b32 s90, 0
L_lp_98:
    ds_read_b32 v12, v14 offset:520
    s_add_u32 s90, s90, 1
    s_cmp_gt_u32 s90, 1000000
    s_waitcnt lgkmcnt(0)
    s_cbranch_scc1 L_lpd_99
    v_cmp_gt_u32 vcc, 1, v12
    s_cbranch_vccnz L_lp_98
L_lpd_99:
    s_branch L_rare_68_b
L_rare_69:
    v_mov_b32 v14, 0
    s_mov_b32 s90, 0
L_lp_100:
    ds_read_b32 v12, v14 offset:520
    s_add_u32 s90, s90, 1
    s_cmp_gt_u32 s90, 1000000
    s_waitcnt lgkmcnt(0)
    s_cbranch_scc1 L_lpd_101
    v_cmp_gt_u32 vcc, 1, v12
    s_cbranch_vccnz L_lp_100
L_lpd_101:
    s_branch L_rare_69_b
L_rare_70:
    v_mov_b32 v14, 0
    s_mov_b32 s90, 0
L_lp_102:
    ds_read_b32 v12, v14 offset:520
    s_add_u32 s90, s90, 1
    s_cmp_gt_u32 s90, 1000000
    s_waitcnt lgkmcnt(0)
    s_cbranch_scc1 L_lpd_103
    v_cmp_gt_u32 vcc, 1, v12
    s_cbranch_vccnz L_lp_102
L_lpd_103:
    s_branch L_rare_70_b
L_rare_71:
    s_lshr_b32 s59, s99, 7
    v_and_b32 v12, 31, v0
    v_min_u32 v12, 23, v12
    v_mul_u32_u24 v13, 86, v12
    v_lshrrev_b32 v13, 8, v13
    v_mul_u32_u24 v14, 3, v13
    v_sub_u32 v14, v12, v14
    v_mul_u32_u24 v14, 10, v14
    v_lshrrev_b32 v15, 5, v0
    v_add3_u32 v14, v14, v15, s59
    v_lshl_add_u32 v14, v14, 3, v13
    v_lshlrev_b32 v245, 7, v14
    s_mov_b32 s30, 11206656
    buffer_load_dwordx2 v[126:127], v245, s[12:15], s30 offen sc1
    s_branch L_rare_71_b
L_rare_77:
    v_mov_b32 v14, 0
    s_mov_b32 s90, 0
L_lp_104:
    ds_read_b32 v12, v14 offset:520
    s_add_u32 s90, s90, 1
    s_cmp_gt_u32 s90, 1000000
    s_waitcnt lgkmcnt(0)
    s_cbranch_scc1 L_lpd_105
    v_cmp_gt_u32 vcc, 1, v12
    s_cbranch_vccnz L_lp_104
L_lpd_105:
    s_branch L_rare_77_b
L_rare_78:
    s_lshr_b32 s59, s99, 7
    v_and_b32 v12, 31, v0
    v_min_u32 v12, 23, v12
    v_mul_u32_u24 v13, 86, v12
    v_lshrrev_b32 v13, 8, v13
    v_mul_u32_u24 v14, 3, v13
    v_sub_u32 v14, v12, v14
    v_mul_u32_u24 v14, 10, v14
    v_lshrrev_b32 v15, 5, v0
    v_add3_u32 v14, v14, v15, s59
    v_lshl_add_u32 v14, v14, 3, v13
    v_lshlrev_b32 v245, 7, v14
    s_mov_b32 s30, 11206656
    buffer_load_dwordx2 v[126:127], v245, s[12:15], s30 offen sc1
    s_branch L_rare_78_b
L_rare_79:
    s_lshl_b32 s58, s2, 7
    s_add_u32 s58, s58, 11042816
    v_mov_b32 v14, 0
    v_mov_b32 v15, 1
    s_mov_b64 exec, 1
    s_waitcnt vmcnt(0)
    s_cmp_eq_u32 s50, 0
    s_cbranch_scc1 L_wt_106
    buffer_store_dword v15, v14, s[12:15], s58 offen
    s_branch L_wtd_107
L_wt_106:
    buffer_store_dword v15, v14, s[12:15], s58 offen sc1
L_wtd_107:
    s_mov_b64 exec, -1
    s_branch L_rare_79_b
L_o_l7:
    s_mov_b64 exec, 0xffff
    s_waitcnt vmcnt(0)
    s_barrier
    s_mov_b32 s90, 0
L_poll_108:
    buffer_load_dword v35, v11, s[12:15], s96 offen sc1
    s_add_u32 s90, s90, 1
    s_cmp_gt_u32 s90, 200000
    s_waitcnt vmcnt(0)
    s_cbranch_scc1 L_polld_109
    v_cmp_ne_u32 vcc, 1, v35
    s_cbranch_vccnz L_poll_108
L_polld_109:
    s_xor_b32 s96, s96, 512
    buffer_load_dword v35, v11, s[12:15], s96 offen sc1
    s_mov_b64 exec, -1
    s_barrier
    ds_read_b64_tr_b16 v[96:97], v7 offset:0
    ds_read_b64_tr_b16 v[98:99], v7 offset:1280
    ds_read_b64_tr_b16 v[100:101], v7 offset:32
    ds_read_b64_tr_b16 v[102:103], v7 offset:1312
    ds_read_b64_tr_b16 v[104:105], v7 offset:64
    ds_read_b64_tr_b16 v[106:107], v7 offset:1344
    ds_read_b64_tr_b16 v[108:109], v7 offset:96
    ds_read_b64_tr_b16 v[110:111], v7 offset:1376
    ds_read_b64_tr_b16 v[112:113], v7 offset:128
    ds_read_b64_tr_b16 v[114:115], v7 offset:1408
    ds_read_b64_tr_b16 v[116:117], v7 offset:6400
    ds_read_b64_tr_b16 v[118:119], v7 offset:7680
    ds_read_b64_tr_b16 v[120:121], v7 offset:6432
    ds_read_b64_tr_b16 v[122:123], v7 offset:7712
    ds_read_b64_tr_b16 v[124:125], v7 offset:6464
    ds_read_b64_tr_b16 v[126:127], v7 offset:7744
    ds_read_b64_tr_b16 v[128:129], v7 offset:6496
    ds_read_b64_tr_b16 v[130:131], v7 offset:7776
    ds_read_b64_tr_b16 v[132:133], v7 offset:6528
    ds_read_b64_tr_b16 v[134:135], v7 offset:7808
    ds_read_b64_tr_b16 v[136:137], v7 offset:12800
    ds_read_b64_tr_b16 v[138:139], v7 offset:14080
    ds_read_b64_tr_b16 v[140:141], v7 offset:12832
    ds_read_b64_tr_b16 v[142:143], v7 offset:14112
    ds_read_b64_tr_b16 v[144:145], v7 offset:12864
    ds_read_b64_tr_b16 v[146:147], v7 offset:14144
    ds_read_b64_tr_b16 v[148:149], v7 offset:12896
    ds_read_b64_tr_b16 v[150:151], v7 offset:14176
    ds_read_b64_tr_b16 v[152:153], v7 offset:12928
    ds_read_b64_tr_b16 v[154:155], v7 offset:14208
    s_mov_b64 exec, 0xffff
    s_mov_b32 s90, 0
    s_branch L_polle_113
L_poll_111:
    buffer_load_dword v35, v11, s[12:15], s96 offen sc1
L_polle_113:
    s_add_u32 s90, s90, 1
    s_cmp_gt_u32 s90, 200000
    s_waitcnt vmcnt(0)
    s_cbranch_scc1 L_polld_112
    v_cmp_ne_u32 vcc, 1, v35
    s_cbranch_vccnz L_poll_111
L_polld_112:
    s_mov_b64 exec, -1
    ds_write_b32 v22, v23 offset:528
    buffer_load_dwordx4 v[36:39], v2, s[12:15], s88 offen sc1
    s_add_u32 s88, s88, 8192
    buffer_load_dwordx4 v[40:43], v2, s[12:15], s88 offen sc1
    s_add_u32 s88, s88, 8192
    buffer_load_dwordx4 v[44:47], v2, s[12:15], s88 offen sc1
    s_add_u32 s88, s88, 8192
    buffer_load_dwordx4 v[48:51], v2, s[12:15], s88 offen sc1
    s_add_u32 s88, s88, 8192
    buffer_load_dwordx4 v[52:55], v2, s[12:15], s88 offen sc1
    s_add_u32 s88, s88, 8192
    buffer_load_dwordx4 v[56:59], v2, s[12:15], s88 offen sc1
    s_add_u32 s88, s88, 8192
    buffer_load_dwordx4 v[60:63], v2, s[12:15], s88 offen sc1
    s_add_u32 s88, s88, 8192
    buffer_load_dwordx4 v[64:67], v2, s[12:15], s88 offen sc1
    s_add_u32 s88, s88, 8192
    ds_read_b64_tr_b16 v[156:157], v7 offset:19200
    ds_read_b64_tr_b16 v[158:159], v7 offset:20480
    ds_read_b64_tr_b16 v[160:161], v7 offset:19232
    ds_read_b64_tr_b16 v[162:163], v7 offset:20512
    ds_read_b64_tr_b16 v[164:165], v7 offset:19264
    ds_read_b64_tr_b16 v[166:167], v7 offset:20544
    ds_read_b64_tr_b16 v[168:169], v7 offset:19296
    ds_read_b64_tr_b16 v[170:171], v7 offset:20576
    ds_read_b64_tr_b16 v[172:173], v7 offset:19328
    ds_read_b64_tr_b16 v[174:175], v7 offset:20608
    ds_read_b64_tr_b16 v[176:177], v7 offset:25600
    ds_read_b64_tr_b16 v[178:179], v7 offset:26880
    ds_read_b64_tr_b16 v[180:181], v7 offset:25632
    ds_read_b64_tr_b16 v[182:183], v7 offset:26912
    ds_read_b64_tr_b16 v[184:185], v7 offset:25664
    ds_read_b64_tr_b16 v[186:187], v7 offset:26944
    ds_read_b64_tr_b16 v[188:189], v7 offset:25696
    ds_read_b64_tr_b16 v[190:191], v7 offset:26976
    ds_read_b64_tr_b16 v[192:193], v7 offset:25728
    ds_read_b64_tr_b16 v[194:195], v7 offset:27008
    ds_read_b64_tr_b16 v[196:197], v7 offset:32000
    ds_read_b64_tr_b16 v[198:199], v7 offset:33280
    ds_read_b64_tr_b16 v[200:201], v7 offset:32032
    ds_read_b64_tr_b16 v[202:203], v7 offset:33312
    ds_read_b64_tr_b16 v[204:205], v7 offset:32064
    ds_read_b64_tr_b16 v[206:207], v7 offset:33344
    ds_read_b64_tr_b16 v[208:209], v7 offset:32096
    ds_read_b64_tr_b16 v[210:211], v7 offset:33376
    ds_read_b64_tr_b16 v[212:213], v7 offset:32128
    ds_read_b64_tr_b16 v[214:215], v7 offset:33408
    ds_read_b64_tr_b16 v[216:217], v7 offset:38400
    ds_read_b64_tr_b16 v[218:219], v7 offset:39680
    ds_read_b64_tr_b16 v[220:221], v7 offset:38432
    ds_read_b64_tr_b16 v[222:223], v7 offset:39712
    ds_read_b64_tr_b16 v[224:225], v7 offset:38464
    ds_read_b64_tr_b16 v[226:227], v7 offset:39744
    ds_read_b64_tr_b16 v[228:229], v7 offset:38496
    ds_read_b64_tr_b16 v[230:231], v7 offset:39776
    ds_read_b64_tr_b16 v[232:233], v7 offset:38528
    ds_read_b64_tr_b16 v[234:235], v7 offset:39808
    ds_read_b64_tr_b16 v[236:237], v7 offset:44800
    ds_read_b64_tr_b16 v[238:239], v7 offset:46080
    ds_read_b64_tr_b16 v[240:241], v7 offset:44832
    ds_read_b64_tr_b16 v[242:243], v7 offset:46112
    ds_read_b64_tr_b16 v[244:245], v7 offset:44864
    ds_read_b64_tr_b16 v[246:247], v7 offset:46144
    ds_read_b64_tr_b16 v[248:249], v7 offset:44896
    ds_read_b64_tr_b16 v[250:251], v7 offset:46176
    ds_read_b64_tr_b16 v[252:253], v7 offset:44928
    ds_read_b64_tr_b16 v[254:255], v7 offset:46208
    s_branch L_o_l5
L_y_get:
    s_mov_b32 s90, 0
    s_branch L_polle_116
L_poll_114:
    buffer_load_dwordx2 v[126:127], v245, s[12:15], s30 offen sc1
L_polle_116:
    s_add_u32 s90, s90, 1
    s_cmp_gt_u32 s90, 200000
    s_waitcnt vmcnt(0)
    s_cbranch_scc1 L_polld_115
    v_cmp_eq_u32 vcc, 0, v126
    s_cbranch_vccnz L_poll_114
L_polld_115:
    v_min_u32 v32, 59, v0
    v_mul_u32_u24 v34, 13, v32
    v_lshrrev_b32 v34, 8, v34
    v_mul_u32_u24 v34, 20160, v34
    v_lshl_add_u32 v32, v32, 4, v34
    v_add_u32 v34, 141312, v243
    v_and_b32 v35, 48, v0
    v_add_u32 v35, 141312, v35
    v_and_b32 v11, 15, v0
    s_cmp_ge_u32 s100, 16
    s_cbranch_scc1 L_ysk_117
    s_mul_i32 s59, s46, 320
    s_add_u32 s59, s59, 10878976
    s_mov_b32 m0, 141312
    s_nop 0
    buffer_load_dwordx4 v32, s[12:15], s59 offen sc1 lds
    s_add_u32 s59, s59, 2560
    s_mov_b32 m0, 142336
    s_nop 0
    buffer_load_dwordx4 v32, s[12:15], s59 offen sc1 lds
    s_add_u32 s59, s59, 2560
    s_mov_b32 m0, 143360
    s_nop 0
    buffer_load_dwordx4 v32, s[12:15], s59 offen sc1 lds
    s_add_u32 s59, s59, 2560
    s_mov_b32 m0, 144384
    s_nop 0
    buffer_load_dwordx4 v32, s[12:15], s59 offen sc1 lds
    s_add_u32 s59, s59, 2560
    s_mov_b32 m0, 145408
    s_nop 0
    buffer_load_dwordx4 v32, s[12:15], s59 offen sc1 lds
    s_add_u32 s59, s59, 2560
    s_mov_b32 m0, 146432
    s_nop 0
    buffer_load_dwordx4 v32, s[12:15], s59 offen sc1 lds
    s_add_u32 s59, s59, 2560
    s_mov_b32 m0, 147456
    s_nop 0
    buffer_load_dwordx4 v32, s[12:15], s59 offen sc1 lds
    s_add_u32 s59, s59, 2560
    s_mov_b32 m0, 148480
    s_nop 0
    buffer_load_dwordx4 v32, s[12:15], s59 offen sc1 lds
    s_and_b32 s59, s54, 0xffff0000
    s_ashr_i32 s60, s59, 31
    s_not_b32 s60, s60
    s_or_b32 s60, s60, 0x80000000
    s_xor_b32 s59, s59, s60
    s_and_b32 s59, s59, 0xffff0000
    v_readlane_b32 s60, v10, s100
    v_mov_b32 v36, 3216550459
    v_mul_f32 v36, s59, v36
    v_exp_f32 v36, v36
    s_nop 0
    v_add_f32 v36, 1.0, v36
    v_rcp_f32 v36, v36
    v_sub_f32 v37, 1.0, s60
    v_mul_f32 v36, v36, v37
    s_nop 0
    v_readfirstlane_b32 s54, v36
L_ysk_117:
    s_cmp_ge_u32 s101, 16
    s_cbranch_scc1 L_ysk_118
    s_mul_i32 s59, s46, 320
    s_add_u32 s59, s59, 10940416
    s_mov_b32 m0, 149504
    s_nop 0
    buffer_load_dwordx4 v32, s[12:15], s59 offen sc1 lds
    s_add_u32 s59, s59, 2560
    s_mov_b32 m0, 150528
    s_nop 0
    buffer_load_dwordx4 v32, s[12:15], s59 offen sc1 lds
    s_add_u32 s59, s59, 2560
    s_mov_b32 m0, 151552
    s_nop 0
    buffer_load_dwordx4 v32, s[12:15], s59 offen sc1 lds
    s_add_u32 s59, s59, 2560
    s_mov_b32 m0, 152576
    s_nop 0
    buffer_load_dwordx4 v32, s[12:15], s59 offen sc1 lds
    s_add_u32 s59, s59, 2560
    s_mov_b32 m0, 153600
    s_nop 0
    buffer_load_dwordx4 v32, s[12:15], s59 offen sc1 lds
    s_add_u32 s59, s59, 2560
    s_mov_b32 m0, 154624
    s_nop 0
    buffer_load_dwordx4 v32, s[12:15], s59 offen sc1 lds
    s_add_u32 s59, s59, 2560
    s_mov_b32 m0, 155648
    s_nop 0
    buffer_load_dwordx4 v32, s[12:15], s59 offen sc1 lds
    s_add_u32 s59, s59, 2560
    s_mov_b32 m0, 156672
    s_nop 0
    buffer_load_dwordx4 v32, s[12:15], s59 offen sc1 lds
    s_and_b32 s59, s55, 0xffff0000
    s_ashr_i32 s60, s59, 31
    s_not_b32 s60, s60
    s_or_b32 s60, s60, 0x80000000
    s_xor_b32 s59, s59, s60
    s_and_b32 s59, s59, 0xffff0000
    v_readlane_b32 s60, v10, s101
    v_mov_b32 v36, 3216550459
    v_mul_f32 v36, s59, v36
    v_exp_f32 v36, v36
    s_nop 0
    v_add_f32 v36, 1.0, v36
    v_rcp_f32 v36, v36
    v_sub_f32 v37, 1.0, s60
    v_mul_f32 v36, v36, v37
    s_nop 0
    v_readfirstlane_b32 s55, v36
L_ysk_118:
    s_branch L_y_back0
L_y_sum:
    s_waitcnt vmcnt(6)
    s_setprio 3
    s_cmp_ge_u32 s100, 16
    s_cbranch_scc1 L_ysk_119
    s_mov_b32 s90, 0
L_yag_120:
    ds_read_b128 v[176:179], v34 offset:0
    ds_read_b128 v[180:183], v34 offset:1024
    ds_read_b128 v[184:187], v34 offset:2048
    ds_read_b128 v[188:191], v34 offset:3072
    ds_read_b128 v[192:195], v34 offset:4096
    ds_read_b128 v[196:199], v34 offset:5120
    ds_read_b128 v[200:203], v34 offset:6144
    ds_read_b128 v[204:207], v34 offset:7168
    s_waitcnt lgkmcnt(6)
    v_add_f32 v208, v176, v180
    v_add_f32 v209, v177, v181
    v_add_f32 v210, v178, v182
    v_add_f32 v211, v179, v183
    s_waitcnt lgkmcnt(5)
    v_add_f32 v208, v208, v184
    v_add_f32 v209, v209, v185
    v_add_f32 v210, v210, v186
    v_add_f32 v211, v211, v187
    s_waitcnt lgkmcnt(4)
    v_add_f32 v208, v208, v188
    v_add_f32 v209, v209, v189
    v_add_f32 v210, v210, v190
    v_add_f32 v211, v211, v191
    s_waitcnt lgkmcnt(3)
    v_add_f32 v208, v208, v192
    v_add_f32 v209, v209, v193
    v_add_f32 v210, v210, v194
    v_add_f32 v211, v211, v195
    s_waitcnt lgkmcnt(2)
    v_add_f32 v208, v208, v196
    v_add_f32 v209, v209, v197
    v_add_f32 v210, v210, v198
    v_add_f32 v211, v211, v199
    s_waitcnt lgkmcnt(1)
    v_add_f32 v208, v208, v200
    v_add_f32 v209, v209, v201
    v_add_f32 v210, v210, v202
    v_add_f32 v211, v211, v203
    s_waitcnt lgkmcnt(0)
    v_add_f32 v208, v208, v204
    v_add_f32 v209, v209, v205
    v_add_f32 v210, v210, v206
    v_add_f32 v211, v211, v207
    v_add_f32 v212, v208, v209
    v_add_f32 v213, v210, v211
    v_cmp_u_f32 vcc, v212, v213
    s_cbranch_vccz L_yok_121
    v_max3_u32 v212, v176, v177, v178
    v_max3_u32 v212, v179, v180, v212
    v_max3_u32 v212, v181, v182, v212
    v_max3_u32 v212, v183, v184, v212
    v_max3_u32 v212, v185, v186, v212
    v_max3_u32 v212, v187, v188, v212
    v_max3_u32 v212, v189, v190, v212
    v_max3_u32 v212, v191, v192, v212
    v_max3_u32 v212, v193, v194, v212
    v_max3_u32 v212, v195, v196, v212
    v_max3_u32 v212, v197, v198, v212
    v_max3_u32 v212, v199, v200, v212
    v_max3_u32 v212, v201, v202, v212
    v_max3_u32 v212, v203, v204, v212
    v_max3_u32 v212, v205, v206, v212
    v_max_u32 v212, v207, v212
    s_add_u32 s90, s90, 1
    s_cmp_gt_u32 s90, 200000
    s_cbranch_scc1 L_yok_121
    v_cmp_eq_u32 vcc, -1, v212
    s_cbranch_vccz L_yok_121
    s_mul_i32 s59, s46, 320
    s_add_u32 s59, s59, 10878976
    s_mov_b32 m0, 141312
    s_nop 0
    buffer_load_dwordx4 v32, s[12:15], s59 offen sc1 lds
    s_add_u32 s59, s59, 2560
    s_mov_b32 m0, 142336
    s_nop 0
    buffer_load_dwordx4 v32, s[12:15], s59 offen sc1 lds
    s_add_u32 s59, s59, 2560
    s_mov_b32 m0, 143360
    s_nop 0
    buffer_load_dwordx4 v32, s[12:15], s59 offen sc1 lds
    s_add_u32 s59, s59, 2560
    s_mov_b32 m0, 144384
    s_nop 0
    buffer_load_dwordx4 v32, s[12:15], s59 offen sc1 lds
    s_add_u32 s59, s59, 2560
    s_mov_b32 m0, 145408
    s_nop 0
    buffer_load_dwordx4 v32, s[12:15], s59 offen sc1 lds
    s_add_u32 s59, s59, 2560
    s_mov_b32 m0, 146432
    s_nop 0
    buffer_load_dwordx4 v32, s[12:15], s59 offen sc1 lds
    s_add_u32 s59, s59, 2560
    s_mov_b32 m0, 147456
    s_nop 0
    buffer_load_dwordx4 v32, s[12:15], s59 offen sc1 lds
    s_add_u32 s59, s59, 2560
    s_mov_b32 m0, 148480
    s_nop 0
    buffer_load_dwordx4 v32, s[12:15], s59 offen sc1 lds
    s_waitcnt vmcnt(0)
    s_branch L_yag_120
L_yok_121:
    ds_write_b128 v34, v[208:211] offset:0
    ds_read_b128 v[212:215], v34 offset:320
    ds_read_b128 v[216:219], v34 offset:640
    v_cmp_eq_u32 vcc, s100, v11
    s_waitcnt lgkmcnt(0)
    v_add_f32 v208, v208, v212
    v_add_f32 v209, v209, v213
    v_add_f32 v210, v210, v214
    v_add_f32 v211, v211, v215
    v_add_f32 v208, v208, v216
    v_add_f32 v209, v209, v217
    v_add_f32 v210, v210, v218
    v_add_f32 v211, v211, v219
    ds_write_b128 v34, v[208:211] offset:0
    ds_read_b128 v[212:215], v35 offset:0
    ds_read_b128 v[216:219], v35 offset:64
    ds_read_b128 v[220:223], v35 offset:128
    ds_read_b128 v[224:227], v35 offset:192
    ds_read_b128 v[228:231], v35 offset:256
    s_mov_b64 exec, vcc
    s_waitcnt lgkmcnt(4)
    v_fmac_f32 v12, s54, v212
    v_fmac_f32 v13, s54, v213
    v_fmac_f32 v14, s54, v214
    v_fmac_f32 v15, s54, v215
    s_waitcnt lgkmcnt(3)
    v_fmac_f32 v16, s54, v216
    v_fmac_f32 v17, s54, v217
    v_fmac_f32 v18, s54, v218
    v_fmac_f32 v19, s54, v219
    s_waitcnt lgkmcnt(2)
    v_fmac_f32 v20, s54, v220
    v_fmac_f32 v21, s54, v221
    v_fmac_f32 v22, s54, v222
    v_fmac_f32 v23, s54, v223
    s_waitcnt lgkmcnt(1)
    v_fmac_f32 v24, s54, v224
    v_fmac_f32 v25, s54, v225
    v_fmac_f32 v26, s54, v226
    v_fmac_f32 v27, s54, v227
    s_waitcnt lgkmcnt(0)
    v_fmac_f32 v28, s54, v228
    v_fmac_f32 v29, s54, v229
    v_fmac_f32 v30, s54, v230
    v_fmac_f32 v31, s54, v231
    s_mov_b64 exec, -1
L_ysk_119:
    s_cmp_ge_u32 s101, 16
    s_cbranch_scc1 L_ysk_123
    s_mov_b32 s90, 0
L_yag_124:
    ds_read_b128 v[176:179], v34 offset:8192
    ds_read_b128 v[180:183], v34 offset:9216
    ds_read_b128 v[184:187], v34 offset:10240
    ds_read_b128 v[188:191], v34 offset:11264
    ds_read_b128 v[192:195], v34 offset:12288
    ds_read_b128 v[196:199], v34 offset:13312
    ds_read_b128 v[200:203], v34 offset:14336
    ds_read_b128 v[204:207], v34 offset:15360
    s_waitcnt lgkmcnt(6)
    v_add_f32 v208, v176, v180
    v_add_f32 v209, v177, v181
    v_add_f32 v210, v178, v182
    v_add_f32 v211, v179, v183
    s_waitcnt lgkmcnt(5)
    v_add_f32 v208, v208, v184
    v_add_f32 v209, v209, v185
    v_add_f32 v210, v210, v186
    v_add_f32 v211, v211, v187
    s_waitcnt lgkmcnt(4)
    v_add_f32 v208, v208, v188
    v_add_f32 v209, v209, v189
    v_add_f32 v210, v210, v190
    v_add_f32 v211, v211, v191
    s_waitcnt lgkmcnt(3)
    v_add_f32 v208, v208, v192
    v_add_f32 v209, v209, v193
    v_add_f32 v210, v210, v194
    v_add_f32 v211, v211, v195
    s_waitcnt lgkmcnt(2)
    v_add_f32 v208, v208, v196
    v_add_f32 v209, v209, v197
    v_add_f32 v210, v210, v198
    v_add_f32 v211, v211, v199
    s_waitcnt lgkmcnt(1)
    v_add_f32 v208, v208, v200
    v_add_f32 v209, v209, v201
    v_add_f32 v210, v210, v202
    v_add_f32 v211, v211, v203
    s_waitcnt lgkmcnt(0)
    v_add_f32 v208, v208, v204
    v_add_f32 v209, v209, v205
    v_add_f32 v210, v210, v206
    v_add_f32 v211, v211, v207
    v_add_f32 v212, v208, v209
    v_add_f32 v213, v210, v211
    v_cmp_u_f32 vcc, v212, v213
    s_cbranch_vccz L_yok_125
    v_max3_u32 v212, v176, v177, v178
    v_max3_u32 v212, v179, v180, v212
    v_max3_u32 v212, v181, v182, v212
    v_max3_u32 v212, v183, v184, v212
    v_max3_u32 v212, v185, v186, v212
    v_max3_u32 v212, v187, v188, v212
    v_max3_u32 v212, v189, v190, v212
    v_max3_u32 v212, v191, v192, v212
    v_max3_u32 v212, v193, v194, v212
    v_max3_u32 v212, v195, v196, v212
    v_max3_u32 v212, v197, v198, v212
    v_max3_u32 v212, v199, v200, v212
    v_max3_u32 v212, v201, v202, v212
    v_max3_u32 v212, v203, v204, v212
    v_max3_u32 v212, v205, v206, v212
    v_max_u32 v212, v207, v212
    s_add_u32 s90, s90, 1
    s_cmp_gt_u32 s90, 200000
    s_cbranch_scc1 L_yok_125
    v_cmp_eq_u32 vcc, -1, v212
    s_cbranch_vccz L_yok_125
    s_mul_i32 s59, s46, 320
    s_add_u32 s59, s59, 10940416
    s_mov_b32 m0, 149504
    s_nop 0
    buffer_load_dwordx4 v32, s[12:15], s59 offen sc1 lds
    s_add_u32 s59, s59, 2560
    s_mov_b32 m0, 150528
    s_nop 0
    buffer_load_dwordx4 v32, s[12:15], s59 offen sc1 lds
    s_add_u32 s59, s59, 2560
    s_mov_b32 m0, 151552
    s_nop 0
    buffer_load_dwordx4 v32, s[12:15], s59 offen sc1 lds
    s_add_u32 s59, s59, 2560
    s_mov_b32 m0, 152576
    s_nop 0
    buffer_load_dwordx4 v32, s[12:15], s59 offen sc1 lds
    s_add_u32 s59, s59, 2560
    s_mov_b32 m0, 153600
    s_nop 0
    buffer_load_dwordx4 v32, s[12:15], s59 offen sc1 lds
    s_add_u32 s59, s59, 2560
    s_mov_b32 m0, 154624
    s_nop 0
    buffer_load_dwordx4 v32, s[12:15], s59 offen sc1 lds
    s_add_u32 s59, s59, 2560
    s_mov_b32 m0, 155648
    s_nop 0
    buffer_load_dwordx4 v32, s[12:15], s59 offen sc1 lds
    s_add_u32 s59, s59, 2560
    s_mov_b32 m0, 156672
    s_nop 0
    buffer_load_dwordx4 v32, s[12:15], s59 offen sc1 lds
    s_waitcnt vmcnt(0)
    s_branch L_yag_124
L_yok_125:
    ds_write_b128 v34, v[208:211] offset:8192
    ds_read_b128 v[212:215], v34 offset:8512
    ds_read_b128 v[216:219], v34 offset:8832
    v_cmp_eq_u32 vcc, s101, v11
    s_waitcnt lgkmcnt(0)
    v_add_f32 v208, v208, v212
    v_add_f32 v209, v209, v213
    v_add_f32 v210, v210, v214
    v_add_f32 v211, v211, v215
    v_add_f32 v208, v208, v216
    v_add_f32 v209, v209, v217
    v_add_f32 v210, v210, v218
    v_add_f32 v211, v211, v219
    ds_write_b128 v34, v[208:211] offset:8192
    ds_read_b128 v[212:215], v35 offset:8192
    ds_read_b128 v[216:219], v35 offset:8256
    ds_read_b128 v[220:223], v35 offset:8320
    ds_read_b128 v[224:227], v35 offset:8384
    ds_read_b128 v[228:231], v35 offset:8448
    s_mov_b64 exec, vcc
    s_waitcnt lgkmcnt(4)
    v_fmac_f32 v12, s55, v212
    v_fmac_f32 v13, s55, v213
    v_fmac_f32 v14, s55, v214
    v_fmac_f32 v15, s55, v215
    s_waitcnt lgkmcnt(3)
    v_fmac_f32 v16, s55, v216
    v_fmac_f32 v17, s55, v217
    v_fmac_f32 v18, s55, v218
    v_fmac_f32 v19, s55, v219
    s_waitcnt lgkmcnt(2)
    v_fmac_f32 v20, s55, v220
    v_fmac_f32 v21, s55, v221
    v_fmac_f32 v22, s55, v222
    v_fmac_f32 v23, s55, v223
    s_waitcnt lgkmcnt(1)
    v_fmac_f32 v24, s55, v224
    v_fmac_f32 v25, s55, v225
    v_fmac_f32 v26, s55, v226
    v_fmac_f32 v27, s55, v227
    s_waitcnt lgkmcnt(0)
    v_fmac_f32 v28, s55, v228
    v_fmac_f32 v29, s55, v229
    v_fmac_f32 v30, s55, v230
    v_fmac_f32 v31, s55, v231
    s_mov_b64 exec, -1
L_ysk_123:
    s_branch L_y_back1
L_att_fb:
    s_mov_b32 s92, 1
    s_mov_b32 exec_lo, 0
    v_mov_b32 v22, 0
    v_mov_b32 v23, 0
    s_mov_b64 exec, -1
    ds_read_b128 v[16:19], v240 offset:8192
    ds_read_b64 v[20:21], v241 offset:4096
    s_waitcnt lgkmcnt(0)
    v_mfma_f32_32x32x16_bf16 v[64:79], v[16:19], v[32:35], v[208:223]
    v_mfma_f32_32x32x8_bf16 v[64:79], v[20:21], v[22:23], v[64:79]
    s_nop 11
    v_max3_f32 v11, v64, v65, v66
    v_max3_f32 v11, v67, v68, v11
    v_max3_f32 v11, v69, v70, v11
    v_max3_f32 v11, v71, v72, v11
    v_max3_f32 v11, v73, v74, v11
    v_max3_f32 v11, v75, v76, v11
    v_max3_f32 v11, v77, v78, v11
    v_max_f32 v11, v79, v11
    s_cmp_eq_u32 s31, 8
    s_cbranch_scc1 L_att_fb2
    ds_read_b128 v[16:19], v240 offset:7168
    ds_read_b64 v[20:21], v241 offset:3584
    s_waitcnt lgkmcnt(0)
    v_mfma_f32_32x32x16_bf16 v[64:79], v[16:19], v[32:35], 0
    v_mfma_f32_32x32x8_bf16 v[64:79], v[20:21], v[22:23], v[64:79]
    s_nop 11
    v_max3_f32 v11, v64, v65, v11
    v_max3_f32 v11, v66, v67, v11
    v_max3_f32 v11, v68, v69, v11
    v_max3_f32 v11, v70, v71, v11
    v_max3_f32 v11, v72, v73, v11
    v_max3_f32 v11, v74, v75, v11
    v_max3_f32 v11, v76, v77, v11
    v_max3_f32 v11, v78, v79, v11
    s_cmp_eq_u32 s31, 7
    s_cbranch_scc1 L_att_fb2
    ds_read_b128 v[16:19], v240 offset:6144
    ds_read_b64 v[20:21], v241 offset:3072
    s_waitcnt lgkmcnt(0)
    v_mfma_f32_32x32x16_bf16 v[64:79], v[16:19], v[32:35], 0
    v_mfma_f32_32x32x8_bf16 v[64:79], v[20:21], v[22:23], v[64:79]
    s_nop 11
    v_max3_f32 v11, v64, v65, v11
    v_max3_f32 v11, v66, v67, v11
    v_max3_f32 v11, v68, v69, v11
    v_max3_f32 v11, v70, v71, v11
    v_max3_f32 v11, v72, v73, v11
    v_max3_f32 v11, v74, v75, v11
    v_max3_f32 v11, v76, v77, v11
    v_max3_f32 v11, v78, v79, v11
    s_cmp_eq_u32 s31, 6
    s_cbranch_scc1 L_att_fb2
    ds_read_b128 v[16:19], v240 offset:5120
    ds_read_b64 v[20:21], v241 offset:2560
    s_waitcnt lgkmcnt(0)
    v_mfma_f32_32x32x16_bf16 v[64:79], v[16:19], v[32:35], 0
    v_mfma_f32_32x32x8_bf16 v[64:79], v[20:21], v[22:23], v[64:79]
    s_nop 11
    v_max3_f32 v11, v64, v65, v11
    v_max3_f32 v11, v66, v67, v11
    v_max3_f32 v11, v68, v69, v11
    v_max3_f32 v11, v70, v71, v11
    v_max3_f32 v11, v72, v73, v11
    v_max3_f32 v11, v74, v75, v11
    v_max3_f32 v11, v76, v77, v11
    v_max3_f32 v11, v78, v79, v11
    s_cmp_eq_u32 s31, 5
    s_cbranch_scc1 L_att_fb2
    ds_read_b128 v[16:19], v240 offset:4096
    ds_read_b64 v[20:21], v241 offset:2048
    s_waitcnt lgkmcnt(0)
    v_mfma_f32_32x32x16_bf16 v[64:79], v[16:19], v[32:35], 0
    v_mfma_f32_32x32x8_bf16 v[64:79], v[20:21], v[22:23], v[64:79]
    s_nop 11
    v_max3_f32 v11, v64, v65, v11
    v_max3_f32 v11, v66, v67, v11
    v_max3_f32 v11, v68, v69, v11
    v_max3_f32 v11, v70, v71, v11
    v_max3_f32 v11, v72, v73, v11
    v_max3_f32 v11, v74, v75, v11
    v_max3_f32 v11, v76, v77, v11
    v_max3_f32 v11, v78, v79, v11
    s_cmp_eq_u32 s31, 4
    s_cbranch_scc1 L_att_fb2
    ds_read_b128 v[16:19], v240 offset:3072
    ds_read_b64 v[20:21], v241 offset:1536
    s_waitcnt lgkmcnt(0)
    v_mfma_f32_32x32x16_bf16 v[64:79], v[16:19], v[32:35], 0
    v_mfma_f32_32x32x8_bf16 v[64:79], v[20:21], v[22:23], v[64:79]
    s_nop 11
    v_max3_f32 v11, v64, v65, v11
    v_max3_f32 v11, v66, v67, v11
    v_max3_f32 v11, v68, v69, v11
    v_max3_f32 v11, v70, v71, v11
    v_max3_f32 v11, v72, v73, v11
    v_max3_f32 v11, v74, v75, v11
    v_max3_f32 v11, v76, v77, v11
    v_max3_f32 v11, v78, v79, v11
    s_cmp_eq_u32 s31, 3
    s_cbranch_scc1 L_att_fb2
    ds_read_b128 v[16:19], v240 offset:2048
    ds_read_b64 v[20:21], v241 offset:1024
    s_waitcnt lgkmcnt(0)
    v_mfma_f32_32x32x16_bf16 v[64:79], v[16:19], v[32:35], 0
    v_mfma_f32_32x32x8_bf16 v[64:79], v[20:21], v[22:23], v[64:79]
    s_nop 11
    v_max3_f32 v11, v64, v65, v11
    v_max3_f32 v11, v66, v67, v11
    v_max3_f32 v11, v68, v69, v11
    v_max3_f32 v11, v70, v71, v11
    v_max3_f32 v11, v72, v73, v11
    v_max3_f32 v11, v74, v75, v11
    v_max3_f32 v11, v76, v77, v11
    v_max3_f32 v11, v78, v79, v11
    s_cmp_eq_u32 s31, 2
    s_cbranch_scc1 L_att_fb2
    ds_read_b128 v[16:19], v240 offset:1024
    ds_read_b64 v[20:21], v241 offset:512
    s_waitcnt lgkmcnt(0)
    v_mfma_f32_32x32x16_bf16 v[64:79], v[16:19], v[32:35], 0
    v_mfma_f32_32x32x8_bf16 v[64:79], v[20:21], v[22:23], v[64:79]
    s_nop 11
    v_max3_f32 v11, v64, v65, v11
    v_max3_f32 v11, v66, v67, v11
    v_max3_f32 v11, v68, v69, v11
    v_max3_f32 v11, v70, v71, v11
    v_max3_f32 v11, v72, v73, v11
    v_max3_f32 v11, v74, v75, v11
    v_max3_f32 v11, v76, v77, v11
    v_max3_f32 v11, v78, v79, v11
    s_cmp_eq_u32 s31, 1
    s_cbranch_scc1 L_att_fb2
    ds_read_b128 v[16:19], v240 offset:0
    ds_read_b64 v[20:21], v241 offset:0
    s_waitcnt lgkmcnt(0)
    v_mfma_f32_32x32x16_bf16 v[64:79], v[16:19], v[32:35], v[224:239]
    v_mfma_f32_32x32x8_bf16 v[64:79], v[20:21], v[22:23], v[64:79]
    s_nop 11
    v_max3_f32 v11, v64, v65, v11
    v_max3_f32 v11, v66, v67, v11
    v_max3_f32 v11, v68, v69, v11
    v_max3_f32 v11, v70, v71, v11
    v_max3_f32 v11, v72, v73, v11
    v_max3_f32 v11, v74, v75, v11
    v_max3_f32 v11, v76, v77, v11
    v_max3_f32 v11, v78, v79, v11
L_att_fb2:
    v_mov_b32 v12, v11
    s_nop 1
    v_permlane32_swap_b32 v11, v12
    v_max_f32 v11, v11, v12
    v_and_b32 v12, 0xffff0000, v11
    v_sub_f32 v1, v11, v12
    v_and_b32 v14, 0xffff0000, v1
    v_sub_f32 v1, v1, v14
    s_mov_b32 exec_lo, 0
    v_cvt_pk_bf16_f32 v22, -v12, -v14
    v_cvt_pk_bf16_f32 v23, -v1, 0
    s_mov_b64 exec, -1
    ds_read_b128 v[16:19], v240 offset:8192
    ds_read_b64 v[20:21], v241 offset:4096
    s_waitcnt lgkmcnt(0)
    v_mfma_f32_32x32x16_bf16 v[64:79], v[16:19], v[32:35], v[208:223]
    v_mfma_f32_32x32x8_bf16 v[64:79], v[20:21], v[22:23], v[64:79]
    s_cmp_lt_u32 s40, 4
    s_cbranch_scc1 L_att_o
    s_branch L_att_y
L_code_end:
.section .rodata,"a"
.p2align 6
.amdhsa_kernel gated_mix__sliding_block__moe_arch_mod__prompt_kernel
  .amdhsa_next_free_vgpr 256
  .amdhsa_next_free_sgpr 102
  .amdhsa_accum_offset 256
  .amdhsa_group_segment_fixed_size 0
  .amdhsa_kernarg_size 96
  .amdhsa_user_sgpr_count 2
  .amdhsa_user_sgpr_kernarg_segment_ptr 1
  .amdhsa_system_sgpr_workgroup_id_x 1
.end_amdhsa_kernel
```
